```python
import torch

def _softmax(x, axis=-1):
    return torch.softmax(x, dim=axis)
def _gelu(x):
    return torch.nn.functional.gelu(x, approximate="tanh")
def _silu(x):
    return torch.nn.functional.silu(x)
def _sigmoid(x):
    return torch.sigmoid(x)
def _layernorm(x, axis=-1, eps=1e-5):
    m = x.mean(dim=axis, keepdim=True)
    v = x.var(dim=axis, keepdim=True, unbiased=False)
    return (x - m) / torch.sqrt(v + eps)
def _scatter_add(tgt, idx, src, axis=0):
    return tgt.clone().index_add_(axis, idx, src)
def _segment_sum(src, seg, n):
    out = torch.zeros((n,) + src.shape[1:], dtype=src.dtype)
    return out.index_add_(0, seg, src)
def _pad(x, pw):
    flat = tuple(v for pair in reversed(pw) for v in pair)
    return torch.nn.functional.pad(x, flat)

kernel_name = 'standalone__mha_block_cached__near_ridge'

def setup_inputs():

    _w = (lambda a: (lambda t: t.to(torch.bfloat16) if t.is_floating_point() else t)(torch.as_tensor(a)))
    B, Sq, D = 8, 144, 448
    H, Sk, Dh = 16, 512, 256
    return {
        "x": _w((lambda *s: torch.randn(*s, dtype=torch.bfloat16) * 0.8)(B, Sq, D)),
        "k_cache": _w((lambda *s: torch.randn(*s, dtype=torch.bfloat16) * 0.8)(B, H, Sk, Dh)),
        "v_cache": _w((lambda *s: torch.randn(*s, dtype=torch.bfloat16) * 0.05)(B, H, Sk, Dh)),
        "wq": _w((lambda *s: torch.randn(*s, dtype=torch.bfloat16) * 0.8)(D, H * Dh) * (D ** -0.5)),
        "wo": _w((lambda *s: torch.randn(*s, dtype=torch.bfloat16) * 0.05)(H * Dh, D) * ((H * Dh) ** -0.5)),
    }

def reference(x, k_cache, v_cache, wq, wo):
    B, Sq, D = x.shape
    H, Dh = 16, 256
    q = (lambda x, *d: x.permute(*d))((x @ wq).reshape(B, Sq, H, Dh), 0, 2, 1, 3)
    scores = torch.einsum("bhqd,bhkd->bhqk", q, k_cache) * (Dh ** -0.5)
    p = _softmax(scores, axis=-1)
    o = torch.einsum("bhqk,bhkd->bhqd", p, v_cache)
    return (lambda x, *d: x.permute(*d))(o, 0, 2, 1, 3).reshape(B, Sq, H * Dh) @ wo
```

```asm
; @launch grid=(256,1,1) block=(256,1,1) lds=163840
.amdgcn_target "amdgcn-amd-amdhsa--gfx950"
.text
.globl standalone__mha_block_cached__near_ridge_kernel
.p2align 8
.type standalone__mha_block_cached__near_ridge_kernel,@function
standalone__mha_block_cached__near_ridge_kernel:
    s_cmp_ge_u32 s2, 256
    s_cbranch_scc1 L_k1_end5
    s_load_dwordx8 s[4:11], s[0:1], 0
    s_load_dwordx2 s[12:13], s[0:1], 32
    v_lshrrev_b32 v1, 6, v0
    s_getpc_b64 s[92:93]
L_pc0:
    v_and_b32 v2, 3, v0
    s_lshr_b32 s21, s2, 3
    v_lshl_add_u32 v2, v2, 7, v1
    s_lshl_b32 s20, s21, 2
    v_add_lshl_u32 v2, v2, s20, 7
    v_min_u32 v2, L_pend4-L_pc0-4, v2
    global_load_dword v255, v2, s[92:93]
    s_load_dwordx2 s[14:15], s[0:1], 56
    s_load_dwordx2 s[88:89], s[0:1], 40
    s_load_dwordx2 s[84:85], s[0:1], 48
    v_and_b32 v0, 63, v0
    v_readfirstlane_b32 s3, v1
    s_and_b32 s20, s2, 7
    s_lshr_b32 s21, s2, 3
    s_and_b32 s22, s21, 1
    s_lshl_b32 s17, s20, 1
    s_add_u32 s17, s17, s22
    s_lshr_b32 s19, s21, 1
    s_lshr_b32 s16, s19, 1
    s_bitcmp1_b32 s19, 0
    s_cbranch_scc0 L_k1_nt4
L_path5:
    s_mul_i32 s20, s19, 7
    s_lshr_b32 s21, s20, 3
    s_mul_i32 s22, s22, 7
    s_add_u32 s21, s21, s22
    s_cmp_ge_u32 s21, 14
    s_cselect_b32 s22, 14, 0
    s_sub_u32 s21, s21, s22
    s_and_b32 s55, s21, 1
    s_lshr_b32 s21, s21, 1
    s_lshr_b32 s23, s20, 4
    s_lshl_b32 s48, s21, 7
    s_add_u32 s49, s48, 128
    s_cmp_eq_u32 s49, 896
    s_cselect_b32 s49, 0, s49
    s_add_u32 s50, s49, 128
    s_cmp_eq_u32 s50, 896
    s_cselect_b32 s50, 0, s50
    s_add_u32 s51, s50, 128
    s_cmp_eq_u32 s51, 896
    s_cselect_b32 s51, 0, s51
    s_add_u32 s52, s51, 128
    s_cmp_eq_u32 s52, 896
    s_cselect_b32 s52, 0, s52
    s_add_u32 s53, s52, 128
    s_cmp_eq_u32 s53, 896
    s_cselect_b32 s53, 0, s53
    s_add_u32 s54, s53, 128
    s_cmp_eq_u32 s54, 896
    s_cselect_b32 s54, 0, s54
    v_lshrrev_b32 v46, 3, v0
    v_and_b32 v47, 7, v0
    v_and_b32 v48, 6, v46
    v_xor_b32 v47, v47, v48
    v_lshlrev_b32 v47, 4, v47
    v_mul_u32_u24 v48, 896, v46
    v_add_u32 v48, v48, v47
    s_mul_i32 s20, s3, 7168
    v_add_u32 v2, s20, v48
    v_add_u32 v3, 28672, v2
    s_lshl_b32 s99, s3, 10
    s_add_u32 s99, s99, 10240
    s_mul_i32 s98, s3, 16384
    s_add_u32 s98, s98, 81920
    s_and_b32 s20, s3, 1
    s_lshl_b32 s97, s20, 10
    s_mul_i32 s20, s20, 7168
    s_add_u32 s20, s20, 57344
    v_add_u32 v4, s20, v48
    s_cmp_ge_u32 s3, 2
    s_cselect_b32 s92, s49, s48
    s_cselect_b32 s93, s51, s50
    s_cselect_b32 s94, s53, s52
    s_cselect_b32 s95, 10240, 0
    s_add_u32 s95, s95, s97
    v_and_b32 v49, 3, v46
    v_lshrrev_b32 v50, 2, v46
    v_lshl_add_u32 v49, v50, 3, v49
    v_lshl_add_u32 v49, v49, 13, v47
    s_lshl_b32 s20, s3, 7
    v_add_u32 v5, s20, v49
    v_add_u32 v6, 130048, v5
    v_add_u32 v7, 30720, v5
    v_add_u32 v8, 160768, v5
    s_lshl_b32 s22, s55, 18
    s_lshl_b32 s56, s48, 12
    s_add_u32 s56, s56, s22
    s_mul_i32 s20, s16, 129024
    s_add_u32 s20, s20, 0
    s_lshl_b32 s21, s17, 9
    s_mov_b32 s26, 71680
    s_mov_b32 s27, 0x20000
    s_sub_u32 s38, 3670016, s21
    s_mov_b32 s39, 0x20000
    s_waitcnt lgkmcnt(0)
    s_add_u32 s24, s4, s20
    s_addc_u32 s25, s5, 0
    s_add_u32 s36, s10, s21
    s_addc_u32 s37, s11, 0
    s_xor_b32 s57, s56, 262144
    s_add_u32 m0, s99, 0
    s_nop 0
    buffer_load_dwordx4 v2, s[24:27], s48 offen lds
    s_add_u32 m0, s99, 4096
    s_nop 0
    buffer_load_dwordx4 v3, s[24:27], s48 offen lds
    s_add_u32 m0, s99, 10240
    s_nop 0
    buffer_load_dwordx4 v2, s[24:27], s49 offen lds
    s_add_u32 m0, s99, 14336
    s_nop 0
    buffer_load_dwordx4 v3, s[24:27], s49 offen lds
    s_add_u32 m0, s95, 18432
    s_nop 0
    buffer_load_dwordx4 v4, s[24:27], s92 offen lds
    s_add_u32 m0, s99, 20480
    s_nop 0
    buffer_load_dwordx4 v2, s[24:27], s50 offen lds
    s_add_u32 m0, s99, 24576
    s_nop 0
    buffer_load_dwordx4 v3, s[24:27], s50 offen lds
    s_add_u32 m0, s99, 30720
    s_nop 0
    buffer_load_dwordx4 v2, s[24:27], s51 offen lds
    s_add_u32 m0, s99, 34816
    s_nop 0
    buffer_load_dwordx4 v3, s[24:27], s51 offen lds
    s_lshl_b32 s58, s49, 12
    s_add_u32 s58, s58, s22
    s_xor_b32 s59, s58, 262144
    s_lshl_b32 s60, s50, 12
    s_add_u32 s60, s60, s22
    s_xor_b32 s61, s60, 262144
    s_lshl_b32 s62, s51, 12
    s_add_u32 s62, s62, s22
    s_xor_b32 s63, s62, 262144
    s_lshl_b32 s64, s52, 12
    s_add_u32 s64, s64, s22
    s_xor_b32 s65, s64, 262144
    s_lshl_b32 s66, s53, 12
    s_add_u32 s66, s66, s22
    s_xor_b32 s67, s66, 262144
    s_lshl_b32 s68, s54, 12
    s_add_u32 s68, s68, s22
    s_xor_b32 s69, s68, 262144
    s_lshl_b32 s20, s16, 4
    s_add_u32 s21, s20, s17
    s_lshl_b32 s20, s21, 18
    s_add_u32 s28, s6, s20
    s_addc_u32 s29, s7, 0
    s_sub_u32 s28, s28, 2048
    s_subb_u32 s29, s29, 0
    s_mov_b32 s30, 264192
    s_mov_b32 s31, 0x20000
    s_add_u32 s32, s8, s20
    s_addc_u32 s33, s9, 0
    s_mov_b32 s34, 262144
    s_mov_b32 s35, 0x20000
    s_mul_i32 s20, s17, 229376
    s_add_u32 s40, s12, s20
    s_addc_u32 s41, s13, 0
    s_mov_b32 s42, 229376
    s_mov_b32 s43, 0x20000
    s_mul_i32 s20, s21, 133120
    s_add_u32 s44, s14, s20
    s_addc_u32 s45, s15, 0
    s_mov_b32 s46, 133120
    s_mov_b32 s47, 0x20000
    s_mov_b32 s96, 0x3db8aa3b
    s_and_b32 s90, s16, 3
    s_lshl_b32 s90, s90, 16
    s_and_b32 s18, s17, 1
    s_lshl_b32 s18, s18, 8
    s_or_b32 s18, s18, s90
    v_lshl_add_u32 v49, v46, 9, v47
    s_lshl_b32 s20, s3, 14
    s_add_u32 s20, s20, 2048
    v_add_u32 v9, s20, v49
    v_add_u32 v10, 3072, v9
    v_subrev_u32 v11, 1920, v9
    v_add_u32 v12, 1152, v9
    s_lshl_b32 s20, s3, 7
    v_add_u32 v13, s20, v49
    v_add_u32 v14, 3072, v13
    v_add_u32 v15, 6144, v13
    v_add_u32 v16, 9216, v13
    s_mul_i32 s20, s3, 57344
    v_add_u32 v17, s20, v48
    v_add_u32 v18, 6144, v17
    v_add_u32 v19, 12288, v17
    v_add_u32 v20, 18432, v17
    s_lshl_b32 s70, s23, 7
    s_add_u32 s71, s70, 128
    s_cmp_eq_u32 s71, 896
    s_cselect_b32 s71, 0, s71
    s_add_u32 s72, s71, 128
    s_cmp_eq_u32 s72, 896
    s_cselect_b32 s72, 0, s72
    s_add_u32 s73, s72, 128
    s_cmp_eq_u32 s73, 896
    s_cselect_b32 s73, 0, s73
    s_add_u32 s74, s73, 128
    s_cmp_eq_u32 s74, 896
    s_cselect_b32 s74, 0, s74
    s_add_u32 s75, s74, 128
    s_cmp_eq_u32 s75, 896
    s_cselect_b32 s75, 0, s75
    s_add_u32 s76, s75, 128
    s_cmp_eq_u32 s76, 896
    s_cselect_b32 s76, 0, s76
    s_mul_i32 s20, s16, 16384
    s_add_u32 s20, s20, 25165824
    s_add_u32 s80, s14, s20
    s_addc_u32 s81, s15, 0
    s_mov_b32 s82, 16384
    s_mov_b32 s83, 0x20000
    s_mov_b32 s86, 256
    s_mov_b32 s87, 0x20000
    s_mul_i32 s8, s16, 2
    s_add_u32 s8, s8, s17
    s_and_b32 s8, s8, 15
    s_lshl_b32 s20, s8, 2
    s_add_u32 s20, s20, s3
    s_add_u32 s20, s20, 0
    s_mul_i32 s20, s20, 128
    v_lshlrev_b32 v1, 24, v0
    v_add_u32 v1, s20, v1
    v_mov_b32 v58, 0
    buffer_store_dword v58, v1, s[80:83], 0 offen sc1
    v_lshrrev_b32 v46, 2, v0
    v_bfe_u32 v47, v0, 3, 2
    v_and_b32 v48, 3, v0
    v_lshlrev_b32 v48, 3, v48
    v_lshl_add_u32 v48, v46, 7, v48
    v_lshl_add_u32 v49, v47, 5, v48
    v_add_u32 v21, s98, v49
    v_xor_b32 v22, 32, v21
    v_xor_b32 v23, 64, v21
    v_xor_b32 v24, 96, v21
    s_lshl_b32 s20, s3, 5
    v_xor_b32 v49, s20, v49
    v_add_u32 v25, 81920, v49
    v_add_u32 v26, 114688, v49
    v_add_u32 v27, 40960, v49
    v_and_b32 v46, 15, v0
    v_lshrrev_b32 v47, 4, v0
    v_and_b32 v48, 6, v0
    v_xor_b32 v48, v48, v47
    v_lshlrev_b32 v48, 4, v48
    v_lshl_add_u32 v48, v46, 7, v48
    v_add_u32 v30, s98, v48
    v_xor_b32 v31, 64, v30
    s_lshl_b32 s20, s55, 6
    v_xor_b32 v48, s20, v48
    v_add_u32 v28, 10240, v48
    v_xor_b32 v29, 64, v28
    v_lshlrev_b32 v32, 4, v0
    v_add_u32 v33, 40960, v32
    s_mul_i32 s20, s3, 10240
    v_add_u32 v36, s20, v32
    s_mul_i32 s22, s3, 5120
    v_add_u32 v35, s22, v32
    v_add_u32 v45, 40960, v35
    v_lshrrev_b32 v48, 1, v47
    v_lshlrev_b32 v48, 8, v48
    v_lshl_add_u32 v48, v46, 4, v48
    v_and_b32 v49, 1, v47
    v_lshl_add_u32 v48, v49, 3, v48
    v_add_u32 v34, s20, v48
    v_lshlrev_b32 v48, 4, v46
    v_add_u32 v38, 147456, v48
    s_lshl_b32 s20, s3, 2
    v_add_u32 v37, s20, v38
    v_lshl_add_u32 v44, v47, 2, v38
    v_lshlrev_b32 v48, 3, v0
    s_lshl_b32 s20, s3, 9
    s_add_u32 s20, s20, 147456
    v_add_u32 v49, s20, v48
    v_mov_b32 v56, 0xff800000
    v_mov_b32 v57, 0xff800000
    ds_write_b64 v49, v[56:57]
    s_lshl_b32 s20, s3, 10
    v_add_u32 v39, s20, v32
    v_add_u32 v40, 4096, v39
    s_add_u32 m0, s95, 38912
    s_nop 0
    buffer_load_dwordx4 v4, s[24:27], s93 offen lds
    s_add_u32 m0, s98, 0
    s_nop 0
    buffer_load_dwordx4 v5, s[36:39], s56 offen  lds
    buffer_load_dwordx4 v6, s[36:39], s56 offen offset:1024  lds
    buffer_load_dwordx4 v7, s[36:39], s56 offen offset:2048  lds
    buffer_load_dwordx4 v8, s[36:39], s56 offen offset:3072  lds
    s_add_u32 m0, s98, 4096
    s_nop 0
    buffer_load_dwordx4 v5, s[36:39], s57 offen  lds
    buffer_load_dwordx4 v6, s[36:39], s57 offen offset:1024  lds
    buffer_load_dwordx4 v7, s[36:39], s57 offen offset:2048  lds
    buffer_load_dwordx4 v8, s[36:39], s57 offen offset:3072  lds
    s_add_u32 m0, s98, 8192
    s_nop 0
    buffer_load_dwordx4 v5, s[36:39], s58 offen  lds
    buffer_load_dwordx4 v6, s[36:39], s58 offen offset:1024  lds
    buffer_load_dwordx4 v7, s[36:39], s58 offen offset:2048  lds
    buffer_load_dwordx4 v8, s[36:39], s58 offen offset:3072  lds
    s_add_u32 m0, s98, 12288
    s_nop 0
    buffer_load_dwordx4 v5, s[36:39], s59 offen  lds
    buffer_load_dwordx4 v6, s[36:39], s59 offen offset:1024  lds
    buffer_load_dwordx4 v7, s[36:39], s59 offen offset:2048  lds
    buffer_load_dwordx4 v8, s[36:39], s59 offen offset:3072  lds
    s_waitcnt vmcnt(22)
    s_waitcnt vmcnt(16)
    s_waitcnt lgkmcnt(0)
    s_barrier
    ds_read_b128 v[56:59], v28 offset:0
    ds_read_b128 v[60:63], v28 offset:2048
    ds_read_b128 v[64:67], v28 offset:4096
    ds_read_b128 v[68:71], v28 offset:6144
    ds_read_b128 v[72:75], v28 offset:8192
    s_waitcnt vmcnt(12)
    ds_read_b64_tr_b16 a[0:1], v21 offset:0
    ds_read_b64_tr_b16 a[2:3], v21 offset:2048
    ds_read_b64_tr_b16 a[4:5], v22 offset:0
    ds_read_b64_tr_b16 a[6:7], v22 offset:2048
    ds_read_b64_tr_b16 a[8:9], v23 offset:0
    ds_read_b64_tr_b16 a[10:11], v23 offset:2048
    ds_read_b64_tr_b16 a[12:13], v24 offset:0
    ds_read_b64_tr_b16 a[14:15], v24 offset:2048
    s_waitcnt lgkmcnt(6)
    v_mfma_f32_16x16x32_bf16 v[96:99], a[0:3], v[56:59], 0
    ds_read_b128 v[76:79], v29 offset:0
    v_mfma_f32_16x16x32_bf16 v[100:103], a[0:3], v[60:63], 0
    v_mfma_f32_16x16x32_bf16 v[104:107], a[0:3], v[64:67], 0
    ds_read_b128 v[80:83], v29 offset:2048
    v_mfma_f32_16x16x32_bf16 v[108:111], a[0:3], v[68:71], 0
    s_add_u32 m0, s98, 0
    v_mfma_f32_16x16x32_bf16 v[112:115], a[0:3], v[72:75], 0
    ds_read_b128 v[84:87], v29 offset:4096
    s_waitcnt lgkmcnt(7)
    v_mfma_f32_16x16x32_bf16 v[116:119], a[4:7], v[56:59], 0
    s_waitcnt lgkmcnt(3)
    buffer_load_dwordx4 v5, s[36:39], s60 offen  lds
    v_mfma_f32_16x16x32_bf16 v[120:123], a[4:7], v[60:63], 0
    ds_read_b128 v[88:91], v29 offset:6144
    buffer_load_dwordx4 v6, s[36:39], s60 offen offset:1024  lds
    v_mfma_f32_16x16x32_bf16 v[124:127], a[4:7], v[64:67], 0
    s_waitcnt vmcnt(10)
    ds_read_b64_tr_b16 a[16:17], v21 offset:4096
    v_mfma_f32_16x16x32_bf16 v[128:131], a[4:7], v[68:71], 0
    ds_read_b128 v[92:95], v29 offset:8192
    ds_read_b64_tr_b16 a[18:19], v21 offset:6144
    v_mfma_f32_16x16x32_bf16 v[132:135], a[4:7], v[72:75], 0
    ds_read_b64_tr_b16 a[20:21], v22 offset:4096
    ds_read_b64_tr_b16 a[22:23], v22 offset:6144
    v_mfma_f32_16x16x32_bf16 v[136:139], a[8:11], v[56:59], 0
    ds_read_b64_tr_b16 a[24:25], v23 offset:4096
    buffer_load_dwordx4 v7, s[36:39], s60 offen offset:2048  lds
    v_mfma_f32_16x16x32_bf16 v[140:143], a[8:11], v[60:63], 0
    ds_read_b64_tr_b16 a[26:27], v23 offset:6144
    buffer_load_dwordx4 v8, s[36:39], s60 offen offset:3072  lds
    v_mfma_f32_16x16x32_bf16 v[144:147], a[8:11], v[64:67], 0
    ds_read_b64_tr_b16 a[28:29], v24 offset:4096
    s_add_u32 m0, s99, 40960
    v_mfma_f32_16x16x32_bf16 v[148:151], a[8:11], v[68:71], 0
    ds_read_b64_tr_b16 a[30:31], v24 offset:6144
    buffer_load_dwordx4 v2, s[24:27], s52 offen lds
    v_mfma_f32_16x16x32_bf16 v[152:155], a[8:11], v[72:75], 0
    s_add_u32 m0, s99, 45056
    s_nop 0
    buffer_load_dwordx4 v3, s[24:27], s52 offen lds
    v_mfma_f32_16x16x32_bf16 v[156:159], a[12:15], v[56:59], 0
    s_add_u32 m0, s99, 51200
    v_mfma_f32_16x16x32_bf16 v[160:163], a[12:15], v[60:63], 0
    buffer_load_dwordx4 v2, s[24:27], s53 offen lds
    v_mfma_f32_16x16x32_bf16 v[164:167], a[12:15], v[64:67], 0
    s_add_u32 m0, s99, 55296
    v_mfma_f32_16x16x32_bf16 v[168:171], a[12:15], v[68:71], 0
    buffer_load_dwordx4 v3, s[24:27], s53 offen lds
    v_mfma_f32_16x16x32_bf16 v[172:175], a[12:15], v[72:75], 0
    s_add_u32 m0, s95, 59392
    s_waitcnt lgkmcnt(3)
    v_mfma_f32_16x16x32_bf16 v[96:99], a[16:19], v[76:79], v[96:99]
    ds_read_b128 v[56:59], v28 offset:10240
    buffer_load_dwordx4 v4, s[24:27], s94 offen lds
    v_mfma_f32_16x16x32_bf16 v[100:103], a[16:19], v[80:83], v[100:103]
    s_add_u32 m0, s99, 61440
    v_mfma_f32_16x16x32_bf16 v[104:107], a[16:19], v[84:87], v[104:107]
    ds_read_b128 v[60:63], v28 offset:12288
    buffer_load_dwordx4 v2, s[24:27], s54 offen lds
    v_mfma_f32_16x16x32_bf16 v[108:111], a[16:19], v[88:91], v[108:111]
    s_add_u32 m0, s99, 65536
    v_mfma_f32_16x16x32_bf16 v[112:115], a[16:19], v[92:95], v[112:115]
    ds_read_b128 v[64:67], v28 offset:14336
    buffer_load_dwordx4 v3, s[24:27], s54 offen lds
    v_mfma_f32_16x16x32_bf16 v[116:119], a[20:23], v[76:79], v[116:119]
    s_add_u32 m0, s97, 79872
    v_mfma_f32_16x16x32_bf16 v[120:123], a[20:23], v[80:83], v[120:123]
    ds_read_b128 v[68:71], v28 offset:16384
    buffer_load_dwordx4 v4, s[24:27], s54 offen lds
    v_mfma_f32_16x16x32_bf16 v[124:127], a[20:23], v[84:87], v[124:127]
    s_waitcnt vmcnt(16)
    ds_read_b64_tr_b16 a[0:1], v21 offset:8192
    v_mfma_f32_16x16x32_bf16 v[128:131], a[20:23], v[88:91], v[128:131]
    ds_read_b128 v[72:75], v28 offset:18432
    ds_read_b64_tr_b16 a[2:3], v21 offset:10240
    v_mfma_f32_16x16x32_bf16 v[132:135], a[20:23], v[92:95], v[132:135]
    ds_read_b64_tr_b16 a[4:5], v22 offset:8192
    ds_read_b64_tr_b16 a[6:7], v22 offset:10240
    s_waitcnt lgkmcnt(8)
    v_mfma_f32_16x16x32_bf16 v[136:139], a[24:27], v[76:79], v[136:139]
    ds_read_b64_tr_b16 a[8:9], v23 offset:8192
    s_add_u32 m0, s98, 4096
    v_mfma_f32_16x16x32_bf16 v[140:143], a[24:27], v[80:83], v[140:143]
    ds_read_b64_tr_b16 a[10:11], v23 offset:10240
    buffer_load_dwordx4 v5, s[36:39], s61 offen  lds
    v_mfma_f32_16x16x32_bf16 v[144:147], a[24:27], v[84:87], v[144:147]
    ds_read_b64_tr_b16 a[12:13], v24 offset:8192
    buffer_load_dwordx4 v6, s[36:39], s61 offen offset:1024  lds
    v_mfma_f32_16x16x32_bf16 v[148:151], a[24:27], v[88:91], v[148:151]
    ds_read_b64_tr_b16 a[14:15], v24 offset:10240
    v_mfma_f32_16x16x32_bf16 v[152:155], a[24:27], v[92:95], v[152:155]
    buffer_load_dwordx4 v7, s[36:39], s61 offen offset:2048  lds
    v_mfma_f32_16x16x32_bf16 v[156:159], a[28:31], v[76:79], v[156:159]
    v_mfma_f32_16x16x32_bf16 v[160:163], a[28:31], v[80:83], v[160:163]
    buffer_load_dwordx4 v8, s[36:39], s61 offen offset:3072  lds
    v_mfma_f32_16x16x32_bf16 v[164:167], a[28:31], v[84:87], v[164:167]
    v_mfma_f32_16x16x32_bf16 v[168:171], a[28:31], v[88:91], v[168:171]
    v_mfma_f32_16x16x32_bf16 v[172:175], a[28:31], v[92:95], v[172:175]
    s_add_u32 m0, s98, 8192
    s_waitcnt lgkmcnt(4)
    v_mfma_f32_16x16x32_bf16 v[96:99], a[0:3], v[56:59], v[96:99]
    ds_read_b128 v[76:79], v29 offset:10240
    v_mfma_f32_16x16x32_bf16 v[100:103], a[0:3], v[60:63], v[100:103]
    v_mfma_f32_16x16x32_bf16 v[104:107], a[0:3], v[64:67], v[104:107]
    ds_read_b128 v[80:83], v29 offset:12288
    v_mfma_f32_16x16x32_bf16 v[108:111], a[0:3], v[68:71], v[108:111]
    s_waitcnt lgkmcnt(2)
    buffer_load_dwordx4 v5, s[36:39], s62 offen  lds
    v_mfma_f32_16x16x32_bf16 v[112:115], a[0:3], v[72:75], v[112:115]
    ds_read_b128 v[84:87], v29 offset:14336
    v_mfma_f32_16x16x32_bf16 v[116:119], a[4:7], v[56:59], v[116:119]
    v_mfma_f32_16x16x32_bf16 v[120:123], a[4:7], v[60:63], v[120:123]
    ds_read_b128 v[88:91], v29 offset:16384
    v_mfma_f32_16x16x32_bf16 v[124:127], a[4:7], v[64:67], v[124:127]
    s_waitcnt vmcnt(17)
    ds_read_b64_tr_b16 a[16:17], v21 offset:12288
    v_mfma_f32_16x16x32_bf16 v[128:131], a[4:7], v[68:71], v[128:131]
    ds_read_b128 v[92:95], v29 offset:18432
    ds_read_b64_tr_b16 a[18:19], v21 offset:14336
    v_mfma_f32_16x16x32_bf16 v[132:135], a[4:7], v[72:75], v[132:135]
    ds_read_b64_tr_b16 a[20:21], v22 offset:12288
    ds_read_b64_tr_b16 a[22:23], v22 offset:14336
    v_mfma_f32_16x16x32_bf16 v[136:139], a[8:11], v[56:59], v[136:139]
    ds_read_b64_tr_b16 a[24:25], v23 offset:12288
    buffer_load_dwordx4 v6, s[36:39], s62 offen offset:1024  lds
    v_mfma_f32_16x16x32_bf16 v[140:143], a[8:11], v[60:63], v[140:143]
    ds_read_b64_tr_b16 a[26:27], v23 offset:14336
    buffer_load_dwordx4 v7, s[36:39], s62 offen offset:2048  lds
    v_mfma_f32_16x16x32_bf16 v[144:147], a[8:11], v[64:67], v[144:147]
    ds_read_b64_tr_b16 a[28:29], v24 offset:12288
    v_mfma_f32_16x16x32_bf16 v[148:151], a[8:11], v[68:71], v[148:151]
    ds_read_b64_tr_b16 a[30:31], v24 offset:14336
    v_mfma_f32_16x16x32_bf16 v[152:155], a[8:11], v[72:75], v[152:155]
    v_mfma_f32_16x16x32_bf16 v[156:159], a[12:15], v[56:59], v[156:159]
    buffer_load_dwordx4 v8, s[36:39], s62 offen offset:3072  lds
    v_mfma_f32_16x16x32_bf16 v[160:163], a[12:15], v[60:63], v[160:163]
    v_mfma_f32_16x16x32_bf16 v[164:167], a[12:15], v[64:67], v[164:167]
    s_waitcnt vmcnt(16)
    ds_read_b64_tr_b16 a[32:33], v21 offset:0
    v_mfma_f32_16x16x32_bf16 v[168:171], a[12:15], v[68:71], v[168:171]
    ds_read_b64_tr_b16 a[34:35], v21 offset:2048
    v_mfma_f32_16x16x32_bf16 v[172:175], a[12:15], v[72:75], v[172:175]
    ds_read_b64_tr_b16 a[36:37], v22 offset:0
    s_add_u32 m0, s98, 12288
    s_waitcnt lgkmcnt(6)
    v_mfma_f32_16x16x32_bf16 v[96:99], a[16:19], v[76:79], v[96:99]
    ds_read_b128 v[56:59], v28 offset:20480
    ds_read_b64_tr_b16 a[38:39], v22 offset:2048
    v_mfma_f32_16x16x32_bf16 v[100:103], a[16:19], v[80:83], v[100:103]
    ds_read_b64_tr_b16 a[40:41], v23 offset:0
    s_waitcnt lgkmcnt(6)
    buffer_load_dwordx4 v5, s[36:39], s63 offen  lds
    v_mfma_f32_16x16x32_bf16 v[104:107], a[16:19], v[84:87], v[104:107]
    ds_read_b128 v[60:63], v28 offset:22528
    ds_read_b64_tr_b16 a[42:43], v23 offset:2048
    v_mfma_f32_16x16x32_bf16 v[108:111], a[16:19], v[88:91], v[108:111]
    ds_read_b64_tr_b16 a[44:45], v24 offset:0
    buffer_load_dwordx4 v6, s[36:39], s63 offen offset:1024  lds
    v_mfma_f32_16x16x32_bf16 v[112:115], a[16:19], v[92:95], v[112:115]
    ds_read_b128 v[64:67], v28 offset:24576
    ds_read_b64_tr_b16 a[46:47], v24 offset:2048
    v_mfma_f32_16x16x32_bf16 v[116:119], a[20:23], v[76:79], v[116:119]
    buffer_load_dwordx4 v7, s[36:39], s63 offen offset:2048  lds
    v_mfma_f32_16x16x32_bf16 v[120:123], a[20:23], v[80:83], v[120:123]
    ds_read_b128 v[68:71], v28 offset:26624
    v_mfma_f32_16x16x32_bf16 v[124:127], a[20:23], v[84:87], v[124:127]
    buffer_load_dwordx4 v8, s[36:39], s63 offen offset:3072  lds
    v_mfma_f32_16x16x32_bf16 v[128:131], a[20:23], v[88:91], v[128:131]
    ds_read_b128 v[72:75], v28 offset:28672
    v_mfma_f32_16x16x32_bf16 v[132:135], a[20:23], v[92:95], v[132:135]
    s_waitcnt vmcnt(8)
    ds_read_b64_tr_b16 a[0:1], v21 offset:4096
    v_mfma_f32_16x16x32_bf16 v[136:139], a[24:27], v[76:79], v[136:139]
    ds_read_b64_tr_b16 a[2:3], v21 offset:6144
    ds_read_b64_tr_b16 a[4:5], v22 offset:4096
    v_mfma_f32_16x16x32_bf16 v[140:143], a[24:27], v[80:83], v[140:143]
    ds_read_b64_tr_b16 a[6:7], v22 offset:6144
    s_add_u32 m0, s98, 0
    v_mfma_f32_16x16x32_bf16 v[144:147], a[24:27], v[84:87], v[144:147]
    ds_read_b64_tr_b16 a[8:9], v23 offset:4096
    s_waitcnt lgkmcnt(7)
    buffer_load_dwordx4 v5, s[36:39], s64 offen  lds
    v_mfma_f32_16x16x32_bf16 v[148:151], a[24:27], v[88:91], v[148:151]
    ds_read_b64_tr_b16 a[10:11], v23 offset:6144
    v_mfma_f32_16x16x32_bf16 v[152:155], a[24:27], v[92:95], v[152:155]
    ds_read_b64_tr_b16 a[12:13], v24 offset:4096
    buffer_load_dwordx4 v6, s[36:39], s64 offen offset:1024  lds
    v_mfma_f32_16x16x32_bf16 v[156:159], a[28:31], v[76:79], v[156:159]
    ds_read_b64_tr_b16 a[14:15], v24 offset:6144
    v_mfma_f32_16x16x32_bf16 v[160:163], a[28:31], v[80:83], v[160:163]
    buffer_load_dwordx4 v7, s[36:39], s64 offen offset:2048  lds
    v_mfma_f32_16x16x32_bf16 v[164:167], a[28:31], v[84:87], v[164:167]
    v_mfma_f32_16x16x32_bf16 v[168:171], a[28:31], v[88:91], v[168:171]
    buffer_load_dwordx4 v8, s[36:39], s64 offen offset:3072  lds
    v_mfma_f32_16x16x32_bf16 v[172:175], a[28:31], v[92:95], v[172:175]
    s_waitcnt vmcnt(8)
    ds_read_b64_tr_b16 a[16:17], v21 offset:8192
    v_mfma_f32_16x16x32_bf16 v[96:99], a[32:35], v[56:59], v[96:99]
    ds_read_b128 v[76:79], v29 offset:20480
    ds_read_b64_tr_b16 a[18:19], v21 offset:10240
    v_mfma_f32_16x16x32_bf16 v[100:103], a[32:35], v[60:63], v[100:103]
    ds_read_b64_tr_b16 a[20:21], v22 offset:8192
    s_add_u32 m0, s98, 4096
    v_mfma_f32_16x16x32_bf16 v[104:107], a[32:35], v[64:67], v[104:107]
    ds_read_b128 v[80:83], v29 offset:22528
    ds_read_b64_tr_b16 a[22:23], v22 offset:10240
    s_waitcnt lgkmcnt(8)
    v_mfma_f32_16x16x32_bf16 v[108:111], a[32:35], v[68:71], v[108:111]
    ds_read_b64_tr_b16 a[24:25], v23 offset:8192
    s_waitcnt lgkmcnt(7)
    buffer_load_dwordx4 v5, s[36:39], s65 offen  lds
    v_mfma_f32_16x16x32_bf16 v[112:115], a[32:35], v[72:75], v[112:115]
    ds_read_b128 v[84:87], v29 offset:24576
    ds_read_b64_tr_b16 a[26:27], v23 offset:10240
    v_mfma_f32_16x16x32_bf16 v[116:119], a[36:39], v[56:59], v[116:119]
    ds_read_b64_tr_b16 a[28:29], v24 offset:8192
    buffer_load_dwordx4 v6, s[36:39], s65 offen offset:1024  lds
    v_mfma_f32_16x16x32_bf16 v[120:123], a[36:39], v[60:63], v[120:123]
    ds_read_b128 v[88:91], v29 offset:26624
    ds_read_b64_tr_b16 a[30:31], v24 offset:10240
    v_mfma_f32_16x16x32_bf16 v[124:127], a[36:39], v[64:67], v[124:127]
    buffer_load_dwordx4 v7, s[36:39], s65 offen offset:2048  lds
    v_mfma_f32_16x16x32_bf16 v[128:131], a[36:39], v[68:71], v[128:131]
    ds_read_b128 v[92:95], v29 offset:28672
    v_mfma_f32_16x16x32_bf16 v[132:135], a[36:39], v[72:75], v[132:135]
    buffer_load_dwordx4 v8, s[36:39], s65 offen offset:3072  lds
    v_mfma_f32_16x16x32_bf16 v[136:139], a[40:43], v[56:59], v[136:139]
    s_waitcnt vmcnt(8)
    ds_read_b64_tr_b16 a[48:49], v21 offset:12288
    v_mfma_f32_16x16x32_bf16 v[140:143], a[40:43], v[60:63], v[140:143]
    ds_read_b64_tr_b16 a[50:51], v21 offset:14336
    v_mfma_f32_16x16x32_bf16 v[144:147], a[40:43], v[64:67], v[144:147]
    ds_read_b64_tr_b16 a[52:53], v22 offset:12288
    s_add_u32 m0, s98, 8192
    v_mfma_f32_16x16x32_bf16 v[148:151], a[40:43], v[68:71], v[148:151]
    ds_read_b64_tr_b16 a[54:55], v22 offset:14336
    v_mfma_f32_16x16x32_bf16 v[152:155], a[40:43], v[72:75], v[152:155]
    ds_read_b64_tr_b16 a[56:57], v23 offset:12288
    s_waitcnt lgkmcnt(6)
    buffer_load_dwordx4 v5, s[36:39], s66 offen  lds
    v_mfma_f32_16x16x32_bf16 v[156:159], a[44:47], v[56:59], v[156:159]
    ds_read_b64_tr_b16 a[58:59], v23 offset:14336
    v_mfma_f32_16x16x32_bf16 v[160:163], a[44:47], v[60:63], v[160:163]
    ds_read_b64_tr_b16 a[60:61], v24 offset:12288
    buffer_load_dwordx4 v6, s[36:39], s66 offen offset:1024  lds
    v_mfma_f32_16x16x32_bf16 v[164:167], a[44:47], v[64:67], v[164:167]
    ds_read_b64_tr_b16 a[62:63], v24 offset:14336
    v_mfma_f32_16x16x32_bf16 v[168:171], a[44:47], v[68:71], v[168:171]
    buffer_load_dwordx4 v7, s[36:39], s66 offen offset:2048  lds
    v_mfma_f32_16x16x32_bf16 v[172:175], a[44:47], v[72:75], v[172:175]
    v_mfma_f32_16x16x32_bf16 v[96:99], a[0:3], v[76:79], v[96:99]
    ds_read_b128 v[56:59], v28 offset:30720
    buffer_load_dwordx4 v8, s[36:39], s66 offen offset:3072  lds
    v_mfma_f32_16x16x32_bf16 v[100:103], a[0:3], v[80:83], v[100:103]
    s_waitcnt vmcnt(8)
    ds_read_b64_tr_b16 a[32:33], v21 offset:0
    v_mfma_f32_16x16x32_bf16 v[104:107], a[0:3], v[84:87], v[104:107]
    ds_read_b128 v[60:63], v28 offset:32768
    ds_read_b64_tr_b16 a[34:35], v21 offset:2048
    v_mfma_f32_16x16x32_bf16 v[108:111], a[0:3], v[88:91], v[108:111]
    ds_read_b64_tr_b16 a[36:37], v22 offset:0
    s_add_u32 m0, s98, 12288
    s_waitcnt lgkmcnt(8)
    v_mfma_f32_16x16x32_bf16 v[112:115], a[0:3], v[92:95], v[112:115]
    ds_read_b128 v[64:67], v28 offset:34816
    ds_read_b64_tr_b16 a[38:39], v22 offset:2048
    v_mfma_f32_16x16x32_bf16 v[116:119], a[4:7], v[76:79], v[116:119]
    ds_read_b64_tr_b16 a[40:41], v23 offset:0
    s_waitcnt lgkmcnt(8)
    buffer_load_dwordx4 v5, s[36:39], s67 offen  lds
    v_mfma_f32_16x16x32_bf16 v[120:123], a[4:7], v[80:83], v[120:123]
    ds_read_b128 v[68:71], v28 offset:36864
    ds_read_b64_tr_b16 a[42:43], v23 offset:2048
    v_mfma_f32_16x16x32_bf16 v[124:127], a[4:7], v[84:87], v[124:127]
    ds_read_b64_tr_b16 a[44:45], v24 offset:0
    buffer_load_dwordx4 v6, s[36:39], s67 offen offset:1024  lds
    v_mfma_f32_16x16x32_bf16 v[128:131], a[4:7], v[88:91], v[128:131]
    ds_read_b128 v[72:75], v28 offset:38912
    ds_read_b64_tr_b16 a[46:47], v24 offset:2048
    v_mfma_f32_16x16x32_bf16 v[132:135], a[4:7], v[92:95], v[132:135]
    buffer_load_dwordx4 v7, s[36:39], s67 offen offset:2048  lds
    v_mfma_f32_16x16x32_bf16 v[136:139], a[8:11], v[76:79], v[136:139]
    v_mfma_f32_16x16x32_bf16 v[140:143], a[8:11], v[80:83], v[140:143]
    buffer_load_dwordx4 v8, s[36:39], s67 offen offset:3072  lds
    v_mfma_f32_16x16x32_bf16 v[144:147], a[8:11], v[84:87], v[144:147]
    s_waitcnt vmcnt(8)
    ds_read_b64_tr_b16 a[64:65], v21 offset:4096
    v_mfma_f32_16x16x32_bf16 v[148:151], a[8:11], v[88:91], v[148:151]
    ds_read_b64_tr_b16 a[66:67], v21 offset:6144
    v_mfma_f32_16x16x32_bf16 v[152:155], a[8:11], v[92:95], v[152:155]
    ds_read_b64_tr_b16 a[68:69], v22 offset:4096
    s_add_u32 m0, s98, 0
    v_mfma_f32_16x16x32_bf16 v[156:159], a[12:15], v[76:79], v[156:159]
    ds_read_b64_tr_b16 a[70:71], v22 offset:6144
    v_mfma_f32_16x16x32_bf16 v[160:163], a[12:15], v[80:83], v[160:163]
    ds_read_b64_tr_b16 a[72:73], v23 offset:4096
    s_waitcnt lgkmcnt(5)
    buffer_load_dwordx4 v5, s[36:39], s68 offen  lds
    v_mfma_f32_16x16x32_bf16 v[164:167], a[12:15], v[84:87], v[164:167]
    ds_read_b64_tr_b16 a[74:75], v23 offset:6144
    v_mfma_f32_16x16x32_bf16 v[168:171], a[12:15], v[88:91], v[168:171]
    ds_read_b64_tr_b16 a[76:77], v24 offset:4096
    buffer_load_dwordx4 v6, s[36:39], s68 offen offset:1024  lds
    v_mfma_f32_16x16x32_bf16 v[172:175], a[12:15], v[92:95], v[172:175]
    ds_read_b64_tr_b16 a[78:79], v24 offset:6144
    v_mfma_f32_16x16x32_bf16 v[96:99], a[16:19], v[56:59], v[96:99]
    ds_read_b128 v[76:79], v29 offset:30720
    buffer_load_dwordx4 v7, s[36:39], s68 offen offset:2048  lds
    v_mfma_f32_16x16x32_bf16 v[100:103], a[16:19], v[60:63], v[100:103]
    v_mfma_f32_16x16x32_bf16 v[104:107], a[16:19], v[64:67], v[104:107]
    ds_read_b128 v[80:83], v29 offset:32768
    buffer_load_dwordx4 v8, s[36:39], s68 offen offset:3072  lds
    v_mfma_f32_16x16x32_bf16 v[108:111], a[16:19], v[68:71], v[108:111]
    s_waitcnt vmcnt(8)
    ds_read_b64_tr_b16 a[0:1], v21 offset:8192
    v_mfma_f32_16x16x32_bf16 v[112:115], a[16:19], v[72:75], v[112:115]
    ds_read_b128 v[84:87], v29 offset:34816
    ds_read_b64_tr_b16 a[2:3], v21 offset:10240
    v_mfma_f32_16x16x32_bf16 v[116:119], a[20:23], v[56:59], v[116:119]
    ds_read_b64_tr_b16 a[4:5], v22 offset:8192
    s_add_u32 m0, s98, 4096
    v_mfma_f32_16x16x32_bf16 v[120:123], a[20:23], v[60:63], v[120:123]
    ds_read_b128 v[88:91], v29 offset:36864
    ds_read_b64_tr_b16 a[6:7], v22 offset:10240
    v_mfma_f32_16x16x32_bf16 v[124:127], a[20:23], v[64:67], v[124:127]
    ds_read_b64_tr_b16 a[8:9], v23 offset:8192
    s_waitcnt lgkmcnt(9)
    buffer_load_dwordx4 v5, s[36:39], s69 offen  lds
    v_mfma_f32_16x16x32_bf16 v[128:131], a[20:23], v[68:71], v[128:131]
    ds_read_b128 v[92:95], v29 offset:38912
    ds_read_b64_tr_b16 a[10:11], v23 offset:10240
    v_mfma_f32_16x16x32_bf16 v[132:135], a[20:23], v[72:75], v[132:135]
    ds_read_b64_tr_b16 a[12:13], v24 offset:8192
    buffer_load_dwordx4 v6, s[36:39], s69 offen offset:1024  lds
    v_mfma_f32_16x16x32_bf16 v[136:139], a[24:27], v[56:59], v[136:139]
    ds_read_b64_tr_b16 a[14:15], v24 offset:10240
    v_mfma_f32_16x16x32_bf16 v[140:143], a[24:27], v[60:63], v[140:143]
    buffer_load_dwordx4 v7, s[36:39], s69 offen offset:2048  lds
    v_mfma_f32_16x16x32_bf16 v[144:147], a[24:27], v[64:67], v[144:147]
    v_mfma_f32_16x16x32_bf16 v[148:151], a[24:27], v[68:71], v[148:151]
    buffer_load_dwordx4 v8, s[36:39], s69 offen offset:3072  lds
    v_mfma_f32_16x16x32_bf16 v[152:155], a[24:27], v[72:75], v[152:155]
    s_waitcnt vmcnt(8)
    ds_read_b64_tr_b16 a[80:81], v21 offset:12288
    v_mfma_f32_16x16x32_bf16 v[156:159], a[28:31], v[56:59], v[156:159]
    ds_read_b64_tr_b16 a[82:83], v21 offset:14336
    v_mfma_f32_16x16x32_bf16 v[160:163], a[28:31], v[60:63], v[160:163]
    ds_read_b64_tr_b16 a[84:85], v22 offset:12288
    s_add_u32 m0, s98, 8192
    s_xor_b32 s91, s18, 0
    v_mfma_f32_16x16x32_bf16 v[164:167], a[28:31], v[64:67], v[164:167]
    ds_read_b64_tr_b16 a[86:87], v22 offset:14336
    v_mfma_f32_16x16x32_bf16 v[168:171], a[28:31], v[68:71], v[168:171]
    s_waitcnt lgkmcnt(4)
    buffer_load_dwordx4 v9, s[28:31], s91 offen  lds
    v_add_u32 v28, 40960, v28
    v_add_u32 v29, 40960, v29
    v_mfma_f32_16x16x32_bf16 v[172:175], a[28:31], v[72:75], v[172:175]
    s_barrier
    v_mfma_f32_16x16x32_bf16 v[96:99], a[48:51], v[76:79], v[96:99]
    ds_read_b128 v[56:59], v28 offset:0
    ds_read_b64_tr_b16 a[88:89], v23 offset:12288
    v_mfma_f32_16x16x32_bf16 v[100:103], a[48:51], v[80:83], v[100:103]
    ds_read_b64_tr_b16 a[90:91], v23 offset:14336
    ds_read_b64_tr_b16 a[92:93], v24 offset:12288
    v_mfma_f32_16x16x32_bf16 v[104:107], a[48:51], v[84:87], v[104:107]
    ds_read_b128 v[60:63], v28 offset:2048
    ds_read_b64_tr_b16 a[94:95], v24 offset:14336
    v_mfma_f32_16x16x32_bf16 v[108:111], a[48:51], v[88:91], v[108:111]
    buffer_load_dwordx4 v10, s[28:31], s91 offen offset:1024  lds
    buffer_load_dwordx4 v11, s[28:31], s91 offen offset:2048  lds
    v_mfma_f32_16x16x32_bf16 v[112:115], a[48:51], v[92:95], v[112:115]
    ds_read_b128 v[64:67], v28 offset:4096
    v_mfma_f32_16x16x32_bf16 v[116:119], a[52:55], v[76:79], v[116:119]
    s_waitcnt vmcnt(7)
    ds_read_b64_tr_b16 a[16:17], v21 offset:0
    v_mfma_f32_16x16x32_bf16 v[120:123], a[52:55], v[80:83], v[120:123]
    ds_read_b128 v[68:71], v28 offset:6144
    ds_read_b64_tr_b16 a[18:19], v21 offset:2048
    v_mfma_f32_16x16x32_bf16 v[124:127], a[52:55], v[84:87], v[124:127]
    ds_read_b64_tr_b16 a[20:21], v22 offset:0
    buffer_load_dwordx4 v12, s[28:31], s91 offen offset:3072  lds
    v_mfma_f32_16x16x32_bf16 v[128:131], a[52:55], v[88:91], v[128:131]
    ds_read_b128 v[72:75], v28 offset:8192
    ds_read_b64_tr_b16 a[22:23], v22 offset:2048
    v_mfma_f32_16x16x32_bf16 v[132:135], a[52:55], v[92:95], v[132:135]
    ds_read_b64_tr_b16 a[24:25], v23 offset:0
    s_add_u32 m0, s98, 12288
    s_xor_b32 s91, s18, 256
    v_mfma_f32_16x16x32_bf16 v[136:139], a[56:59], v[76:79], v[136:139]
    ds_read_b64_tr_b16 a[26:27], v23 offset:2048
    v_mfma_f32_16x16x32_bf16 v[140:143], a[56:59], v[80:83], v[140:143]
    ds_read_b64_tr_b16 a[28:29], v24 offset:0
    v_mfma_f32_16x16x32_bf16 v[144:147], a[56:59], v[84:87], v[144:147]
    ds_read_b64_tr_b16 a[30:31], v24 offset:2048
    v_mfma_f32_16x16x32_bf16 v[148:151], a[56:59], v[88:91], v[148:151]
    s_waitcnt lgkmcnt(10)
    buffer_load_dwordx4 v9, s[28:31], s91 offen  lds
    v_mfma_f32_16x16x32_bf16 v[152:155], a[56:59], v[92:95], v[152:155]
    buffer_load_dwordx4 v10, s[28:31], s91 offen offset:1024  lds
    buffer_load_dwordx4 v11, s[28:31], s91 offen offset:2048  lds
    v_mfma_f32_16x16x32_bf16 v[156:159], a[60:63], v[76:79], v[156:159]
    v_mfma_f32_16x16x32_bf16 v[160:163], a[60:63], v[80:83], v[160:163]
    s_waitcnt vmcnt(7)
    ds_read_b64_tr_b16 a[96:97], v21 offset:4096
    v_mfma_f32_16x16x32_bf16 v[164:167], a[60:63], v[84:87], v[164:167]
    ds_read_b64_tr_b16 a[98:99], v21 offset:6144
    buffer_load_dwordx4 v12, s[28:31], s91 offen offset:3072  lds
    v_mfma_f32_16x16x32_bf16 v[168:171], a[60:63], v[88:91], v[168:171]
    ds_read_b64_tr_b16 a[100:101], v22 offset:4096
    s_add_u32 m0, s98, 0
    s_xor_b32 s91, s18, 8192
    v_mfma_f32_16x16x32_bf16 v[172:175], a[60:63], v[92:95], v[172:175]
    ds_read_b64_tr_b16 a[102:103], v22 offset:6144
    v_mfma_f32_16x16x32_bf16 v[96:99], a[32:35], v[56:59], v[96:99]
    ds_read_b128 v[76:79], v29 offset:0
    ds_read_b64_tr_b16 a[104:105], v23 offset:4096
    v_mfma_f32_16x16x32_bf16 v[100:103], a[32:35], v[60:63], v[100:103]
    ds_read_b64_tr_b16 a[106:107], v23 offset:6144
    s_waitcnt lgkmcnt(7)
    buffer_load_dwordx4 v9, s[28:31], s91 offen  lds
    v_mfma_f32_16x16x32_bf16 v[104:107], a[32:35], v[64:67], v[104:107]
    ds_read_b128 v[80:83], v29 offset:2048
    ds_read_b64_tr_b16 a[108:109], v24 offset:4096
    v_mfma_f32_16x16x32_bf16 v[108:111], a[32:35], v[68:71], v[108:111]
    ds_read_b64_tr_b16 a[110:111], v24 offset:6144
    buffer_load_dwordx4 v10, s[28:31], s91 offen offset:1024  lds
    v_mfma_f32_16x16x32_bf16 v[112:115], a[32:35], v[72:75], v[112:115]
    ds_read_b128 v[84:87], v29 offset:4096
    buffer_load_dwordx4 v11, s[28:31], s91 offen offset:2048  lds
    v_mfma_f32_16x16x32_bf16 v[116:119], a[36:39], v[56:59], v[116:119]
    v_mfma_f32_16x16x32_bf16 v[120:123], a[36:39], v[60:63], v[120:123]
    ds_read_b128 v[88:91], v29 offset:6144
    buffer_load_dwordx4 v12, s[28:31], s91 offen offset:3072  lds
    v_mfma_f32_16x16x32_bf16 v[124:127], a[36:39], v[64:67], v[124:127]
    v_mfma_f32_16x16x32_bf16 v[128:131], a[36:39], v[68:71], v[128:131]
    ds_read_b128 v[92:95], v29 offset:8192
    v_mfma_f32_16x16x32_bf16 v[132:135], a[36:39], v[72:75], v[132:135]
    s_add_u32 m0, s98, 4096
    s_xor_b32 s91, s18, 8448
    v_mfma_f32_16x16x32_bf16 v[136:139], a[40:43], v[56:59], v[136:139]
    v_mfma_f32_16x16x32_bf16 v[140:143], a[40:43], v[60:63], v[140:143]
    s_waitcnt lgkmcnt(3)
    buffer_load_dwordx4 v9, s[28:31], s91 offen  lds
    v_mfma_f32_16x16x32_bf16 v[144:147], a[40:43], v[64:67], v[144:147]
    v_mfma_f32_16x16x32_bf16 v[148:151], a[40:43], v[68:71], v[148:151]
    v_mfma_f32_16x16x32_bf16 v[152:155], a[40:43], v[72:75], v[152:155]
    s_waitcnt vmcnt(9)
    ds_read_b128 a[240:243], v30 offset:8192
    v_mfma_f32_16x16x32_bf16 v[156:159], a[44:47], v[56:59], v[156:159]
    ds_read_b128 a[244:247], v31 offset:8192
    buffer_load_dwordx4 v10, s[28:31], s91 offen offset:1024  lds
    v_mfma_f32_16x16x32_bf16 v[160:163], a[44:47], v[60:63], v[160:163]
    ds_read_b128 a[248:251], v30 offset:10240
    v_mfma_f32_16x16x32_bf16 v[164:167], a[44:47], v[64:67], v[164:167]
    ds_read_b128 a[252:255], v31 offset:10240
    buffer_load_dwordx4 v11, s[28:31], s91 offen offset:2048  lds
    v_mfma_f32_16x16x32_bf16 v[168:171], a[44:47], v[68:71], v[168:171]
    v_mfma_f32_16x16x32_bf16 v[172:175], a[44:47], v[72:75], v[172:175]
    v_mfma_f32_16x16x32_bf16 v[96:99], a[64:67], v[76:79], v[96:99]
    ds_read_b128 v[56:59], v28 offset:10240
    buffer_load_dwordx4 v12, s[28:31], s91 offen offset:3072  lds
    v_mfma_f32_16x16x32_bf16 v[100:103], a[64:67], v[80:83], v[100:103]
    s_waitcnt lgkmcnt(5)
    v_mfma_f32_16x16x32_bf16 v[104:107], a[64:67], v[84:87], v[104:107]
    ds_read_b128 v[60:63], v28 offset:12288
    v_mfma_f32_16x16x32_bf16 v[108:111], a[64:67], v[88:91], v[108:111]
    s_add_u32 m0, s98, 8192
    s_xor_b32 s91, s18, 65536
    v_mfma_f32_16x16x32_bf16 v[112:115], a[64:67], v[92:95], v[112:115]
    ds_read_b128 v[64:67], v28 offset:14336
    v_mfma_f32_16x16x32_bf16 v[116:119], a[68:71], v[76:79], v[116:119]
    v_mfma_f32_16x16x32_bf16 v[120:123], a[68:71], v[80:83], v[120:123]
    ds_read_b128 v[68:71], v28 offset:16384
    v_mfma_f32_16x16x32_bf16 v[124:127], a[68:71], v[84:87], v[124:127]
    s_waitcnt lgkmcnt(4)
    buffer_load_dwordx4 v9, s[28:31], s91 offen  lds
    v_mfma_f32_16x16x32_bf16 v[128:131], a[68:71], v[88:91], v[128:131]
    ds_read_b128 v[72:75], v28 offset:18432
    v_mfma_f32_16x16x32_bf16 v[132:135], a[68:71], v[92:95], v[132:135]
    v_mfma_f32_16x16x32_bf16 v[136:139], a[72:75], v[76:79], v[136:139]
    v_mfma_f32_16x16x32_bf16 v[140:143], a[72:75], v[80:83], v[140:143]
    v_mfma_f32_16x16x32_bf16 v[144:147], a[72:75], v[84:87], v[144:147]
    buffer_load_dwordx4 v10, s[28:31], s91 offen offset:1024  lds
    v_mfma_f32_16x16x32_bf16 v[148:151], a[72:75], v[88:91], v[148:151]
    v_mfma_f32_16x16x32_bf16 v[152:155], a[72:75], v[92:95], v[152:155]
    v_mfma_f32_16x16x32_bf16 v[156:159], a[76:79], v[76:79], v[156:159]
    v_mfma_f32_16x16x32_bf16 v[160:163], a[76:79], v[80:83], v[160:163]
    v_mfma_f32_16x16x32_bf16 v[164:167], a[76:79], v[84:87], v[164:167]
    buffer_load_dwordx4 v11, s[28:31], s91 offen offset:2048  lds
    v_mfma_f32_16x16x32_bf16 v[168:171], a[76:79], v[88:91], v[168:171]
    s_waitcnt vmcnt(11)
    ds_read_b128 a[224:227], v30 offset:12288
    v_mfma_f32_16x16x32_bf16 v[172:175], a[76:79], v[92:95], v[172:175]
    ds_read_b128 a[228:231], v31 offset:12288
    s_waitcnt lgkmcnt(2)
    v_mfma_f32_16x16x32_bf16 v[96:99], a[0:3], v[56:59], v[96:99]
    ds_read_b128 v[76:79], v29 offset:10240
    ds_read_b128 a[232:235], v30 offset:14336
    v_mfma_f32_16x16x32_bf16 v[100:103], a[0:3], v[60:63], v[100:103]
    ds_read_b128 a[236:239], v31 offset:14336
    v_mfma_f32_16x16x32_bf16 v[104:107], a[0:3], v[64:67], v[104:107]
    ds_read_b128 v[80:83], v29 offset:12288
    buffer_load_dwordx4 v12, s[28:31], s91 offen offset:3072  lds
    v_mfma_f32_16x16x32_bf16 v[108:111], a[0:3], v[68:71], v[108:111]
    v_mfma_f32_16x16x32_bf16 v[112:115], a[0:3], v[72:75], v[112:115]
    ds_read_b128 v[84:87], v29 offset:14336
    v_mfma_f32_16x16x32_bf16 v[116:119], a[4:7], v[56:59], v[116:119]
    v_mfma_f32_16x16x32_bf16 v[120:123], a[4:7], v[60:63], v[120:123]
    ds_read_b128 v[88:91], v29 offset:16384
    v_mfma_f32_16x16x32_bf16 v[124:127], a[4:7], v[64:67], v[124:127]
    s_add_u32 m0, s98, 12288
    s_xor_b32 s91, s18, 65792
    v_mfma_f32_16x16x32_bf16 v[128:131], a[4:7], v[68:71], v[128:131]
    ds_read_b128 v[92:95], v29 offset:18432
    v_mfma_f32_16x16x32_bf16 v[132:135], a[4:7], v[72:75], v[132:135]
    v_mfma_f32_16x16x32_bf16 v[136:139], a[8:11], v[56:59], v[136:139]
    v_mfma_f32_16x16x32_bf16 v[140:143], a[8:11], v[60:63], v[140:143]
    v_mfma_f32_16x16x32_bf16 v[144:147], a[8:11], v[64:67], v[144:147]
    s_waitcnt lgkmcnt(3)
    buffer_load_dwordx4 v9, s[28:31], s91 offen  lds
    v_mfma_f32_16x16x32_bf16 v[148:151], a[8:11], v[68:71], v[148:151]
    v_mfma_f32_16x16x32_bf16 v[152:155], a[8:11], v[72:75], v[152:155]
    v_mfma_f32_16x16x32_bf16 v[156:159], a[12:15], v[56:59], v[156:159]
    v_mfma_f32_16x16x32_bf16 v[160:163], a[12:15], v[60:63], v[160:163]
    v_mfma_f32_16x16x32_bf16 v[164:167], a[12:15], v[64:67], v[164:167]
    buffer_load_dwordx4 v10, s[28:31], s91 offen offset:1024  lds
    v_mfma_f32_16x16x32_bf16 v[168:171], a[12:15], v[68:71], v[168:171]
    v_mfma_f32_16x16x32_bf16 v[172:175], a[12:15], v[72:75], v[172:175]
    v_mfma_f32_16x16x32_bf16 v[96:99], a[80:83], v[76:79], v[96:99]
    ds_read_b128 v[56:59], v28 offset:20480
    v_mfma_f32_16x16x32_bf16 v[100:103], a[80:83], v[80:83], v[100:103]
    s_waitcnt lgkmcnt(1)
    v_mfma_f32_16x16x32_bf16 v[104:107], a[80:83], v[84:87], v[104:107]
    ds_read_b128 v[60:63], v28 offset:22528
    buffer_load_dwordx4 v11, s[28:31], s91 offen offset:2048  lds
    v_mfma_f32_16x16x32_bf16 v[108:111], a[80:83], v[88:91], v[108:111]
    s_waitcnt vmcnt(11)
    ds_read_b128 a[208:211], v30 offset:0
    v_mfma_f32_16x16x32_bf16 v[112:115], a[80:83], v[92:95], v[112:115]
    ds_read_b128 v[64:67], v28 offset:24576
    ds_read_b128 a[212:215], v31 offset:0
    v_mfma_f32_16x16x32_bf16 v[116:119], a[84:87], v[76:79], v[116:119]
    ds_read_b128 a[216:219], v30 offset:2048
    v_mfma_f32_16x16x32_bf16 v[120:123], a[84:87], v[80:83], v[120:123]
    ds_read_b128 v[68:71], v28 offset:26624
    ds_read_b128 a[220:223], v31 offset:2048
    v_mfma_f32_16x16x32_bf16 v[124:127], a[84:87], v[84:87], v[124:127]
    buffer_load_dwordx4 v12, s[28:31], s91 offen offset:3072  lds
    v_mfma_f32_16x16x32_bf16 v[128:131], a[84:87], v[88:91], v[128:131]
    ds_read_b128 v[72:75], v28 offset:28672
    v_mfma_f32_16x16x32_bf16 v[132:135], a[84:87], v[92:95], v[132:135]
    v_mfma_f32_16x16x32_bf16 v[136:139], a[88:91], v[76:79], v[136:139]
    v_mfma_f32_16x16x32_bf16 v[140:143], a[88:91], v[80:83], v[140:143]
    v_mfma_f32_16x16x32_bf16 v[144:147], a[88:91], v[84:87], v[144:147]
    s_add_u32 m0, s98, 0
    s_xor_b32 s91, s18, 73728
    v_mfma_f32_16x16x32_bf16 v[148:151], a[88:91], v[88:91], v[148:151]
    v_mfma_f32_16x16x32_bf16 v[152:155], a[88:91], v[92:95], v[152:155]
    v_mfma_f32_16x16x32_bf16 v[156:159], a[92:95], v[76:79], v[156:159]
    v_mfma_f32_16x16x32_bf16 v[160:163], a[92:95], v[80:83], v[160:163]
    s_waitcnt lgkmcnt(1)
    buffer_load_dwordx4 v9, s[28:31], s91 offen  lds
    v_mfma_f32_16x16x32_bf16 v[164:167], a[92:95], v[84:87], v[164:167]
    v_mfma_f32_16x16x32_bf16 v[168:171], a[92:95], v[88:91], v[168:171]
    v_mfma_f32_16x16x32_bf16 v[172:175], a[92:95], v[92:95], v[172:175]
    v_mfma_f32_16x16x32_bf16 v[96:99], a[16:19], v[56:59], v[96:99]
    ds_read_b128 v[76:79], v29 offset:20480
    s_bfe_u32 s21, s18, 0x10008
    s_mul_i32 s21, s21, 20480
    v_mfma_f32_16x16x32_bf16 v[100:103], a[16:19], v[60:63], v[100:103]
    s_sub_u32 s22, 20480, s21
    buffer_load_dwordx4 v10, s[28:31], s91 offen offset:1024  lds
    v_mfma_f32_16x16x32_bf16 v[104:107], a[16:19], v[64:67], v[104:107]
    ds_read_b128 v[80:83], v29 offset:22528
    v_add_u32 v54, s21, v32
    v_add_u32 v55, s22, v32
    v_mfma_f32_16x16x32_bf16 v[108:111], a[16:19], v[68:71], v[108:111]
    s_waitcnt lgkmcnt(2)
    v_mfma_f32_16x16x32_bf16 v[112:115], a[16:19], v[72:75], v[112:115]
    ds_read_b128 v[84:87], v29 offset:24576
    v_mfma_f32_16x16x32_bf16 v[116:119], a[20:23], v[56:59], v[116:119]
    v_mfma_f32_16x16x32_bf16 v[120:123], a[20:23], v[60:63], v[120:123]
    ds_read_b128 v[88:91], v29 offset:26624
    buffer_load_dwordx4 v11, s[28:31], s91 offen offset:2048  lds
    v_mfma_f32_16x16x32_bf16 v[124:127], a[20:23], v[64:67], v[124:127]
    s_waitcnt vmcnt(11)
    ds_read_b128 a[192:195], v30 offset:4096
    v_mfma_f32_16x16x32_bf16 v[128:131], a[20:23], v[68:71], v[128:131]
    ds_read_b128 v[92:95], v29 offset:28672
    ds_read_b128 a[196:199], v31 offset:4096
    v_mfma_f32_16x16x32_bf16 v[132:135], a[20:23], v[72:75], v[132:135]
    ds_read_b128 a[200:203], v30 offset:6144
    v_mfma_f32_16x16x32_bf16 v[136:139], a[24:27], v[56:59], v[136:139]
    ds_read_b128 a[204:207], v31 offset:6144
    v_mfma_f32_16x16x32_bf16 v[140:143], a[24:27], v[60:63], v[140:143]
    buffer_load_dwordx4 v12, s[28:31], s91 offen offset:3072  lds
    v_mfma_f32_16x16x32_bf16 v[144:147], a[24:27], v[64:67], v[144:147]
    v_mfma_f32_16x16x32_bf16 v[148:151], a[24:27], v[68:71], v[148:151]
    v_mfma_f32_16x16x32_bf16 v[152:155], a[24:27], v[72:75], v[152:155]
    v_mfma_f32_16x16x32_bf16 v[156:159], a[28:31], v[56:59], v[156:159]
    v_mfma_f32_16x16x32_bf16 v[160:163], a[28:31], v[60:63], v[160:163]
    s_add_u32 m0, s98, 4096
    s_xor_b32 s91, s18, 73984
    v_mfma_f32_16x16x32_bf16 v[164:167], a[28:31], v[64:67], v[164:167]
    v_mfma_f32_16x16x32_bf16 v[168:171], a[28:31], v[68:71], v[168:171]
    v_mfma_f32_16x16x32_bf16 v[172:175], a[28:31], v[72:75], v[172:175]
    s_waitcnt lgkmcnt(2)
    v_mfma_f32_16x16x32_bf16 v[96:99], a[96:99], v[76:79], v[96:99]
    v_mfma_f32_16x16x32_bf16 v[100:103], a[96:99], v[80:83], v[100:103]
    v_mfma_f32_16x16x32_bf16 v[104:107], a[96:99], v[84:87], v[104:107]
    v_mfma_f32_16x16x32_bf16 v[108:111], a[96:99], v[88:91], v[108:111]
    s_waitcnt lgkmcnt(0)
    buffer_load_dwordx4 v9, s[28:31], s91 offen  lds
    s_nop 2
    v_cvt_pk_bf16_f32 v46, v96, v97
    v_cvt_pk_bf16_f32 v47, v98, v99
    v_mfma_f32_16x16x32_bf16 v[112:115], a[96:99], v[92:95], v[112:115]
    ds_write_b64 v34, v[46:47] offset:0
    v_cvt_pk_bf16_f32 v48, v100, v101
    v_cvt_pk_bf16_f32 v49, v102, v103
    v_mfma_f32_16x16x32_bf16 v[116:119], a[100:103], v[76:79], v[116:119]
    ds_write_b64 v34, v[48:49] offset:1024
    v_cvt_pk_bf16_f32 v50, v104, v105
    v_cvt_pk_bf16_f32 v51, v106, v107
    v_mfma_f32_16x16x32_bf16 v[120:123], a[100:103], v[80:83], v[120:123]
    ds_write_b64 v34, v[50:51] offset:2048
    v_cvt_pk_bf16_f32 v52, v108, v109
    v_cvt_pk_bf16_f32 v53, v110, v111
    v_mfma_f32_16x16x32_bf16 v[124:127], a[100:103], v[84:87], v[124:127]
    ds_write_b64 v34, v[52:53] offset:3072
    v_cvt_pk_bf16_f32 v46, v112, v113
    v_cvt_pk_bf16_f32 v47, v114, v115
    v_mfma_f32_16x16x32_bf16 v[128:131], a[100:103], v[88:91], v[128:131]
    ds_write_b64 v34, v[46:47] offset:4096
    v_cvt_pk_bf16_f32 v48, v116, v117
    v_cvt_pk_bf16_f32 v49, v118, v119
    v_mfma_f32_16x16x32_bf16 v[132:135], a[100:103], v[92:95], v[132:135]
    ds_write_b64 v34, v[48:49] offset:512
    v_cvt_pk_bf16_f32 v50, v120, v121
    v_cvt_pk_bf16_f32 v51, v122, v123
    v_mfma_f32_16x16x32_bf16 v[136:139], a[104:107], v[76:79], v[136:139]
    ds_write_b64 v34, v[50:51] offset:1536
    buffer_load_dwordx4 v10, s[28:31], s91 offen offset:1024  lds
    v_cvt_pk_bf16_f32 v52, v124, v125
    v_cvt_pk_bf16_f32 v53, v126, v127
    v_mfma_f32_16x16x32_bf16 v[140:143], a[104:107], v[80:83], v[140:143]
    ds_write_b64 v34, v[52:53] offset:2560
    v_cvt_pk_bf16_f32 v46, v128, v129
    v_cvt_pk_bf16_f32 v47, v130, v131
    v_mfma_f32_16x16x32_bf16 v[144:147], a[104:107], v[84:87], v[144:147]
    ds_write_b64 v34, v[46:47] offset:3584
    v_cvt_pk_bf16_f32 v48, v132, v133
    v_cvt_pk_bf16_f32 v49, v134, v135
    v_mfma_f32_16x16x32_bf16 v[148:151], a[104:107], v[88:91], v[148:151]
    ds_write_b64 v34, v[48:49] offset:4608
    v_cvt_pk_bf16_f32 v50, v136, v137
    v_cvt_pk_bf16_f32 v51, v138, v139
    v_mfma_f32_16x16x32_bf16 v[152:155], a[104:107], v[92:95], v[152:155]
    ds_write_b64 v34, v[50:51] offset:5120
    v_cvt_pk_bf16_f32 v52, v140, v141
    v_cvt_pk_bf16_f32 v53, v142, v143
    v_mfma_f32_16x16x32_bf16 v[156:159], a[108:111], v[76:79], v[156:159]
    ds_write_b64 v34, v[52:53] offset:6144
    v_cvt_pk_bf16_f32 v46, v144, v145
    v_cvt_pk_bf16_f32 v47, v146, v147
    v_mfma_f32_16x16x32_bf16 v[160:163], a[108:111], v[80:83], v[160:163]
    ds_write_b64 v34, v[46:47] offset:7168
    v_cvt_pk_bf16_f32 v48, v148, v149
    v_cvt_pk_bf16_f32 v49, v150, v151
    v_mfma_f32_16x16x32_bf16 v[164:167], a[108:111], v[84:87], v[164:167]
    ds_write_b64 v34, v[48:49] offset:8192
    v_cvt_pk_bf16_f32 v50, v152, v153
    v_cvt_pk_bf16_f32 v51, v154, v155
    v_mfma_f32_16x16x32_bf16 v[168:171], a[108:111], v[88:91], v[168:171]
    ds_write_b64 v34, v[50:51] offset:9216
    v_cvt_pk_bf16_f32 v52, v156, v157
    v_cvt_pk_bf16_f32 v53, v158, v159
    v_mfma_f32_16x16x32_bf16 v[172:175], a[108:111], v[92:95], v[172:175]
    ds_write_b64 v34, v[52:53] offset:5632
    v_cvt_pk_bf16_f32 v46, v160, v161
    v_cvt_pk_bf16_f32 v47, v162, v163
    ds_write_b64 v34, v[46:47] offset:6656
    v_cvt_pk_bf16_f32 v48, v164, v165
    v_cvt_pk_bf16_f32 v49, v166, v167
    v_cvt_pk_bf16_f32 v50, v168, v169
    v_cvt_pk_bf16_f32 v51, v170, v171
    v_cvt_pk_bf16_f32 v52, v172, v173
    v_cvt_pk_bf16_f32 v53, v174, v175
    ds_write_b64 v34, v[48:49] offset:7680
    ds_write_b64 v34, v[50:51] offset:8704
    ds_write_b64 v34, v[52:53] offset:9728
    s_waitcnt lgkmcnt(0)
    s_barrier
    ds_read_b128 a[0:3], v54 offset:0
    ds_read_b128 a[4:7], v54 offset:1024
    ds_read_b128 a[8:11], v54 offset:2048
    ds_read_b128 a[12:15], v54 offset:3072
    ds_read_b128 a[16:19], v54 offset:4096
    ds_read_b128 a[20:23], v54 offset:5120
    ds_read_b128 a[24:27], v54 offset:6144
    ds_read_b128 a[28:31], v54 offset:7168
    buffer_load_dwordx4 v11, s[28:31], s91 offen offset:2048  lds
    s_waitcnt lgkmcnt(7)
    v_mfma_f32_16x16x32_bf16 v[96:99], a[240:243], a[0:3], 0
    ds_read_b128 a[32:35], v54 offset:8192
    s_waitcnt vmcnt(11)
    ds_read_b128 a[176:179], v30 offset:8192
    s_waitcnt lgkmcnt(8)
    v_mfma_f32_16x16x32_bf16 v[100:103], a[240:243], a[4:7], 0
    ds_read_b128 a[36:39], v54 offset:9216
    ds_read_b128 a[180:183], v31 offset:8192
    s_waitcnt lgkmcnt(9)
    v_mfma_f32_16x16x32_bf16 v[104:107], a[240:243], a[8:11], 0
    ds_read_b128 a[40:43], v54 offset:10240
    s_mov_b32 s4, 0
    ds_read_b128 a[184:187], v30 offset:10240
    s_waitcnt lgkmcnt(10)
    v_mfma_f32_16x16x32_bf16 v[108:111], a[240:243], a[12:15], 0
    ds_read_b128 a[44:47], v54 offset:11264
    s_lshl_b32 s21, s3, 3
    s_lshr_b32 s5, s17, 1
    s_waitcnt lgkmcnt(10)
    v_mfma_f32_16x16x32_bf16 v[112:115], a[240:243], a[16:19], 0
    ds_read_b128 a[48:51], v54 offset:12288
    s_add_u32 s5, s5, s21
    s_waitcnt lgkmcnt(10)
    v_mfma_f32_16x16x32_bf16 v[96:99], a[244:247], a[20:23], v[96:99]
    ds_read_b128 a[52:55], v54 offset:13312
    ds_read_b128 a[188:191], v31 offset:10240
    s_waitcnt lgkmcnt(11)
    v_mfma_f32_16x16x32_bf16 v[100:103], a[244:247], a[24:27], v[100:103]
    ds_read_b128 a[56:59], v54 offset:14336
    buffer_load_dwordx4 v12, s[28:31], s91 offen offset:3072  lds
    s_waitcnt lgkmcnt(11)
    v_mfma_f32_16x16x32_bf16 v[104:107], a[244:247], a[28:31], v[104:107]
    ds_read_b128 a[60:63], v54 offset:15360
    s_waitcnt lgkmcnt(11)
    v_mfma_f32_16x16x32_bf16 v[108:111], a[244:247], a[32:35], v[108:111]
    ds_read_b128 a[64:67], v54 offset:16384
    s_waitcnt lgkmcnt(10)
    v_mfma_f32_16x16x32_bf16 v[112:115], a[244:247], a[36:39], v[112:115]
    ds_read_b128 a[68:71], v54 offset:17408
    s_waitcnt lgkmcnt(9)
    v_mfma_f32_16x16x32_bf16 v[96:99], a[248:251], a[40:43], v[96:99]
    ds_read_b128 a[72:75], v54 offset:18432
    s_waitcnt lgkmcnt(8)
    v_mfma_f32_16x16x32_bf16 v[100:103], a[248:251], a[44:47], v[100:103]
    ds_read_b128 a[76:79], v54 offset:19456
    s_add_u32 m0, s98, 8192
    s_xor_b32 s91, s18, 131072
    s_waitcnt lgkmcnt(8)
    v_mfma_f32_16x16x32_bf16 v[104:107], a[248:251], a[48:51], v[104:107]
    ds_read_b128 a[80:83], v55 offset:0
    s_waitcnt lgkmcnt(8)
    v_mfma_f32_16x16x32_bf16 v[108:111], a[248:251], a[52:55], v[108:111]
    ds_read_b128 a[84:87], v55 offset:1024
    s_waitcnt lgkmcnt(7)
    v_mfma_f32_16x16x32_bf16 v[112:115], a[248:251], a[56:59], v[112:115]
    ds_read_b128 a[88:91], v55 offset:2048
    buffer_load_dwordx4 v9, s[28:31], s91 offen  lds
    s_waitcnt lgkmcnt(7)
    v_mfma_f32_16x16x32_bf16 v[96:99], a[252:255], a[60:63], v[96:99]
    ds_read_b128 a[92:95], v55 offset:3072
    s_waitcnt lgkmcnt(7)
    v_mfma_f32_16x16x32_bf16 v[100:103], a[252:255], a[64:67], v[100:103]
    ds_read_b128 a[96:99], v55 offset:4096
    s_waitcnt lgkmcnt(7)
    v_mfma_f32_16x16x32_bf16 v[104:107], a[252:255], a[68:71], v[104:107]
    ds_read_b128 a[100:103], v55 offset:5120
    s_waitcnt lgkmcnt(7)
    v_mfma_f32_16x16x32_bf16 v[108:111], a[252:255], a[72:75], v[108:111]
    ds_read_b128 a[104:107], v55 offset:6144
    buffer_load_dwordx4 v10, s[28:31], s91 offen offset:1024  lds
    s_waitcnt lgkmcnt(7)
    v_mfma_f32_16x16x32_bf16 v[112:115], a[252:255], a[76:79], v[112:115]
    ds_read_b128 a[108:111], v55 offset:7168
    s_waitcnt lgkmcnt(7)
    v_mfma_f32_16x16x32_bf16 v[96:99], a[224:227], a[80:83], v[96:99]
    ds_read_b128 a[112:115], v55 offset:8192
    s_waitcnt vmcnt(10)
    ds_read_b128 a[240:243], v30 offset:12288
    s_waitcnt lgkmcnt(8)
    v_mfma_f32_16x16x32_bf16 v[100:103], a[224:227], a[84:87], v[100:103]
    ds_read_b128 a[116:119], v55 offset:9216
    ds_read_b128 a[244:247], v31 offset:12288
    s_waitcnt lgkmcnt(9)
    v_mfma_f32_16x16x32_bf16 v[104:107], a[224:227], a[88:91], v[104:107]
    ds_read_b128 a[120:123], v55 offset:10240
    ds_read_b128 a[248:251], v30 offset:14336
    s_waitcnt lgkmcnt(10)
    v_mfma_f32_16x16x32_bf16 v[108:111], a[224:227], a[92:95], v[108:111]
    ds_read_b128 a[124:127], v55 offset:11264
    ds_read_b128 a[252:255], v31 offset:14336
    s_waitcnt lgkmcnt(11)
    v_mfma_f32_16x16x32_bf16 v[112:115], a[224:227], a[96:99], v[112:115]
    ds_read_b128 a[128:131], v55 offset:12288
    buffer_load_dwordx4 v11, s[28:31], s91 offen offset:2048  lds
    s_waitcnt lgkmcnt(11)
    v_mfma_f32_16x16x32_bf16 v[96:99], a[228:231], a[100:103], v[96:99]
    ds_read_b128 a[132:135], v55 offset:13312
    buffer_load_dwordx4 v12, s[28:31], s91 offen offset:3072  lds
    s_waitcnt lgkmcnt(11)
    v_mfma_f32_16x16x32_bf16 v[100:103], a[228:231], a[104:107], v[100:103]
    ds_read_b128 a[136:139], v55 offset:14336
    s_waitcnt lgkmcnt(11)
    v_mfma_f32_16x16x32_bf16 v[104:107], a[228:231], a[108:111], v[104:107]
    ds_read_b128 a[140:143], v55 offset:15360
    s_waitcnt lgkmcnt(11)
    v_mfma_f32_16x16x32_bf16 v[108:111], a[228:231], a[112:115], v[108:111]
    ds_read_b128 a[144:147], v55 offset:16384
    s_waitcnt lgkmcnt(10)
    v_mfma_f32_16x16x32_bf16 v[112:115], a[228:231], a[116:119], v[112:115]
    ds_read_b128 a[148:151], v55 offset:17408
    s_waitcnt lgkmcnt(9)
    v_mfma_f32_16x16x32_bf16 v[96:99], a[232:235], a[120:123], v[96:99]
    ds_read_b128 a[152:155], v55 offset:18432
    s_waitcnt lgkmcnt(8)
    v_mfma_f32_16x16x32_bf16 v[100:103], a[232:235], a[124:127], v[100:103]
    ds_read_b128 a[156:159], v55 offset:19456
    s_waitcnt lgkmcnt(7)
    v_mfma_f32_16x16x32_bf16 v[104:107], a[232:235], a[128:131], v[104:107]
    s_cmp_eq_u32 s5, 0
    s_cbranch_scc1 L_ar5_0
L_ab5_0:
    s_waitcnt lgkmcnt(6)
    v_mfma_f32_16x16x32_bf16 v[108:111], a[232:235], a[132:135], v[108:111]
    s_add_u32 m0, s98, 12288
    s_xor_b32 s91, s18, 131328
    s_waitcnt lgkmcnt(5)
    v_mfma_f32_16x16x32_bf16 v[112:115], a[232:235], a[136:139], v[112:115]
    buffer_load_dwordx4 v9, s[28:31], s91 offen  lds
    s_waitcnt lgkmcnt(4)
    v_mfma_f32_16x16x32_bf16 v[96:99], a[236:239], a[140:143], v[96:99]
    s_waitcnt lgkmcnt(3)
    v_mfma_f32_16x16x32_bf16 v[100:103], a[236:239], a[144:147], v[100:103]
    s_waitcnt lgkmcnt(2)
    v_mfma_f32_16x16x32_bf16 v[104:107], a[236:239], a[148:151], v[104:107]
    buffer_load_dwordx4 v10, s[28:31], s91 offen offset:1024  lds
    s_waitcnt lgkmcnt(1)
    v_mfma_f32_16x16x32_bf16 v[108:111], a[236:239], a[152:155], v[108:111]
    s_waitcnt lgkmcnt(0)
    v_mfma_f32_16x16x32_bf16 v[112:115], a[236:239], a[156:159], v[112:115]
    v_mfma_f32_16x16x32_bf16 v[116:119], a[208:211], a[0:3], 0
    s_waitcnt vmcnt(10)
    ds_read_b128 a[224:227], v30 offset:0
    v_mfma_f32_16x16x32_bf16 v[120:123], a[208:211], a[4:7], 0
    ds_read_b128 a[228:231], v31 offset:0
    buffer_load_dwordx4 v11, s[28:31], s91 offen offset:2048  lds
    v_mfma_f32_16x16x32_bf16 v[124:127], a[208:211], a[8:11], 0
    ds_read_b128 a[232:235], v30 offset:2048
    v_mfma_f32_16x16x32_bf16 v[128:131], a[208:211], a[12:15], 0
    ds_read_b128 a[236:239], v31 offset:2048
    v_mfma_f32_16x16x32_bf16 v[132:135], a[208:211], a[16:19], 0
    s_mul_i32 s48, s3, 128
    v_mfma_f32_16x16x32_bf16 v[116:119], a[212:215], a[20:23], v[116:119]
    buffer_load_dwordx4 v12, s[28:31], s91 offen offset:3072  lds
    v_mfma_f32_16x16x32_bf16 v[120:123], a[212:215], a[24:27], v[120:123]
    v_max3_f32 v46, v96, v97, v98
    v_mfma_f32_16x16x32_bf16 v[124:127], a[212:215], a[28:31], v[124:127]
    v_max_f32 v46, v46, v99
    v_mfma_f32_16x16x32_bf16 v[128:131], a[212:215], a[32:35], v[128:131]
    v_mfma_f32_16x16x32_bf16 v[132:135], a[212:215], a[36:39], v[132:135]
    s_add_u32 m0, s98, 0
    s_xor_b32 s91, s18, 139264
    v_mfma_f32_16x16x32_bf16 v[116:119], a[216:219], a[40:43], v[116:119]
    v_max3_f32 v47, v100, v101, v102
    v_mfma_f32_16x16x32_bf16 v[120:123], a[216:219], a[44:47], v[120:123]
    s_lshl_b32 s49, 1, s17
    v_mfma_f32_16x16x32_bf16 v[124:127], a[216:219], a[48:51], v[124:127]
    v_max_f32 v47, v47, v103
    v_mfma_f32_16x16x32_bf16 v[128:131], a[216:219], a[52:55], v[128:131]
    s_waitcnt lgkmcnt(0)
    buffer_load_dwordx4 v9, s[28:31], s91 offen  lds
    v_mfma_f32_16x16x32_bf16 v[132:135], a[216:219], a[56:59], v[132:135]
    v_max3_f32 v48, v104, v105, v106
    v_mfma_f32_16x16x32_bf16 v[116:119], a[220:223], a[60:63], v[116:119]
    v_mfma_f32_16x16x32_bf16 v[120:123], a[220:223], a[64:67], v[120:123]
    v_max_f32 v48, v48, v107
    v_mfma_f32_16x16x32_bf16 v[124:127], a[220:223], a[68:71], v[124:127]
    buffer_load_dwordx4 v10, s[28:31], s91 offen offset:1024  lds
    v_mfma_f32_16x16x32_bf16 v[128:131], a[220:223], a[72:75], v[128:131]
    v_max3_f32 v49, v108, v109, v110
    v_mfma_f32_16x16x32_bf16 v[132:135], a[220:223], a[76:79], v[132:135]
    v_max_f32 v49, v49, v111
    v_mfma_f32_16x16x32_bf16 v[116:119], a[192:195], a[80:83], v[116:119]
    s_waitcnt vmcnt(10)
    ds_read_b128 a[208:211], v30 offset:4096
    v_mfma_f32_16x16x32_bf16 v[120:123], a[192:195], a[84:87], v[120:123]
    ds_read_b128 a[212:215], v31 offset:4096
    buffer_load_dwordx4 v11, s[28:31], s91 offen offset:2048  lds
    v_mfma_f32_16x16x32_bf16 v[124:127], a[192:195], a[88:91], v[124:127]
    ds_read_b128 a[216:219], v30 offset:6144
    v_mfma_f32_16x16x32_bf16 v[128:131], a[192:195], a[92:95], v[128:131]
    ds_read_b128 a[220:223], v31 offset:6144
    v_mfma_f32_16x16x32_bf16 v[132:135], a[192:195], a[96:99], v[132:135]
    v_mul_u32_u24 v2, 512, v0
    v_mfma_f32_16x16x32_bf16 v[116:119], a[196:199], a[100:103], v[116:119]
    buffer_load_dwordx4 v12, s[28:31], s91 offen offset:3072  lds
    v_mfma_f32_16x16x32_bf16 v[120:123], a[196:199], a[104:107], v[120:123]
    v_mfma_f32_16x16x32_bf16 v[124:127], a[196:199], a[108:111], v[124:127]
    v_add_u32 v2, s48, v2
    v_mfma_f32_16x16x32_bf16 v[128:131], a[196:199], a[112:115], v[128:131]
    v_mov_b32 v34, s49
    v_mfma_f32_16x16x32_bf16 v[132:135], a[196:199], a[116:119], v[132:135]
    s_add_u32 m0, s98, 4096
    s_xor_b32 s91, s18, 139520
    v_mfma_f32_16x16x32_bf16 v[116:119], a[200:203], a[120:123], v[116:119]
    v_max3_f32 v50, v112, v113, v114
    v_mfma_f32_16x16x32_bf16 v[120:123], a[200:203], a[124:127], v[120:123]
    v_mov_b32 v76, 0x3f803f80
    v_mfma_f32_16x16x32_bf16 v[124:127], a[200:203], a[128:131], v[124:127]
    s_cmp_eq_u32 s5, 1
    s_cbranch_scc1 L_ar5_1
L_ab5_1:
    v_mfma_f32_16x16x32_bf16 v[128:131], a[200:203], a[132:135], v[128:131]
    s_waitcnt lgkmcnt(0)
    buffer_load_dwordx4 v9, s[28:31], s91 offen  lds
    v_mfma_f32_16x16x32_bf16 v[132:135], a[200:203], a[136:139], v[132:135]
    v_max_f32 v50, v50, v115
    v_mfma_f32_16x16x32_bf16 v[116:119], a[204:207], a[140:143], v[116:119]
    v_mov_b32 v77, 0x3f803f80
    v_mfma_f32_16x16x32_bf16 v[120:123], a[204:207], a[144:147], v[120:123]
    v_mov_b32 v78, 0x3f803f80
    v_mfma_f32_16x16x32_bf16 v[124:127], a[204:207], a[148:151], v[124:127]
    buffer_load_dwordx4 v10, s[28:31], s91 offen offset:1024  lds
    v_mfma_f32_16x16x32_bf16 v[128:131], a[204:207], a[152:155], v[128:131]
    v_mfma_f32_16x16x32_bf16 v[132:135], a[204:207], a[156:159], v[132:135]
    v_mov_b32 v79, 0x3f803f80
    v_mfma_f32_16x16x32_bf16 v[136:139], a[176:179], a[0:3], 0
    s_waitcnt vmcnt(10)
    ds_read_b128 a[192:195], v30 offset:8192
    v_mfma_f32_16x16x32_bf16 v[140:143], a[176:179], a[4:7], 0
    ds_read_b128 a[196:199], v31 offset:8192
    buffer_load_dwordx4 v11, s[28:31], s91 offen offset:2048  lds
    v_mfma_f32_16x16x32_bf16 v[144:147], a[176:179], a[8:11], 0
    ds_read_b128 a[200:203], v30 offset:10240
    v_mfma_f32_16x16x32_bf16 v[148:151], a[176:179], a[12:15], 0
    ds_read_b128 a[204:207], v31 offset:10240
    v_max3_f32 v46, v46, v116, v117
    v_max3_f32 v46, v46, v118, v119
    v_mfma_f32_16x16x32_bf16 v[152:155], a[176:179], a[16:19], 0
    v_max3_f32 v47, v47, v120, v121
    v_max3_f32 v47, v47, v122, v123
    v_mfma_f32_16x16x32_bf16 v[136:139], a[180:183], a[20:23], v[136:139]
    v_max3_f32 v48, v48, v124, v125
    v_max3_f32 v48, v48, v126, v127
    v_mfma_f32_16x16x32_bf16 v[140:143], a[180:183], a[24:27], v[140:143]
    v_max3_f32 v49, v49, v128, v129
    v_max3_f32 v49, v49, v130, v131
    v_mfma_f32_16x16x32_bf16 v[144:147], a[180:183], a[28:31], v[144:147]
    v_max3_f32 v50, v50, v132, v133
    v_max3_f32 v50, v50, v134, v135
    v_mfma_f32_16x16x32_bf16 v[148:151], a[180:183], a[32:35], v[148:151]
    buffer_load_dwordx4 v12, s[28:31], s91 offen offset:3072  lds
    v_mfma_f32_16x16x32_bf16 v[152:155], a[180:183], a[36:39], v[152:155]
    v_permlane32_swap_b32 v46, v48
    v_permlane32_swap_b32 v47, v49
    v_mfma_f32_16x16x32_bf16 v[136:139], a[184:187], a[40:43], v[136:139]
    v_max_f32 v46, v46, v48
    v_max_f32 v47, v47, v49
    v_mfma_f32_16x16x32_bf16 v[140:143], a[184:187], a[44:47], v[140:143]
    ds_max_f32 v44, v50 offset:256
    v_mfma_f32_16x16x32_bf16 v[144:147], a[184:187], a[48:51], v[144:147]
    v_permlane16_swap_b32 v46, v47
    v_max_f32 v46, v46, v47
    v_mfma_f32_16x16x32_bf16 v[148:151], a[184:187], a[52:55], v[148:151]
    ds_max_f32 v44, v46 offset:0
    v_mfma_f32_16x16x32_bf16 v[152:155], a[184:187], a[56:59], v[152:155]
    s_add_u32 m0, s98, 8192
    s_xor_b32 s91, s18, 196608
    v_mfma_f32_16x16x32_bf16 v[136:139], a[188:191], a[60:63], v[136:139]
    s_waitcnt lgkmcnt(2)
    buffer_load_dwordx4 v9, s[28:31], s91 offen  lds
    v_mfma_f32_16x16x32_bf16 v[140:143], a[188:191], a[64:67], v[140:143]
    v_mfma_f32_16x16x32_bf16 v[144:147], a[188:191], a[68:71], v[144:147]
    buffer_load_dwordx4 v10, s[28:31], s91 offen offset:1024  lds
    v_mfma_f32_16x16x32_bf16 v[148:151], a[188:191], a[72:75], v[148:151]
    v_mfma_f32_16x16x32_bf16 v[152:155], a[188:191], a[76:79], v[152:155]
    v_mfma_f32_16x16x32_bf16 v[136:139], a[240:243], a[80:83], v[136:139]
    s_waitcnt vmcnt(10)
    ds_read_b128 a[176:179], v30 offset:12288
    v_mfma_f32_16x16x32_bf16 v[140:143], a[240:243], a[84:87], v[140:143]
    ds_read_b128 a[180:183], v31 offset:12288
    buffer_load_dwordx4 v11, s[28:31], s91 offen offset:2048  lds
    v_mfma_f32_16x16x32_bf16 v[144:147], a[240:243], a[88:91], v[144:147]
    s_waitcnt lgkmcnt(2)
    s_barrier
    ds_read_b128 v[216:219], v38 offset:0
    ds_read_b128 v[220:223], v38 offset:256
    v_mfma_f32_16x16x32_bf16 v[148:151], a[240:243], a[92:95], v[148:151]
    ds_read_b128 a[184:187], v30 offset:14336
    ds_read_b128 a[188:191], v31 offset:14336
    v_mfma_f32_16x16x32_bf16 v[152:155], a[240:243], a[96:99], v[152:155]
    v_mfma_f32_16x16x32_bf16 v[136:139], a[244:247], a[100:103], v[136:139]
    buffer_load_dwordx4 v12, s[28:31], s91 offen offset:3072  lds
    v_mfma_f32_16x16x32_bf16 v[140:143], a[244:247], a[104:107], v[140:143]
    v_mfma_f32_16x16x32_bf16 v[144:147], a[244:247], a[108:111], v[144:147]
    v_mfma_f32_16x16x32_bf16 v[148:151], a[244:247], a[112:115], v[148:151]
    v_mfma_f32_16x16x32_bf16 v[152:155], a[244:247], a[116:119], v[152:155]
    s_add_u32 m0, s98, 12288
    s_xor_b32 s91, s18, 196864
    s_waitcnt lgkmcnt(2)
    v_max3_f32 v220, v220, v221, v222
    v_mfma_f32_16x16x32_bf16 v[136:139], a[248:251], a[120:123], v[136:139]
    v_max_f32 v220, v220, v223
    v_mul_f32 v51, 0xbdb8aa3b, v216
    v_mul_f32 v52, 0xbdb8aa3b, v217
    v_mfma_f32_16x16x32_bf16 v[140:143], a[248:251], a[124:127], v[140:143]
    v_mul_f32 v53, 0xbdb8aa3b, v218
    v_mul_f32 v54, 0xbdb8aa3b, v219
    v_mfma_f32_16x16x32_bf16 v[144:147], a[248:251], a[128:131], v[144:147]
    s_cmp_eq_u32 s5, 2
    s_cbranch_scc1 L_ar5_2
L_ab5_2:
    v_mul_f32 v55, 0xbdb8aa3b, v220
    v_mfma_f32_16x16x32_bf16 v[148:151], a[248:251], a[132:135], v[148:151]
    s_waitcnt lgkmcnt(0)
    buffer_load_dwordx4 v9, s[28:31], s91 offen  lds
    v_fma_f32 v96, v96, s96, v51
    v_mfma_f32_16x16x32_bf16 v[152:155], a[248:251], a[136:139], v[152:155]
    v_fma_f32 v97, v97, s96, v51
    v_exp_f32 v96, v96
    v_mfma_f32_16x16x32_bf16 v[136:139], a[252:255], a[140:143], v[136:139]
    v_exp_f32 v97, v97
    v_fma_f32 v98, v98, s96, v51
    v_mfma_f32_16x16x32_bf16 v[140:143], a[252:255], a[144:147], v[140:143]
    v_fma_f32 v99, v99, s96, v51
    v_exp_f32 v98, v98
    v_mfma_f32_16x16x32_bf16 v[144:147], a[252:255], a[148:151], v[144:147]
    buffer_load_dwordx4 v10, s[28:31], s91 offen offset:1024  lds
    v_exp_f32 v99, v99
    v_mfma_f32_16x16x32_bf16 v[148:151], a[252:255], a[152:155], v[148:151]
    v_fma_f32 v116, v116, s96, v51
    v_fma_f32 v117, v117, s96, v51
    v_mfma_f32_16x16x32_bf16 v[152:155], a[252:255], a[156:159], v[152:155]
    v_exp_f32 v116, v116
    v_exp_f32 v117, v117
    v_mfma_f32_16x16x32_bf16 v[156:159], a[224:227], a[0:3], 0
    s_waitcnt vmcnt(10)
    ds_read_b128 a[240:243], v30 offset:0
    v_mfma_f32_16x16x32_bf16 v[160:163], a[224:227], a[4:7], 0
    ds_read_b128 a[244:247], v31 offset:0
    buffer_load_dwordx4 v11, s[28:31], s91 offen offset:2048  lds
    v_fma_f32 v118, v118, s96, v51
    v_mfma_f32_16x16x32_bf16 v[164:167], a[224:227], a[8:11], 0
    ds_read_b128 a[248:251], v30 offset:2048
    v_fma_f32 v119, v119, s96, v51
    v_mfma_f32_16x16x32_bf16 v[168:171], a[224:227], a[12:15], 0
    ds_read_b128 a[252:255], v31 offset:2048
    v_exp_f32 v118, v118
    v_cvt_pk_bf16_f32 v224, v96, v97
    v_mfma_f32_16x16x32_bf16 v[172:175], a[224:227], a[16:19], 0
    v_cvt_pk_bf16_f32 v225, v98, v99
    v_exp_f32 v119, v119
    v_mfma_f32_16x16x32_bf16 v[156:159], a[228:231], a[20:23], v[156:159]
    buffer_load_dwordx4 v12, s[28:31], s91 offen offset:3072  lds
    v_cvt_pk_bf16_f32 v226, v116, v117
    v_mfma_f32_16x16x32_bf16 v[160:163], a[228:231], a[24:27], v[160:163]
    v_cvt_pk_bf16_f32 v227, v118, v119
    v_max3_f32 v46, v136, v137, v138
    v_mfma_f32_16x16x32_bf16 v[164:167], a[228:231], a[28:31], v[164:167]
    ds_write_b128 v35, v[224:227] offset:0
    v_mfma_f32_16x16x32_bf16 v[56:59], v[76:79], v[224:227], 0
    v_mfma_f32_16x16x32_bf16 v[168:171], a[228:231], a[32:35], v[168:171]
    v_fma_f32 v100, v100, s96, v52
    v_max_f32 v46, v46, v139
    v_max3_f32 v47, v140, v141, v142
    v_mfma_f32_16x16x32_bf16 v[172:175], a[228:231], a[36:39], v[172:175]
    s_add_u32 m0, s98, 0
    s_xor_b32 s91, s18, 204800
    v_fma_f32 v101, v101, s96, v52
    v_mfma_f32_16x16x32_bf16 v[156:159], a[232:235], a[40:43], v[156:159]
    v_exp_f32 v100, v100
    v_mfma_f32_16x16x32_bf16 v[160:163], a[232:235], a[44:47], v[160:163]
    v_exp_f32 v101, v101
    v_fma_f32 v102, v102, s96, v52
    v_mfma_f32_16x16x32_bf16 v[164:167], a[232:235], a[48:51], v[164:167]
    v_fma_f32 v103, v103, s96, v52
    v_exp_f32 v102, v102
    v_mfma_f32_16x16x32_bf16 v[168:171], a[232:235], a[52:55], v[168:171]
    s_waitcnt lgkmcnt(1)
    buffer_load_dwordx4 v9, s[28:31], s91 offen  lds
    v_exp_f32 v103, v103
    v_mfma_f32_16x16x32_bf16 v[172:175], a[232:235], a[56:59], v[172:175]
    v_fma_f32 v120, v120, s96, v52
    v_fma_f32 v121, v121, s96, v52
    v_mfma_f32_16x16x32_bf16 v[156:159], a[236:239], a[60:63], v[156:159]
    v_exp_f32 v120, v120
    v_max_f32 v47, v47, v143
    v_mfma_f32_16x16x32_bf16 v[160:163], a[236:239], a[64:67], v[160:163]
    v_exp_f32 v121, v121
    v_fma_f32 v122, v122, s96, v52
    v_fma_f32 v123, v123, s96, v52
    v_mfma_f32_16x16x32_bf16 v[164:167], a[236:239], a[68:71], v[164:167]
    buffer_load_dwordx4 v10, s[28:31], s91 offen offset:1024  lds
    v_exp_f32 v122, v122
    v_mfma_f32_16x16x32_bf16 v[168:171], a[236:239], a[72:75], v[168:171]
    v_cvt_pk_bf16_f32 v228, v100, v101
    v_cvt_pk_bf16_f32 v229, v102, v103
    v_mfma_f32_16x16x32_bf16 v[172:175], a[236:239], a[76:79], v[172:175]
    v_exp_f32 v123, v123
    v_cvt_pk_bf16_f32 v230, v120, v121
    v_mfma_f32_16x16x32_bf16 v[156:159], a[208:211], a[80:83], v[156:159]
    s_waitcnt vmcnt(10)
    ds_read_b128 a[224:227], v30 offset:4096
    v_cvt_pk_bf16_f32 v231, v122, v123
    v_mfma_f32_16x16x32_bf16 v[160:163], a[208:211], a[84:87], v[160:163]
    ds_read_b128 a[228:231], v31 offset:4096
    buffer_load_dwordx4 v11, s[28:31], s91 offen offset:2048  lds
    v_mfma_f32_16x16x32_bf16 v[164:167], a[208:211], a[88:91], v[164:167]
    ds_read_b128 a[232:235], v30 offset:6144
    v_max3_f32 v48, v144, v145, v146
    v_max_f32 v48, v48, v147
    v_mfma_f32_16x16x32_bf16 v[168:171], a[208:211], a[92:95], v[168:171]
    ds_read_b128 a[236:239], v31 offset:6144
    ds_write_b128 v35, v[228:231] offset:1024
    v_mfma_f32_16x16x32_bf16 v[60:63], v[76:79], v[228:231], 0
    v_mfma_f32_16x16x32_bf16 v[172:175], a[208:211], a[96:99], v[172:175]
    v_fma_f32 v104, v104, s96, v53
    v_max3_f32 v49, v148, v149, v150
    v_mfma_f32_16x16x32_bf16 v[156:159], a[212:215], a[100:103], v[156:159]
    buffer_load_dwordx4 v12, s[28:31], s91 offen offset:3072  lds
    v_fma_f32 v105, v105, s96, v53
    v_mfma_f32_16x16x32_bf16 v[160:163], a[212:215], a[104:107], v[160:163]
    v_exp_f32 v104, v104
    v_exp_f32 v105, v105
    v_mfma_f32_16x16x32_bf16 v[164:167], a[212:215], a[108:111], v[164:167]
    v_fma_f32 v106, v106, s96, v53
    v_fma_f32 v107, v107, s96, v53
    v_mfma_f32_16x16x32_bf16 v[168:171], a[212:215], a[112:115], v[168:171]
    v_exp_f32 v106, v106
    v_max_f32 v49, v49, v151
    v_mfma_f32_16x16x32_bf16 v[172:175], a[212:215], a[116:119], v[172:175]
    s_add_u32 m0, s98, 4096
    s_xor_b32 s91, s18, 205056
    v_exp_f32 v107, v107
    v_mfma_f32_16x16x32_bf16 v[156:159], a[216:219], a[120:123], v[156:159]
    v_fma_f32 v124, v124, s96, v53
    v_fma_f32 v125, v125, s96, v53
    v_mfma_f32_16x16x32_bf16 v[160:163], a[216:219], a[124:127], v[160:163]
    v_exp_f32 v124, v124
    v_exp_f32 v125, v125
    v_mfma_f32_16x16x32_bf16 v[164:167], a[216:219], a[128:131], v[164:167]
    s_cmp_eq_u32 s5, 3
    s_cbranch_scc1 L_ar5_3
L_ab5_3:
    v_mfma_f32_16x16x32_bf16 v[168:171], a[216:219], a[132:135], v[168:171]
    s_waitcnt lgkmcnt(1)
    buffer_load_dwordx4 v9, s[28:31], s91 offen  lds
    v_fma_f32 v126, v126, s96, v53
    v_mfma_f32_16x16x32_bf16 v[172:175], a[216:219], a[136:139], v[172:175]
    v_fma_f32 v127, v127, s96, v53
    v_exp_f32 v126, v126
    v_mfma_f32_16x16x32_bf16 v[156:159], a[220:223], a[140:143], v[156:159]
    v_cvt_pk_bf16_f32 v224, v104, v105
    v_cvt_pk_bf16_f32 v225, v106, v107
    v_max3_f32 v50, v152, v153, v154
    v_mfma_f32_16x16x32_bf16 v[160:163], a[220:223], a[144:147], v[160:163]
    v_exp_f32 v127, v127
    v_cvt_pk_bf16_f32 v226, v124, v125
    v_cvt_pk_bf16_f32 v227, v126, v127
    v_mfma_f32_16x16x32_bf16 v[164:167], a[220:223], a[148:151], v[164:167]
    buffer_load_dwordx4 v10, s[28:31], s91 offen offset:1024  lds
    v_max_f32 v50, v50, v155
    v_mfma_f32_16x16x32_bf16 v[168:171], a[220:223], a[152:155], v[168:171]
    v_mfma_f32_16x16x32_bf16 v[172:175], a[220:223], a[156:159], v[172:175]
    v_mfma_f32_16x16x32_bf16 v[176:179], a[192:195], a[0:3], 0
    s_waitcnt vmcnt(10)
    ds_read_b128 a[208:211], v30 offset:8192
    v_fma_f32 v108, v108, s96, v54
    v_mfma_f32_16x16x32_bf16 v[180:183], a[192:195], a[4:7], 0
    ds_read_b128 a[212:215], v31 offset:8192
    buffer_load_dwordx4 v11, s[28:31], s91 offen offset:2048  lds
    v_fma_f32 v109, v109, s96, v54
    v_mfma_f32_16x16x32_bf16 v[184:187], a[192:195], a[8:11], 0
    ds_read_b128 a[216:219], v30 offset:10240
    v_exp_f32 v108, v108
    v_mfma_f32_16x16x32_bf16 v[188:191], a[192:195], a[12:15], 0
    ds_read_b128 a[220:223], v31 offset:10240
    ds_write_b128 v35, v[224:227] offset:2048
    v_mfma_f32_16x16x32_bf16 v[64:67], v[76:79], v[224:227], 0
    v_max3_f32 v46, v46, v156, v157
    v_max3_f32 v46, v46, v158, v159
    v_mfma_f32_16x16x32_bf16 v[192:195], a[192:195], a[16:19], 0
    v_max3_f32 v47, v47, v160, v161
    v_max3_f32 v47, v47, v162, v163
    v_mfma_f32_16x16x32_bf16 v[176:179], a[196:199], a[20:23], v[176:179]
    v_max3_f32 v48, v48, v164, v165
    v_max3_f32 v48, v48, v166, v167
    v_exp_f32 v109, v109
    v_mfma_f32_16x16x32_bf16 v[180:183], a[196:199], a[24:27], v[180:183]
    v_max3_f32 v49, v49, v168, v169
    v_max3_f32 v49, v49, v170, v171
    v_mfma_f32_16x16x32_bf16 v[184:187], a[196:199], a[28:31], v[184:187]
    v_max3_f32 v50, v50, v172, v173
    v_max3_f32 v50, v50, v174, v175
    v_fma_f32 v110, v110, s96, v54
    v_mfma_f32_16x16x32_bf16 v[188:191], a[196:199], a[32:35], v[188:191]
    buffer_load_dwordx4 v12, s[28:31], s91 offen offset:3072  lds
    v_fma_f32 v111, v111, s96, v54
    v_mfma_f32_16x16x32_bf16 v[192:195], a[196:199], a[36:39], v[192:195]
    v_permlane32_swap_b32 v46, v48
    v_permlane32_swap_b32 v47, v49
    v_exp_f32 v110, v110
    v_mfma_f32_16x16x32_bf16 v[176:179], a[200:203], a[40:43], v[176:179]
    v_max_f32 v46, v46, v48
    v_max_f32 v47, v47, v49
    v_mfma_f32_16x16x32_bf16 v[180:183], a[200:203], a[44:47], v[180:183]
    ds_max_f32 v44, v50 offset:768
    v_exp_f32 v111, v111
    v_mfma_f32_16x16x32_bf16 v[184:187], a[200:203], a[48:51], v[184:187]
    v_permlane16_swap_b32 v46, v47
    v_max_f32 v46, v46, v47
    v_fma_f32 v128, v128, s96, v54
    v_mfma_f32_16x16x32_bf16 v[188:191], a[200:203], a[52:55], v[188:191]
    ds_max_f32 v44, v46 offset:512
    v_fma_f32 v129, v129, s96, v54
    v_mfma_f32_16x16x32_bf16 v[192:195], a[200:203], a[56:59], v[192:195]
    s_add_u32 m0, s98, 8192
    s_xor_b32 s91, s90, 0
    v_exp_f32 v128, v128
    v_mfma_f32_16x16x32_bf16 v[176:179], a[204:207], a[60:63], v[176:179]
    s_waitcnt lgkmcnt(3)
    buffer_load_dwordx4 v13, s[32:35], s91 offen  lds
    v_mfma_f32_16x16x32_bf16 v[180:183], a[204:207], a[64:67], v[180:183]
    v_exp_f32 v129, v129
    v_fma_f32 v130, v130, s96, v54
    v_fma_f32 v131, v131, s96, v54
    v_mfma_f32_16x16x32_bf16 v[184:187], a[204:207], a[68:71], v[184:187]
    buffer_load_dwordx4 v14, s[32:35], s91 offen offset:1024  lds
    v_exp_f32 v130, v130
    v_mfma_f32_16x16x32_bf16 v[188:191], a[204:207], a[72:75], v[188:191]
    v_cvt_pk_bf16_f32 v228, v108, v109
    v_cvt_pk_bf16_f32 v229, v110, v111
    v_mfma_f32_16x16x32_bf16 v[192:195], a[204:207], a[76:79], v[192:195]
    v_exp_f32 v131, v131
    v_cvt_pk_bf16_f32 v230, v128, v129
    v_mfma_f32_16x16x32_bf16 v[176:179], a[176:179], a[80:83], v[176:179]
    s_waitcnt vmcnt(10)
    ds_read_b128 a[192:195], v30 offset:12288
    v_cvt_pk_bf16_f32 v231, v130, v131
    v_mfma_f32_16x16x32_bf16 v[180:183], a[176:179], a[84:87], v[180:183]
    ds_read_b128 a[196:199], v31 offset:12288
    buffer_load_dwordx4 v15, s[32:35], s91 offen offset:2048  lds
    v_mfma_f32_16x16x32_bf16 v[184:187], a[176:179], a[88:91], v[184:187]
    ds_read_b128 a[200:203], v30 offset:14336
    v_mfma_f32_16x16x32_bf16 v[188:191], a[176:179], a[92:95], v[188:191]
    ds_read_b128 a[204:207], v31 offset:14336
    ds_write_b128 v35, v[228:231] offset:3072
    v_mfma_f32_16x16x32_bf16 v[68:71], v[76:79], v[228:231], 0
    v_mfma_f32_16x16x32_bf16 v[192:195], a[176:179], a[96:99], v[192:195]
    v_mfma_f32_16x16x32_bf16 v[176:179], a[180:183], a[100:103], v[176:179]
    buffer_load_dwordx4 v16, s[32:35], s91 offen offset:3072  lds
    v_fma_f32 v112, v112, s96, v55
    v_fma_f32 v113, v113, s96, v55
    v_mfma_f32_16x16x32_bf16 v[180:183], a[180:183], a[104:107], v[180:183]
    v_exp_f32 v112, v112
    v_exp_f32 v113, v113
    v_mfma_f32_16x16x32_bf16 v[184:187], a[180:183], a[108:111], v[184:187]
    v_fma_f32 v114, v114, s96, v55
    v_fma_f32 v115, v115, s96, v55
    v_mfma_f32_16x16x32_bf16 v[188:191], a[180:183], a[112:115], v[188:191]
    v_exp_f32 v114, v114
    v_mfma_f32_16x16x32_bf16 v[192:195], a[180:183], a[116:119], v[192:195]
    s_add_u32 m0, s98, 12288
    s_xor_b32 s91, s90, 16384
    v_exp_f32 v115, v115
    v_mfma_f32_16x16x32_bf16 v[176:179], a[184:187], a[120:123], v[176:179]
    v_fma_f32 v132, v132, s96, v55
    v_fma_f32 v133, v133, s96, v55
    v_mfma_f32_16x16x32_bf16 v[180:183], a[184:187], a[124:127], v[180:183]
    v_exp_f32 v132, v132
    v_exp_f32 v133, v133
    v_mfma_f32_16x16x32_bf16 v[184:187], a[184:187], a[128:131], v[184:187]
    s_cmp_eq_u32 s5, 4
    s_cbranch_scc1 L_ar5_4
L_ab5_4:
    v_mfma_f32_16x16x32_bf16 v[188:191], a[184:187], a[132:135], v[188:191]
    s_waitcnt lgkmcnt(1)
    buffer_load_dwordx4 v13, s[32:35], s91 offen  lds
    v_fma_f32 v134, v134, s96, v55
    v_mfma_f32_16x16x32_bf16 v[192:195], a[184:187], a[136:139], v[192:195]
    v_fma_f32 v135, v135, s96, v55
    v_exp_f32 v134, v134
    v_mfma_f32_16x16x32_bf16 v[176:179], a[188:191], a[140:143], v[176:179]
    v_cvt_pk_bf16_f32 v224, v112, v113
    v_cvt_pk_bf16_f32 v225, v114, v115
    v_mfma_f32_16x16x32_bf16 v[180:183], a[188:191], a[144:147], v[180:183]
    v_exp_f32 v135, v135
    v_cvt_pk_bf16_f32 v226, v132, v133
    v_cvt_pk_bf16_f32 v227, v134, v135
    v_mfma_f32_16x16x32_bf16 v[184:187], a[188:191], a[148:151], v[184:187]
    buffer_load_dwordx4 v14, s[32:35], s91 offen offset:1024  lds
    v_mfma_f32_16x16x32_bf16 v[188:191], a[188:191], a[152:155], v[188:191]
    ds_write_b128 v35, v[224:227] offset:4096
    v_mfma_f32_16x16x32_bf16 v[72:75], v[76:79], v[224:227], 0
    v_mfma_f32_16x16x32_bf16 v[192:195], a[188:191], a[156:159], v[192:195]
    v_mfma_f32_16x16x32_bf16 v[196:199], a[240:243], a[0:3], 0
    s_waitcnt vmcnt(10)
    ds_read_b128 a[176:179], v30 offset:0
    v_mfma_f32_16x16x32_bf16 v[200:203], a[240:243], a[4:7], 0
    ds_read_b128 a[180:183], v31 offset:0
    buffer_load_dwordx4 v15, s[32:35], s91 offen offset:2048  lds
    v_mfma_f32_16x16x32_bf16 v[204:207], a[240:243], a[8:11], 0
    ds_read_b128 a[184:187], v30 offset:2048
    v_mfma_f32_16x16x32_bf16 v[208:211], a[240:243], a[12:15], 0
    ds_read_b128 a[188:191], v31 offset:2048
    v_mfma_f32_16x16x32_bf16 v[212:215], a[240:243], a[16:19], 0
    s_waitcnt lgkmcnt(4)
    s_barrier
    ds_read_b128 v[96:99], v38 offset:512
    ds_read_b128 v[100:103], v38 offset:768
    v_mfma_f32_16x16x32_bf16 v[196:199], a[244:247], a[20:23], v[196:199]
    buffer_load_dwordx4 v16, s[32:35], s91 offen offset:3072  lds
    v_mfma_f32_16x16x32_bf16 v[200:203], a[244:247], a[24:27], v[200:203]
    v_max3_f32 v46, v176, v177, v178
    v_max_f32 v46, v46, v179
    v_mfma_f32_16x16x32_bf16 v[204:207], a[244:247], a[28:31], v[204:207]
    v_max3_f32 v47, v180, v181, v182
    v_max_f32 v47, v47, v183
    v_mfma_f32_16x16x32_bf16 v[208:211], a[244:247], a[32:35], v[208:211]
    v_max3_f32 v48, v184, v185, v186
    v_max_f32 v48, v48, v187
    v_mfma_f32_16x16x32_bf16 v[212:215], a[244:247], a[36:39], v[212:215]
    s_add_u32 m0, s98, 0
    s_xor_b32 s91, s90, 32768
    v_mfma_f32_16x16x32_bf16 v[196:199], a[248:251], a[40:43], v[196:199]
    v_max3_f32 v49, v188, v189, v190
    v_max_f32 v49, v49, v191
    v_mfma_f32_16x16x32_bf16 v[200:203], a[248:251], a[44:47], v[200:203]
    s_waitcnt lgkmcnt(0)
    v_max3_f32 v100, v100, v101, v102
    v_max_f32 v100, v100, v103
    v_fma_f32 v80, v96, s96, v51
    v_mfma_f32_16x16x32_bf16 v[204:207], a[248:251], a[48:51], v[204:207]
    v_fma_f32 v81, v97, s96, v52
    v_fma_f32 v82, v98, s96, v53
    v_fma_f32 v83, v99, s96, v54
    v_mfma_f32_16x16x32_bf16 v[208:211], a[248:251], a[52:55], v[208:211]
    buffer_load_dwordx4 v13, s[32:35], s91 offen  lds
    v_fma_f32 v84, v100, s96, v55
    v_mfma_f32_16x16x32_bf16 v[212:215], a[248:251], a[56:59], v[212:215]
    v_max3_f32 v101, v80, v81, v82
    v_max3_f32 v101, v101, v83, v84
    v_mfma_f32_16x16x32_bf16 v[196:199], a[252:255], a[60:63], v[196:199]
    v_cmp_lt_f32 vcc, 0x41200000, v101
    s_cbranch_vccnz L_mv5_1
L_mb5_1:
    v_fma_f32 v136, v136, s96, v51
    v_fma_f32 v137, v137, s96, v51
    v_mfma_f32_16x16x32_bf16 v[200:203], a[252:255], a[64:67], v[200:203]
    v_exp_f32 v136, v136
    v_mfma_f32_16x16x32_bf16 v[204:207], a[252:255], a[68:71], v[204:207]
    buffer_load_dwordx4 v14, s[32:35], s91 offen offset:1024  lds
    v_exp_f32 v137, v137
    v_fma_f32 v138, v138, s96, v51
    v_mfma_f32_16x16x32_bf16 v[208:211], a[252:255], a[72:75], v[208:211]
    v_fma_f32 v139, v139, s96, v51
    v_exp_f32 v138, v138
    v_mfma_f32_16x16x32_bf16 v[212:215], a[252:255], a[76:79], v[212:215]
    v_exp_f32 v139, v139
    v_max3_f32 v50, v192, v193, v194
    v_mfma_f32_16x16x32_bf16 v[196:199], a[224:227], a[80:83], v[196:199]
    s_waitcnt vmcnt(10)
    ds_read_b128 a[240:243], v30 offset:4096
    v_fma_f32 v156, v156, s96, v51
    v_fma_f32 v157, v157, s96, v51
    v_mfma_f32_16x16x32_bf16 v[200:203], a[224:227], a[84:87], v[200:203]
    ds_read_b128 a[244:247], v31 offset:4096
    buffer_load_dwordx4 v15, s[32:35], s91 offen offset:2048  lds
    v_mfma_f32_16x16x32_bf16 v[204:207], a[224:227], a[88:91], v[204:207]
    ds_read_b128 a[248:251], v30 offset:6144
    v_exp_f32 v156, v156
    v_mfma_f32_16x16x32_bf16 v[208:211], a[224:227], a[92:95], v[208:211]
    ds_read_b128 a[252:255], v31 offset:6144
    v_exp_f32 v157, v157
    v_mfma_f32_16x16x32_bf16 v[212:215], a[224:227], a[96:99], v[212:215]
    v_fma_f32 v158, v158, s96, v51
    v_fma_f32 v159, v159, s96, v51
    v_exp_f32 v158, v158
    v_mfma_f32_16x16x32_bf16 v[196:199], a[228:231], a[100:103], v[196:199]
    buffer_load_dwordx4 v16, s[32:35], s91 offen offset:3072  lds
    v_cvt_pk_bf16_f32 v104, v136, v137
    v_mfma_f32_16x16x32_bf16 v[200:203], a[228:231], a[104:107], v[200:203]
    v_cvt_pk_bf16_f32 v105, v138, v139
    v_exp_f32 v159, v159
    v_mfma_f32_16x16x32_bf16 v[204:207], a[228:231], a[108:111], v[204:207]
    v_cvt_pk_bf16_f32 v106, v156, v157
    v_cvt_pk_bf16_f32 v107, v158, v159
    v_mfma_f32_16x16x32_bf16 v[208:211], a[228:231], a[112:115], v[208:211]
    ds_write_b128 v35, v[104:107] offset:20480
    v_mfma_f32_16x16x32_bf16 v[56:59], v[76:79], v[104:107], v[56:59]
    v_mfma_f32_16x16x32_bf16 v[212:215], a[228:231], a[116:119], v[212:215]
    s_add_u32 m0, s98, 4096
    s_xor_b32 s91, s90, 49152
    v_mfma_f32_16x16x32_bf16 v[196:199], a[232:235], a[120:123], v[196:199]
    v_fma_f32 v140, v140, s96, v52
    v_max_f32 v50, v50, v195
    v_mfma_f32_16x16x32_bf16 v[200:203], a[232:235], a[124:127], v[200:203]
    v_fma_f32 v141, v141, s96, v52
    v_exp_f32 v140, v140
    v_mfma_f32_16x16x32_bf16 v[204:207], a[232:235], a[128:131], v[204:207]
    s_cmp_eq_u32 s5, 5
    s_cbranch_scc1 L_ar5_5
L_ab5_5:
    v_mfma_f32_16x16x32_bf16 v[208:211], a[232:235], a[132:135], v[208:211]
    v_exp_f32 v141, v141
    v_fma_f32 v142, v142, s96, v52
    v_mfma_f32_16x16x32_bf16 v[212:215], a[232:235], a[136:139], v[212:215]
    s_waitcnt lgkmcnt(1)
    buffer_load_dwordx4 v13, s[32:35], s91 offen  lds
    v_fma_f32 v143, v143, s96, v52
    v_mfma_f32_16x16x32_bf16 v[196:199], a[236:239], a[140:143], v[196:199]
    v_exp_f32 v142, v142
    v_exp_f32 v143, v143
    v_mfma_f32_16x16x32_bf16 v[200:203], a[236:239], a[144:147], v[200:203]
    v_fma_f32 v160, v160, s96, v52
    v_fma_f32 v161, v161, s96, v52
    v_mfma_f32_16x16x32_bf16 v[204:207], a[236:239], a[148:151], v[204:207]
    v_exp_f32 v160, v160
    v_exp_f32 v161, v161
    v_mfma_f32_16x16x32_bf16 v[208:211], a[236:239], a[152:155], v[208:211]
    v_fma_f32 v162, v162, s96, v52
    v_fma_f32 v163, v163, s96, v52
    v_mfma_f32_16x16x32_bf16 v[212:215], a[236:239], a[156:159], v[212:215]
    buffer_load_dwordx4 v14, s[32:35], s91 offen offset:1024  lds
    v_exp_f32 v162, v162
    v_mfma_f32_16x16x32_bf16 v[216:219], a[208:211], a[0:3], 0
    s_waitcnt vmcnt(10)
    ds_read_b64_tr_b16 a[224:225], v21 offset:8192
    v_cvt_pk_bf16_f32 v108, v140, v141
    v_mfma_f32_16x16x32_bf16 v[220:223], a[208:211], a[4:7], 0
    ds_read_b64_tr_b16 a[226:227], v21 offset:10240
    v_cvt_pk_bf16_f32 v109, v142, v143
    v_exp_f32 v163, v163
    v_mfma_f32_16x16x32_bf16 v[224:227], a[208:211], a[8:11], 0
    ds_read_b64_tr_b16 a[228:229], v22 offset:8192
    v_cvt_pk_bf16_f32 v110, v160, v161
    v_mfma_f32_16x16x32_bf16 v[228:231], a[208:211], a[12:15], 0
    ds_read_b64_tr_b16 a[230:231], v22 offset:10240
    v_max3_f32 v46, v46, v196, v197
    v_max3_f32 v46, v46, v198, v199
    v_mfma_f32_16x16x32_bf16 v[232:235], a[208:211], a[16:19], 0
    ds_read_b64_tr_b16 a[232:233], v23 offset:8192
    v_max3_f32 v47, v47, v200, v201
    v_max3_f32 v47, v47, v202, v203
    v_mfma_f32_16x16x32_bf16 v[216:219], a[212:215], a[20:23], v[216:219]
    ds_read_b64_tr_b16 a[234:235], v23 offset:10240
    v_max3_f32 v48, v48, v204, v205
    v_max3_f32 v48, v48, v206, v207
    v_mfma_f32_16x16x32_bf16 v[220:223], a[212:215], a[24:27], v[220:223]
    buffer_load_dwordx4 v15, s[32:35], s91 offen offset:2048  lds
    v_max3_f32 v49, v49, v208, v209
    v_max3_f32 v49, v49, v210, v211
    v_mfma_f32_16x16x32_bf16 v[224:227], a[212:215], a[28:31], v[224:227]
    v_max3_f32 v50, v50, v212, v213
    v_max3_f32 v50, v50, v214, v215
    v_cvt_pk_bf16_f32 v111, v162, v163
    v_mfma_f32_16x16x32_bf16 v[228:231], a[212:215], a[32:35], v[228:231]
    ds_read_b64_tr_b16 a[236:237], v24 offset:8192
    ds_read_b64_tr_b16 a[238:239], v24 offset:10240
    v_mfma_f32_16x16x32_bf16 v[232:235], a[212:215], a[36:39], v[232:235]
    v_permlane32_swap_b32 v46, v48
    v_permlane32_swap_b32 v47, v49
    v_mfma_f32_16x16x32_bf16 v[216:219], a[216:219], a[40:43], v[216:219]
    v_max_f32 v46, v46, v48
    v_max_f32 v47, v47, v49
    v_mfma_f32_16x16x32_bf16 v[220:223], a[216:219], a[44:47], v[220:223]
    ds_max_f32 v44, v50 offset:1280
    buffer_load_dwordx4 v16, s[32:35], s91 offen offset:3072  lds
    v_mfma_f32_16x16x32_bf16 v[224:227], a[216:219], a[48:51], v[224:227]
    v_permlane16_swap_b32 v46, v47
    v_max_f32 v46, v46, v47
    v_mfma_f32_16x16x32_bf16 v[228:231], a[216:219], a[52:55], v[228:231]
    ds_max_f32 v44, v46 offset:1024
    ds_write_b128 v35, v[108:111] offset:21504
    v_mfma_f32_16x16x32_bf16 v[60:63], v[76:79], v[108:111], v[60:63]
    v_mfma_f32_16x16x32_bf16 v[232:235], a[216:219], a[56:59], v[232:235]
    s_add_u32 m0, s98, 8192
    s_xor_b32 s91, s90, 65536
    v_mfma_f32_16x16x32_bf16 v[216:219], a[220:223], a[60:63], v[216:219]
    v_fma_f32 v144, v144, s96, v53
    v_fma_f32 v145, v145, s96, v53
    v_exp_f32 v144, v144
    v_mfma_f32_16x16x32_bf16 v[220:223], a[220:223], a[64:67], v[220:223]
    v_exp_f32 v145, v145
    v_mfma_f32_16x16x32_bf16 v[224:227], a[220:223], a[68:71], v[224:227]
    s_waitcnt lgkmcnt(3)
    buffer_load_dwordx4 v13, s[32:35], s91 offen  lds
    v_fma_f32 v146, v146, s96, v53
    v_mfma_f32_16x16x32_bf16 v[228:231], a[220:223], a[72:75], v[228:231]
    v_fma_f32 v147, v147, s96, v53
    v_exp_f32 v146, v146
    v_mfma_f32_16x16x32_bf16 v[232:235], a[220:223], a[76:79], v[232:235]
    v_exp_f32 v147, v147
    v_fma_f32 v164, v164, s96, v53
    v_mfma_f32_16x16x32_bf16 v[216:219], a[192:195], a[80:83], v[216:219]
    s_waitcnt vmcnt(9)
    ds_read_b64_tr_b16 a[208:209], v21 offset:12288
    v_fma_f32 v165, v165, s96, v53
    v_mfma_f32_16x16x32_bf16 v[220:223], a[192:195], a[84:87], v[220:223]
    ds_read_b64_tr_b16 a[210:211], v21 offset:14336
    buffer_load_dwordx4 v14, s[32:35], s91 offen offset:1024  lds
    v_exp_f32 v164, v164
    v_mfma_f32_16x16x32_bf16 v[224:227], a[192:195], a[88:91], v[224:227]
    ds_read_b64_tr_b16 a[212:213], v22 offset:12288
    v_exp_f32 v165, v165
    v_mfma_f32_16x16x32_bf16 v[228:231], a[192:195], a[92:95], v[228:231]
    ds_read_b64_tr_b16 a[214:215], v22 offset:14336
    v_fma_f32 v166, v166, s96, v53
    v_mfma_f32_16x16x32_bf16 v[232:235], a[192:195], a[96:99], v[232:235]
    ds_read_b64_tr_b16 a[216:217], v23 offset:12288
    v_fma_f32 v167, v167, s96, v53
    v_mfma_f32_16x16x32_bf16 v[216:219], a[196:199], a[100:103], v[216:219]
    ds_read_b64_tr_b16 a[218:219], v23 offset:14336
    buffer_load_dwordx4 v15, s[32:35], s91 offen offset:2048  lds
    v_exp_f32 v166, v166
    v_mfma_f32_16x16x32_bf16 v[220:223], a[196:199], a[104:107], v[220:223]
    ds_read_b64_tr_b16 a[220:221], v24 offset:12288
    v_cvt_pk_bf16_f32 v104, v144, v145
    v_cvt_pk_bf16_f32 v105, v146, v147
    v_mfma_f32_16x16x32_bf16 v[224:227], a[196:199], a[108:111], v[224:227]
    ds_read_b64_tr_b16 a[222:223], v24 offset:14336
    v_exp_f32 v167, v167
    v_mfma_f32_16x16x32_bf16 v[228:231], a[196:199], a[112:115], v[228:231]
    v_cvt_pk_bf16_f32 v106, v164, v165
    v_cvt_pk_bf16_f32 v107, v166, v167
    v_mfma_f32_16x16x32_bf16 v[232:235], a[196:199], a[116:119], v[232:235]
    buffer_load_dwordx4 v16, s[32:35], s91 offen offset:3072  lds
    v_mfma_f32_16x16x32_bf16 v[216:219], a[200:203], a[120:123], v[216:219]
    ds_write_b128 v35, v[104:107] offset:22528
    v_mfma_f32_16x16x32_bf16 v[64:67], v[76:79], v[104:107], v[64:67]
    v_mfma_f32_16x16x32_bf16 v[220:223], a[200:203], a[124:127], v[220:223]
    v_fma_f32 v148, v148, s96, v54
    v_mfma_f32_16x16x32_bf16 v[224:227], a[200:203], a[128:131], v[224:227]
    s_cmp_eq_u32 s5, 6
    s_cbranch_scc1 L_ar5_6
L_ab5_6:
    v_fma_f32 v149, v149, s96, v54
    v_mfma_f32_16x16x32_bf16 v[228:231], a[200:203], a[132:135], v[228:231]
    s_add_u32 m0, s98, 12288
    s_xor_b32 s91, s90, 81920
    v_exp_f32 v148, v148
    v_mfma_f32_16x16x32_bf16 v[232:235], a[200:203], a[136:139], v[232:235]
    v_exp_f32 v149, v149
    v_mfma_f32_16x16x32_bf16 v[216:219], a[204:207], a[140:143], v[216:219]
    v_fma_f32 v150, v150, s96, v54
    v_fma_f32 v151, v151, s96, v54
    v_exp_f32 v150, v150
    v_mfma_f32_16x16x32_bf16 v[220:223], a[204:207], a[144:147], v[220:223]
    v_exp_f32 v151, v151
    v_mfma_f32_16x16x32_bf16 v[224:227], a[204:207], a[148:151], v[224:227]
    s_waitcnt lgkmcnt(1)
    buffer_load_dwordx4 v13, s[32:35], s91 offen  lds
    v_fma_f32 v168, v168, s96, v54
    v_mfma_f32_16x16x32_bf16 v[228:231], a[204:207], a[152:155], v[228:231]
    v_fma_f32 v169, v169, s96, v54
    v_exp_f32 v168, v168
    v_mfma_f32_16x16x32_bf16 v[232:235], a[204:207], a[156:159], v[232:235]
    v_exp_f32 v169, v169
    v_fma_f32 v170, v170, s96, v54
    v_mfma_f32_16x16x32_bf16 v[236:239], a[176:179], a[0:3], 0
    s_waitcnt vmcnt(9)
    ds_read_b64_tr_b16 a[192:193], v21 offset:0
    v_fma_f32 v171, v171, s96, v54
    v_mfma_f32_16x16x32_bf16 v[240:243], a[176:179], a[4:7], 0
    ds_read_b64_tr_b16 a[194:195], v21 offset:2048
    buffer_load_dwordx4 v14, s[32:35], s91 offen offset:1024  lds
    v_mfma_f32_16x16x32_bf16 v[244:247], a[176:179], a[8:11], 0
    ds_read_b64_tr_b16 a[196:197], v22 offset:0
    v_exp_f32 v170, v170
    v_cvt_pk_bf16_f32 v108, v148, v149
    v_mfma_f32_16x16x32_bf16 v[248:251], a[176:179], a[12:15], 0
    ds_read_b64_tr_b16 a[198:199], v22 offset:2048
    v_cvt_pk_bf16_f32 v109, v150, v151
    v_mfma_f32_16x16x32_bf16 v[252:255], a[176:179], a[16:19], 0
    ds_read_b64_tr_b16 a[200:201], v23 offset:0
    v_exp_f32 v171, v171
    v_cvt_pk_bf16_f32 v110, v168, v169
    v_mfma_f32_16x16x32_bf16 v[236:239], a[180:183], a[20:23], v[236:239]
    ds_read_b64_tr_b16 a[202:203], v23 offset:2048
    buffer_load_dwordx4 v15, s[32:35], s91 offen offset:2048  lds
    v_cvt_pk_bf16_f32 v111, v170, v171
    v_mfma_f32_16x16x32_bf16 v[240:243], a[180:183], a[24:27], v[240:243]
    ds_read_b64_tr_b16 a[204:205], v24 offset:0
    v_max3_f32 v46, v216, v217, v218
    v_mfma_f32_16x16x32_bf16 v[244:247], a[180:183], a[28:31], v[244:247]
    ds_read_b64_tr_b16 a[206:207], v24 offset:2048
    v_mfma_f32_16x16x32_bf16 v[248:251], a[180:183], a[32:35], v[248:251]
    ds_write_b128 v35, v[108:111] offset:23552
    v_mfma_f32_16x16x32_bf16 v[68:71], v[76:79], v[108:111], v[68:71]
    v_mfma_f32_16x16x32_bf16 v[252:255], a[180:183], a[36:39], v[252:255]
    buffer_load_dwordx4 v16, s[32:35], s91 offen offset:3072  lds
    v_fma_f32 v152, v152, s96, v55
    v_mfma_f32_16x16x32_bf16 v[236:239], a[184:187], a[40:43], v[236:239]
    v_fma_f32 v153, v153, s96, v55
    v_exp_f32 v152, v152
    v_mfma_f32_16x16x32_bf16 v[240:243], a[184:187], a[44:47], v[240:243]
    v_exp_f32 v153, v153
    v_fma_f32 v154, v154, s96, v55
    v_mfma_f32_16x16x32_bf16 v[244:247], a[184:187], a[48:51], v[244:247]
    v_fma_f32 v155, v155, s96, v55
    v_exp_f32 v154, v154
    v_mfma_f32_16x16x32_bf16 v[248:251], a[184:187], a[52:55], v[248:251]
    s_add_u32 m0, s98, 0
    s_xor_b32 s91, s90, 98304
    v_mfma_f32_16x16x32_bf16 v[252:255], a[184:187], a[56:59], v[252:255]
    v_exp_f32 v155, v155
    v_fma_f32 v172, v172, s96, v55
    v_fma_f32 v173, v173, s96, v55
    v_mfma_f32_16x16x32_bf16 v[236:239], a[188:191], a[60:63], v[236:239]
    v_exp_f32 v172, v172
    v_mfma_f32_16x16x32_bf16 v[240:243], a[188:191], a[64:67], v[240:243]
    v_exp_f32 v173, v173
    v_fma_f32 v174, v174, s96, v55
    v_fma_f32 v175, v175, s96, v55
    v_mfma_f32_16x16x32_bf16 v[244:247], a[188:191], a[68:71], v[244:247]
    s_waitcnt lgkmcnt(1)
    buffer_load_dwordx4 v13, s[32:35], s91 offen  lds
    v_mfma_f32_16x16x32_bf16 v[248:251], a[188:191], a[72:75], v[248:251]
    v_exp_f32 v174, v174
    v_cvt_pk_bf16_f32 v104, v152, v153
    v_cvt_pk_bf16_f32 v105, v154, v155
    v_mfma_f32_16x16x32_bf16 v[252:255], a[188:191], a[76:79], v[252:255]
    v_exp_f32 v175, v175
    v_cvt_pk_bf16_f32 v106, v172, v173
    v_mfma_f32_16x16x32_bf16 v[236:239], a[240:243], a[80:83], v[236:239]
    ds_read_b128 a[0:3], v32 offset:0
    v_cvt_pk_bf16_f32 v107, v174, v175
    v_mfma_f32_16x16x32_bf16 v[240:243], a[240:243], a[84:87], v[240:243]
    s_waitcnt vmcnt(9)
    ds_read_b64_tr_b16 a[176:177], v21 offset:4096
    v_mfma_f32_16x16x32_bf16 v[244:247], a[240:243], a[88:91], v[244:247]
    ds_read_b128 a[4:7], v32 offset:1024
    ds_read_b64_tr_b16 a[178:179], v21 offset:6144
    v_mfma_f32_16x16x32_bf16 v[248:251], a[240:243], a[92:95], v[248:251]
    ds_read_b64_tr_b16 a[180:181], v22 offset:4096
    ds_read_b64_tr_b16 a[182:183], v22 offset:6144
    v_mfma_f32_16x16x32_bf16 v[252:255], a[240:243], a[96:99], v[252:255]
    ds_read_b128 a[8:11], v32 offset:2048
    ds_read_b64_tr_b16 a[184:185], v23 offset:4096
    v_mfma_f32_16x16x32_bf16 v[236:239], a[244:247], a[100:103], v[236:239]
    ds_read_b64_tr_b16 a[186:187], v23 offset:6144
    buffer_load_dwordx4 v14, s[32:35], s91 offen offset:1024  lds
    v_mfma_f32_16x16x32_bf16 v[240:243], a[244:247], a[104:107], v[240:243]
    ds_read_b128 a[12:15], v32 offset:3072
    ds_read_b64_tr_b16 a[188:189], v24 offset:4096
    v_mfma_f32_16x16x32_bf16 v[244:247], a[244:247], a[108:111], v[244:247]
    ds_read_b64_tr_b16 a[190:191], v24 offset:6144
    buffer_load_dwordx4 v15, s[32:35], s91 offen offset:2048  lds
    v_mfma_f32_16x16x32_bf16 v[248:251], a[244:247], a[112:115], v[248:251]
    ds_read_b128 a[16:19], v32 offset:4096
    ds_write_b128 v35, v[104:107] offset:24576
    v_mfma_f32_16x16x32_bf16 v[72:75], v[76:79], v[104:107], v[72:75]
    v_mfma_f32_16x16x32_bf16 v[252:255], a[244:247], a[116:119], v[252:255]
    buffer_load_dwordx4 v16, s[32:35], s91 offen offset:3072  lds
    v_max_f32 v46, v46, v219
    v_mfma_f32_16x16x32_bf16 v[236:239], a[248:251], a[120:123], v[236:239]
    v_max3_f32 v47, v220, v221, v222
    v_max_f32 v47, v47, v223
    v_mfma_f32_16x16x32_bf16 v[240:243], a[248:251], a[124:127], v[240:243]
    v_max3_f32 v48, v224, v225, v226
    v_mfma_f32_16x16x32_bf16 v[244:247], a[248:251], a[128:131], v[244:247]
    s_cmp_eq_u32 s5, 7
    s_cbranch_scc1 L_ar5_7
L_ab5_7:
    s_waitcnt lgkmcnt(0)
    s_barrier
    ds_read_b128 v[4:7], v38 offset:1024
    ds_read_b128 v[8:11], v38 offset:1280
    v_mfma_f32_16x16x32_bf16 v[248:251], a[248:251], a[132:135], v[248:251]
    s_add_u32 m0, s98, 4096
    s_xor_b32 s91, s90, 114688
    v_mfma_f32_16x16x32_bf16 v[252:255], a[248:251], a[136:139], v[252:255]
    v_max_f32 v48, v48, v227
    v_max3_f32 v49, v228, v229, v230
    v_mfma_f32_16x16x32_bf16 v[236:239], a[252:255], a[140:143], v[236:239]
    v_max_f32 v49, v49, v231
    v_mfma_f32_16x16x32_bf16 v[240:243], a[252:255], a[144:147], v[240:243]
    v_max3_f32 v50, v232, v233, v234
    v_max_f32 v50, v50, v235
    v_mfma_f32_16x16x32_bf16 v[244:247], a[252:255], a[148:151], v[244:247]
    buffer_load_dwordx4 v13, s[32:35], s91 offen  lds
    v_mfma_f32_16x16x32_bf16 v[248:251], a[252:255], a[152:155], v[248:251]
    v_mfma_f32_16x16x32_bf16 v[252:255], a[252:255], a[156:159], v[252:255]
    s_waitcnt lgkmcnt(0)
    v_max3_f32 v8, v8, v9, v10
    v_max_f32 v8, v8, v11
    v_fma_f32 v85, v4, s96, v51
    v_mfma_f32_16x16x32_bf16 v[96:99], a[224:227], a[0:3], 0
    ds_read_b128 a[20:23], v32 offset:5120
    v_fma_f32 v86, v5, s96, v52
    v_mfma_f32_16x16x32_bf16 v[100:103], a[224:227], a[4:7], 0
    s_waitcnt vmcnt(9)
    ds_read_b64_tr_b16 a[240:241], v21 offset:8192
    buffer_load_dwordx4 v14, s[32:35], s91 offen offset:1024  lds
    v_mfma_f32_16x16x32_bf16 v[104:107], a[224:227], a[8:11], 0
    ds_read_b128 a[24:27], v32 offset:6144
    ds_read_b64_tr_b16 a[242:243], v21 offset:10240
    ds_read_b64_tr_b16 a[244:245], v22 offset:8192
    v_mfma_f32_16x16x32_bf16 v[108:111], a[224:227], a[12:15], 0
    ds_read_b64_tr_b16 a[246:247], v22 offset:10240
    v_max3_f32 v46, v46, v236, v237
    v_max3_f32 v46, v46, v238, v239
    v_mfma_f32_16x16x32_bf16 v[112:115], a[224:227], a[16:19], 0
    ds_read_b128 a[28:31], v32 offset:7168
    v_max3_f32 v47, v47, v240, v241
    v_max3_f32 v47, v47, v242, v243
    v_mfma_f32_16x16x32_bf16 v[116:119], a[228:231], a[0:3], 0
    ds_read_b64_tr_b16 a[248:249], v23 offset:8192
    v_max3_f32 v48, v48, v244, v245
    v_max3_f32 v48, v48, v246, v247
    v_mfma_f32_16x16x32_bf16 v[120:123], a[228:231], a[4:7], 0
    ds_read_b128 a[32:35], v32 offset:8192
    v_max3_f32 v49, v49, v248, v249
    v_max3_f32 v49, v49, v250, v251
    v_mfma_f32_16x16x32_bf16 v[124:127], a[228:231], a[8:11], 0
    ds_read_b64_tr_b16 a[250:251], v23 offset:10240
    v_max3_f32 v50, v50, v252, v253
    v_max3_f32 v50, v50, v254, v255
    v_mfma_f32_16x16x32_bf16 v[128:131], a[228:231], a[12:15], 0
    ds_read_b128 a[36:39], v32 offset:9216
    ds_read_b64_tr_b16 a[252:253], v24 offset:8192
    ds_read_b64_tr_b16 a[254:255], v24 offset:10240
    v_mfma_f32_16x16x32_bf16 v[132:135], a[228:231], a[16:19], 0
    buffer_load_dwordx4 v15, s[32:35], s91 offen offset:2048  lds
    v_permlane32_swap_b32 v46, v48
    v_permlane32_swap_b32 v47, v49
    v_mfma_f32_16x16x32_bf16 v[136:139], a[232:235], a[0:3], 0
    v_max_f32 v46, v46, v48
    v_max_f32 v47, v47, v49
    v_fma_f32 v87, v6, s96, v53
    v_mfma_f32_16x16x32_bf16 v[140:143], a[232:235], a[4:7], 0
    ds_max_f32 v44, v50 offset:1792
    buffer_load_dwordx4 v16, s[32:35], s91 offen offset:3072  lds
    v_fma_f32 v88, v7, s96, v54
    v_mfma_f32_16x16x32_bf16 v[144:147], a[232:235], a[8:11], 0
    v_permlane16_swap_b32 v46, v47
    v_max_f32 v46, v46, v47
    v_fma_f32 v89, v8, s96, v55
    v_mfma_f32_16x16x32_bf16 v[148:151], a[232:235], a[12:15], 0
    ds_max_f32 v44, v46 offset:1536
    v_max3_f32 v9, v85, v86, v87
    v_mfma_f32_16x16x32_bf16 v[152:155], a[232:235], a[16:19], 0
    s_add_u32 m0, s98, 8192
    s_xor_b32 s91, s90, 131072
    v_max3_f32 v9, v9, v88, v89
    v_mfma_f32_16x16x32_bf16 v[156:159], a[236:239], a[0:3], 0
    v_cmp_lt_f32 vcc, 0x41200000, v9
    s_cbranch_vccnz L_mv5_2
L_mb5_2:
    v_fma_f32 v176, v176, s96, v51
    v_mfma_f32_16x16x32_bf16 v[160:163], a[236:239], a[4:7], 0
    v_fma_f32 v177, v177, s96, v51
    v_exp_f32 v176, v176
    v_mfma_f32_16x16x32_bf16 v[164:167], a[236:239], a[8:11], 0
    v_exp_f32 v177, v177
    v_mfma_f32_16x16x32_bf16 v[168:171], a[236:239], a[12:15], 0
    v_fma_f32 v178, v178, s96, v51
    v_fma_f32 v179, v179, s96, v51
    v_exp_f32 v178, v178
    v_mfma_f32_16x16x32_bf16 v[172:175], a[236:239], a[16:19], 0
    s_waitcnt lgkmcnt(2)
    buffer_load_dwordx4 v13, s[32:35], s91 offen  lds
    v_mfma_f32_16x16x32_bf16 v[96:99], a[208:211], a[20:23], v[96:99]
    ds_read_b128 a[0:3], v32 offset:10240
    v_exp_f32 v179, v179
    v_mfma_f32_16x16x32_bf16 v[100:103], a[208:211], a[24:27], v[100:103]
    v_fma_f32 v196, v196, s96, v51
    v_fma_f32 v197, v197, s96, v51
    v_mfma_f32_16x16x32_bf16 v[104:107], a[208:211], a[28:31], v[104:107]
    ds_read_b128 a[4:7], v32 offset:11264
    v_exp_f32 v196, v196
    v_mfma_f32_16x16x32_bf16 v[108:111], a[208:211], a[32:35], v[108:111]
    v_exp_f32 v197, v197
    v_fma_f32 v198, v198, s96, v51
    v_mfma_f32_16x16x32_bf16 v[112:115], a[208:211], a[36:39], v[112:115]
    ds_read_b128 a[8:11], v32 offset:12288
    buffer_load_dwordx4 v14, s[32:35], s91 offen offset:1024  lds
    v_fma_f32 v199, v199, s96, v51
    v_mfma_f32_16x16x32_bf16 v[116:119], a[212:215], a[20:23], v[116:119]
    v_exp_f32 v198, v198
    v_cvt_pk_bf16_f32 v4, v176, v177
    v_mfma_f32_16x16x32_bf16 v[120:123], a[212:215], a[24:27], v[120:123]
    ds_read_b128 a[12:15], v32 offset:13312
    v_cvt_pk_bf16_f32 v5, v178, v179
    v_mfma_f32_16x16x32_bf16 v[124:127], a[212:215], a[28:31], v[124:127]
    s_waitcnt vmcnt(10)
    ds_read_b64_tr_b16 a[224:225], v21 offset:12288
    v_exp_f32 v199, v199
    v_mfma_f32_16x16x32_bf16 v[128:131], a[212:215], a[32:35], v[128:131]
    ds_read_b128 a[16:19], v32 offset:14336
    ds_read_b64_tr_b16 a[226:227], v21 offset:14336
    v_mfma_f32_16x16x32_bf16 v[132:135], a[212:215], a[36:39], v[132:135]
    ds_read_b64_tr_b16 a[228:229], v22 offset:12288
    ds_read_b64_tr_b16 a[230:231], v22 offset:14336
    v_cvt_pk_bf16_f32 v6, v196, v197
    v_mfma_f32_16x16x32_bf16 v[136:139], a[216:219], a[20:23], v[136:139]
    ds_read_b64_tr_b16 a[232:233], v23 offset:12288
    buffer_load_dwordx4 v15, s[32:35], s91 offen offset:2048  lds
    v_mfma_f32_16x16x32_bf16 v[140:143], a[216:219], a[24:27], v[140:143]
    ds_read_b64_tr_b16 a[234:235], v23 offset:14336
    v_cvt_pk_bf16_f32 v7, v198, v199
    v_mfma_f32_16x16x32_bf16 v[144:147], a[216:219], a[28:31], v[144:147]
    ds_read_b64_tr_b16 a[236:237], v24 offset:12288
    v_mfma_f32_16x16x32_bf16 v[148:151], a[216:219], a[32:35], v[148:151]
    ds_read_b64_tr_b16 a[238:239], v24 offset:14336
    ds_write_b128 v35, v[4:7] offset:40960
    v_mfma_f32_16x16x32_bf16 v[56:59], v[76:79], v[4:7], v[56:59]
    v_mfma_f32_16x16x32_bf16 v[152:155], a[216:219], a[36:39], v[152:155]
    buffer_load_dwordx4 v16, s[32:35], s91 offen offset:3072  lds
    v_mfma_f32_16x16x32_bf16 v[156:159], a[220:223], a[20:23], v[156:159]
    v_fma_f32 v180, v180, s96, v52
    v_fma_f32 v181, v181, s96, v52
    v_mfma_f32_16x16x32_bf16 v[160:163], a[220:223], a[24:27], v[160:163]
    v_exp_f32 v180, v180
    v_mfma_f32_16x16x32_bf16 v[164:167], a[220:223], a[28:31], v[164:167]
    v_exp_f32 v181, v181
    v_fma_f32 v182, v182, s96, v52
    v_fma_f32 v183, v183, s96, v52
    v_mfma_f32_16x16x32_bf16 v[168:171], a[220:223], a[32:35], v[168:171]
    v_exp_f32 v182, v182
    v_mfma_f32_16x16x32_bf16 v[172:175], a[220:223], a[36:39], v[172:175]
    s_add_u32 m0, s98, 12288
    s_xor_b32 s91, s90, 147456
    v_exp_f32 v183, v183
    s_waitcnt lgkmcnt(1)
    v_mfma_f32_16x16x32_bf16 v[96:99], a[192:195], a[0:3], v[96:99]
    ds_read_b128 a[20:23], v32 offset:15360
    v_fma_f32 v200, v200, s96, v52
    v_mfma_f32_16x16x32_bf16 v[100:103], a[192:195], a[4:7], v[100:103]
    v_fma_f32 v201, v201, s96, v52
    v_exp_f32 v200, v200
    v_mfma_f32_16x16x32_bf16 v[104:107], a[192:195], a[8:11], v[104:107]
    ds_read_b128 a[24:27], v32 offset:16384
    v_exp_f32 v201, v201
    v_mfma_f32_16x16x32_bf16 v[108:111], a[192:195], a[12:15], v[108:111]
    v_fma_f32 v202, v202, s96, v52
    v_fma_f32 v203, v203, s96, v52
    v_mfma_f32_16x16x32_bf16 v[112:115], a[192:195], a[16:19], v[112:115]
    ds_read_b128 a[28:31], v32 offset:17408
    v_exp_f32 v202, v202
    v_mfma_f32_16x16x32_bf16 v[116:119], a[196:199], a[0:3], v[116:119]
    buffer_load_dwordx4 v13, s[32:35], s91 offen  lds
    v_cvt_pk_bf16_f32 v8, v180, v181
    v_mfma_f32_16x16x32_bf16 v[120:123], a[196:199], a[4:7], v[120:123]
    ds_read_b128 a[32:35], v32 offset:18432
    v_cvt_pk_bf16_f32 v9, v182, v183
    v_mfma_f32_16x16x32_bf16 v[124:127], a[196:199], a[8:11], v[124:127]
    v_exp_f32 v203, v203
    v_cvt_pk_bf16_f32 v10, v200, v201
    v_mfma_f32_16x16x32_bf16 v[128:131], a[196:199], a[12:15], v[128:131]
    ds_read_b128 a[36:39], v32 offset:19456
    v_cvt_pk_bf16_f32 v11, v202, v203
    v_mfma_f32_16x16x32_bf16 v[132:135], a[196:199], a[16:19], v[132:135]
    buffer_load_dwordx4 v14, s[32:35], s91 offen offset:1024  lds
    v_mfma_f32_16x16x32_bf16 v[136:139], a[200:203], a[0:3], v[136:139]
    ds_write_b128 v35, v[8:11] offset:41984
    v_mfma_f32_16x16x32_bf16 v[60:63], v[76:79], v[8:11], v[60:63]
    v_mfma_f32_16x16x32_bf16 v[140:143], a[200:203], a[4:7], v[140:143]
    v_fma_f32 v184, v184, s96, v53
    v_mfma_f32_16x16x32_bf16 v[144:147], a[200:203], a[8:11], v[144:147]
    v_fma_f32 v185, v185, s96, v53
    v_exp_f32 v184, v184
    v_mfma_f32_16x16x32_bf16 v[148:151], a[200:203], a[12:15], v[148:151]
    s_waitcnt vmcnt(10)
    ds_read_b64_tr_b16 a[208:209], v21 offset:0
    v_mfma_f32_16x16x32_bf16 v[152:155], a[200:203], a[16:19], v[152:155]
    ds_read_b64_tr_b16 a[210:211], v21 offset:2048
    v_exp_f32 v185, v185
    v_fma_f32 v186, v186, s96, v53
    v_mfma_f32_16x16x32_bf16 v[156:159], a[204:207], a[0:3], v[156:159]
    ds_read_b64_tr_b16 a[212:213], v22 offset:0
    buffer_load_dwordx4 v15, s[32:35], s91 offen offset:2048  lds
    v_mfma_f32_16x16x32_bf16 v[160:163], a[204:207], a[4:7], v[160:163]
    ds_read_b64_tr_b16 a[214:215], v22 offset:2048
    v_fma_f32 v187, v187, s96, v53
    v_exp_f32 v186, v186
    v_mfma_f32_16x16x32_bf16 v[164:167], a[204:207], a[8:11], v[164:167]
    ds_read_b64_tr_b16 a[216:217], v23 offset:0
    v_mfma_f32_16x16x32_bf16 v[168:171], a[204:207], a[12:15], v[168:171]
    ds_read_b64_tr_b16 a[218:219], v23 offset:2048
    v_exp_f32 v187, v187
    v_fma_f32 v204, v204, s96, v53
    v_mfma_f32_16x16x32_bf16 v[172:175], a[204:207], a[16:19], v[172:175]
    ds_read_b64_tr_b16 a[220:221], v24 offset:0
    v_fma_f32 v205, v205, s96, v53
    s_waitcnt lgkmcnt(8)
    v_mfma_f32_16x16x32_bf16 v[96:99], a[176:179], a[20:23], v[96:99]
    ds_read_b128 a[0:3], v32 offset:20480
    ds_read_b64_tr_b16 a[222:223], v24 offset:2048
    v_exp_f32 v204, v204
    v_mfma_f32_16x16x32_bf16 v[100:103], a[176:179], a[24:27], v[100:103]
    buffer_load_dwordx4 v16, s[32:35], s91 offen offset:3072  lds
    v_mfma_f32_16x16x32_bf16 v[104:107], a[176:179], a[28:31], v[104:107]
    ds_read_b128 a[4:7], v32 offset:21504
    v_exp_f32 v205, v205
    v_fma_f32 v206, v206, s96, v53
    v_mfma_f32_16x16x32_bf16 v[108:111], a[176:179], a[32:35], v[108:111]
    v_fma_f32 v207, v207, s96, v53
    v_exp_f32 v206, v206
    v_mfma_f32_16x16x32_bf16 v[112:115], a[176:179], a[36:39], v[112:115]
    ds_read_b128 a[8:11], v32 offset:22528
    v_cvt_pk_bf16_f32 v4, v184, v185
    v_mfma_f32_16x16x32_bf16 v[116:119], a[180:183], a[20:23], v[116:119]
    v_cvt_pk_bf16_f32 v5, v186, v187
    v_exp_f32 v207, v207
    v_mfma_f32_16x16x32_bf16 v[120:123], a[180:183], a[24:27], v[120:123]
    ds_read_b128 a[12:15], v32 offset:23552
    v_cvt_pk_bf16_f32 v6, v204, v205
    v_cvt_pk_bf16_f32 v7, v206, v207
    v_mfma_f32_16x16x32_bf16 v[124:127], a[180:183], a[28:31], v[124:127]
    s_add_u32 m0, s98, 0
    s_xor_b32 s91, s90, 163840
    v_mfma_f32_16x16x32_bf16 v[128:131], a[180:183], a[32:35], v[128:131]
    ds_read_b128 a[16:19], v32 offset:24576
    v_mfma_f32_16x16x32_bf16 v[132:135], a[180:183], a[36:39], v[132:135]
    ds_write_b128 v35, v[4:7] offset:43008
    v_mfma_f32_16x16x32_bf16 v[64:67], v[76:79], v[4:7], v[64:67]
    v_mfma_f32_16x16x32_bf16 v[136:139], a[184:187], a[20:23], v[136:139]
    v_mfma_f32_16x16x32_bf16 v[140:143], a[184:187], a[24:27], v[140:143]
    s_waitcnt lgkmcnt(4)
    buffer_load_dwordx4 v13, s[32:35], s91 offen  lds
    v_fma_f32 v188, v188, s96, v54
    v_mfma_f32_16x16x32_bf16 v[144:147], a[184:187], a[28:31], v[144:147]
    v_fma_f32 v189, v189, s96, v54
    v_exp_f32 v188, v188
    v_mfma_f32_16x16x32_bf16 v[148:151], a[184:187], a[32:35], v[148:151]
    v_exp_f32 v189, v189
    v_fma_f32 v190, v190, s96, v54
    v_mfma_f32_16x16x32_bf16 v[152:155], a[184:187], a[36:39], v[152:155]
    v_fma_f32 v191, v191, s96, v54
    v_exp_f32 v190, v190
    v_mfma_f32_16x16x32_bf16 v[156:159], a[188:191], a[20:23], v[156:159]
    v_exp_f32 v191, v191
    v_mfma_f32_16x16x32_bf16 v[160:163], a[188:191], a[24:27], v[160:163]
    buffer_load_dwordx4 v14, s[32:35], s91 offen offset:1024  lds
    v_fma_f32 v208, v208, s96, v54
    v_fma_f32 v209, v209, s96, v54
    v_mfma_f32_16x16x32_bf16 v[164:167], a[188:191], a[28:31], v[164:167]
    v_exp_f32 v208, v208
    v_mfma_f32_16x16x32_bf16 v[168:171], a[188:191], a[32:35], v[168:171]
    v_exp_f32 v209, v209
    v_fma_f32 v210, v210, s96, v54
    v_fma_f32 v211, v211, s96, v54
    v_mfma_f32_16x16x32_bf16 v[172:175], a[188:191], a[36:39], v[172:175]
    v_exp_f32 v210, v210
    s_bitcmp1_b32 s4, 1
    s_cbranch_scc1 L_rs5_1
L_rb5_1:
    v_mfma_f32_16x16x32_bf16 v[96:99], a[240:243], a[0:3], v[96:99]
    ds_read_b128 a[20:23], v32 offset:25600
    v_cvt_pk_bf16_f32 v8, v188, v189
    v_cvt_pk_bf16_f32 v9, v190, v191
    v_mfma_f32_16x16x32_bf16 v[100:103], a[240:243], a[4:7], v[100:103]
    s_waitcnt vmcnt(10)
    ds_read_b64_tr_b16 a[192:193], v21 offset:4096
    v_exp_f32 v211, v211
    s_waitcnt lgkmcnt(3)
    v_mfma_f32_16x16x32_bf16 v[104:107], a[240:243], a[8:11], v[104:107]
    ds_read_b128 a[24:27], v32 offset:26624
    ds_read_b64_tr_b16 a[194:195], v21 offset:6144
    v_mfma_f32_16x16x32_bf16 v[108:111], a[240:243], a[12:15], v[108:111]
    ds_read_b64_tr_b16 a[196:197], v22 offset:4096
    ds_read_b64_tr_b16 a[198:199], v22 offset:6144
    v_cvt_pk_bf16_f32 v10, v208, v209
    v_mfma_f32_16x16x32_bf16 v[112:115], a[240:243], a[16:19], v[112:115]
    ds_read_b128 a[28:31], v32 offset:27648
    ds_read_b64_tr_b16 a[200:201], v23 offset:4096
    v_mfma_f32_16x16x32_bf16 v[116:119], a[244:247], a[0:3], v[116:119]
    ds_read_b64_tr_b16 a[202:203], v23 offset:6144
    buffer_load_dwordx4 v15, s[32:35], s91 offen offset:2048  lds
    v_cvt_pk_bf16_f32 v11, v210, v211
    v_mfma_f32_16x16x32_bf16 v[120:123], a[244:247], a[4:7], v[120:123]
    ds_read_b128 a[32:35], v32 offset:28672
    ds_read_b64_tr_b16 a[204:205], v24 offset:4096
    v_mfma_f32_16x16x32_bf16 v[124:127], a[244:247], a[8:11], v[124:127]
    ds_read_b64_tr_b16 a[206:207], v24 offset:6144
    buffer_load_dwordx4 v16, s[32:35], s91 offen offset:3072  lds
    v_mfma_f32_16x16x32_bf16 v[128:131], a[244:247], a[12:15], v[128:131]
    ds_read_b128 a[36:39], v32 offset:29696
    v_mfma_f32_16x16x32_bf16 v[132:135], a[244:247], a[16:19], v[132:135]
    ds_write_b128 v35, v[8:11] offset:44032
    v_mfma_f32_16x16x32_bf16 v[68:71], v[76:79], v[8:11], v[68:71]
    v_mfma_f32_16x16x32_bf16 v[136:139], a[248:251], a[0:3], v[136:139]
    v_fma_f32 v192, v192, s96, v55
    v_fma_f32 v193, v193, s96, v55
    v_mfma_f32_16x16x32_bf16 v[140:143], a[248:251], a[4:7], v[140:143]
    v_exp_f32 v192, v192
    v_mfma_f32_16x16x32_bf16 v[144:147], a[248:251], a[8:11], v[144:147]
    v_exp_f32 v193, v193
    v_fma_f32 v194, v194, s96, v55
    v_mfma_f32_16x16x32_bf16 v[148:151], a[248:251], a[12:15], v[148:151]
    s_add_u32 m0, s98, 4096
    s_xor_b32 s91, s90, 180224
    v_fma_f32 v195, v195, s96, v55
    v_mfma_f32_16x16x32_bf16 v[152:155], a[248:251], a[16:19], v[152:155]
    v_exp_f32 v194, v194
    v_mfma_f32_16x16x32_bf16 v[156:159], a[252:255], a[0:3], v[156:159]
    v_exp_f32 v195, v195
    v_fma_f32 v212, v212, s96, v55
    v_mfma_f32_16x16x32_bf16 v[160:163], a[252:255], a[4:7], v[160:163]
    v_fma_f32 v213, v213, s96, v55
    v_exp_f32 v212, v212
    v_mfma_f32_16x16x32_bf16 v[164:167], a[252:255], a[8:11], v[164:167]
    v_exp_f32 v213, v213
    v_fma_f32 v214, v214, s96, v55
    v_mfma_f32_16x16x32_bf16 v[168:171], a[252:255], a[12:15], v[168:171]
    s_waitcnt lgkmcnt(1)
    buffer_load_dwordx4 v13, s[32:35], s91 offen  lds
    v_fma_f32 v215, v215, s96, v55
    v_mfma_f32_16x16x32_bf16 v[172:175], a[252:255], a[16:19], v[172:175]
    v_exp_f32 v214, v214
    v_cvt_pk_bf16_f32 v4, v192, v193
    v_mfma_f32_16x16x32_bf16 v[96:99], a[224:227], a[20:23], v[96:99]
    ds_read_b128 a[0:3], v32 offset:30720
    v_cvt_pk_bf16_f32 v5, v194, v195
    v_mfma_f32_16x16x32_bf16 v[100:103], a[224:227], a[24:27], v[100:103]
    v_exp_f32 v215, v215
    v_cvt_pk_bf16_f32 v6, v212, v213
    v_mfma_f32_16x16x32_bf16 v[104:107], a[224:227], a[28:31], v[104:107]
    ds_read_b128 a[4:7], v32 offset:31744
    v_cvt_pk_bf16_f32 v7, v214, v215
    v_mfma_f32_16x16x32_bf16 v[108:111], a[224:227], a[32:35], v[108:111]
    buffer_load_dwordx4 v14, s[32:35], s91 offen offset:1024  lds
    v_mfma_f32_16x16x32_bf16 v[112:115], a[224:227], a[36:39], v[112:115]
    ds_read_b128 a[8:11], v32 offset:32768
    ds_write_b128 v35, v[4:7] offset:45056
    v_mfma_f32_16x16x32_bf16 v[72:75], v[76:79], v[4:7], v[72:75]
    v_mfma_f32_16x16x32_bf16 v[116:119], a[228:231], a[20:23], v[116:119]
    v_mfma_f32_16x16x32_bf16 v[120:123], a[228:231], a[24:27], v[120:123]
    ds_read_b128 a[12:15], v32 offset:33792
    v_mfma_f32_16x16x32_bf16 v[124:127], a[228:231], a[28:31], v[124:127]
    s_waitcnt vmcnt(10)
    ds_read_b64_tr_b16 a[240:241], v21 offset:8192
    v_mfma_f32_16x16x32_bf16 v[128:131], a[228:231], a[32:35], v[128:131]
    ds_read_b128 a[16:19], v32 offset:34816
    ds_read_b64_tr_b16 a[242:243], v21 offset:10240
    v_mfma_f32_16x16x32_bf16 v[132:135], a[228:231], a[36:39], v[132:135]
    ds_read_b64_tr_b16 a[244:245], v22 offset:8192
    ds_read_b64_tr_b16 a[246:247], v22 offset:10240
    v_mfma_f32_16x16x32_bf16 v[136:139], a[232:235], a[20:23], v[136:139]
    s_waitcnt lgkmcnt(6)
    s_barrier
    ds_read_b128 v[4:7], v38 offset:1536
    ds_read_b128 v[8:11], v38 offset:1792
    v_mfma_f32_16x16x32_bf16 v[140:143], a[232:235], a[24:27], v[140:143]
    ds_read_b64_tr_b16 a[248:249], v23 offset:8192
    ds_read_b64_tr_b16 a[250:251], v23 offset:10240
    v_mfma_f32_16x16x32_bf16 v[144:147], a[232:235], a[28:31], v[144:147]
    ds_read_b64_tr_b16 a[252:253], v24 offset:8192
    buffer_load_dwordx4 v15, s[32:35], s91 offen offset:2048  lds
    v_mfma_f32_16x16x32_bf16 v[148:151], a[232:235], a[32:35], v[148:151]
    ds_read_b64_tr_b16 a[254:255], v24 offset:10240
    buffer_load_dwordx4 v16, s[32:35], s91 offen offset:3072  lds
    v_mfma_f32_16x16x32_bf16 v[152:155], a[232:235], a[36:39], v[152:155]
    v_mfma_f32_16x16x32_bf16 v[156:159], a[236:239], a[20:23], v[156:159]
    v_mfma_f32_16x16x32_bf16 v[160:163], a[236:239], a[24:27], v[160:163]
    v_mfma_f32_16x16x32_bf16 v[164:167], a[236:239], a[28:31], v[164:167]
    s_waitcnt lgkmcnt(4)
    v_max3_f32 v8, v8, v9, v10
    v_max_f32 v8, v8, v11
    v_fma_f32 v90, v4, s96, v51
    v_mfma_f32_16x16x32_bf16 v[168:171], a[236:239], a[32:35], v[168:171]
    v_fma_f32 v91, v5, s96, v52
    v_fma_f32 v92, v6, s96, v53
    v_mfma_f32_16x16x32_bf16 v[172:175], a[236:239], a[36:39], v[172:175]
    s_add_u32 m0, s98, 8192
    s_xor_b32 s91, s90, 196608
    v_fma_f32 v93, v7, s96, v54
    v_mfma_f32_16x16x32_bf16 v[96:99], a[208:211], a[0:3], v[96:99]
    ds_read_b128 a[20:23], v32 offset:35840
    v_fma_f32 v94, v8, s96, v55
    v_mfma_f32_16x16x32_bf16 v[100:103], a[208:211], a[4:7], v[100:103]
    v_max3_f32 v9, v90, v91, v92
    v_max3_f32 v9, v9, v93, v94
    v_mfma_f32_16x16x32_bf16 v[104:107], a[208:211], a[8:11], v[104:107]
    ds_read_b128 a[24:27], v32 offset:36864
    v_cmp_lt_f32 vcc, 0x41200000, v9
    s_cbranch_vccnz L_mv5_3
L_mb5_3:
    v_fma_f32 v216, v216, s96, v51
    v_mfma_f32_16x16x32_bf16 v[108:111], a[208:211], a[12:15], v[108:111]
    v_fma_f32 v217, v217, s96, v51
    v_exp_f32 v216, v216
    v_mfma_f32_16x16x32_bf16 v[112:115], a[208:211], a[16:19], v[112:115]
    ds_read_b128 a[28:31], v32 offset:37888
    v_mfma_f32_16x16x32_bf16 v[116:119], a[212:215], a[0:3], v[116:119]
    s_waitcnt lgkmcnt(3)
    buffer_load_dwordx4 v13, s[32:35], s91 offen  lds
    v_exp_f32 v217, v217
    v_mfma_f32_16x16x32_bf16 v[120:123], a[212:215], a[4:7], v[120:123]
    ds_read_b128 a[32:35], v32 offset:38912
    v_fma_f32 v218, v218, s96, v51
    v_mfma_f32_16x16x32_bf16 v[124:127], a[212:215], a[8:11], v[124:127]
    v_fma_f32 v219, v219, s96, v51
    v_exp_f32 v218, v218
    v_mfma_f32_16x16x32_bf16 v[128:131], a[212:215], a[12:15], v[128:131]
    ds_read_b128 a[36:39], v32 offset:39936
    v_exp_f32 v219, v219
    v_mfma_f32_16x16x32_bf16 v[132:135], a[212:215], a[16:19], v[132:135]
    buffer_load_dwordx4 v14, s[32:35], s91 offen offset:1024  lds
    v_fma_f32 v236, v236, s96, v51
    v_mfma_f32_16x16x32_bf16 v[136:139], a[216:219], a[0:3], v[136:139]
    v_fma_f32 v237, v237, s96, v51
    v_exp_f32 v236, v236
    v_mfma_f32_16x16x32_bf16 v[140:143], a[216:219], a[4:7], v[140:143]
    v_exp_f32 v237, v237
    v_mfma_f32_16x16x32_bf16 v[144:147], a[216:219], a[8:11], v[144:147]
    v_fma_f32 v238, v238, s96, v51
    v_fma_f32 v239, v239, s96, v51
    v_mfma_f32_16x16x32_bf16 v[148:151], a[216:219], a[12:15], v[148:151]
    s_waitcnt vmcnt(10)
    ds_read_b64_tr_b16 a[224:225], v21 offset:12288
    v_exp_f32 v238, v238
    v_mfma_f32_16x16x32_bf16 v[152:155], a[216:219], a[16:19], v[152:155]
    ds_read_b64_tr_b16 a[226:227], v21 offset:14336
    v_cvt_pk_bf16_f32 v4, v216, v217
    v_mfma_f32_16x16x32_bf16 v[156:159], a[220:223], a[0:3], v[156:159]
    ds_read_b64_tr_b16 a[228:229], v22 offset:12288
    buffer_load_dwordx4 v15, s[32:35], s91 offen offset:2048  lds
    v_cvt_pk_bf16_f32 v5, v218, v219
    v_mfma_f32_16x16x32_bf16 v[160:163], a[220:223], a[4:7], v[160:163]
    ds_read_b64_tr_b16 a[230:231], v22 offset:14336
    v_exp_f32 v239, v239
    v_mfma_f32_16x16x32_bf16 v[164:167], a[220:223], a[8:11], v[164:167]
    ds_read_b64_tr_b16 a[232:233], v23 offset:12288
    v_cvt_pk_bf16_f32 v6, v236, v237
    v_mfma_f32_16x16x32_bf16 v[168:171], a[220:223], a[12:15], v[168:171]
    ds_read_b64_tr_b16 a[234:235], v23 offset:14336
    v_cvt_pk_bf16_f32 v7, v238, v239
    v_mfma_f32_16x16x32_bf16 v[172:175], a[220:223], a[16:19], v[172:175]
    ds_read_b64_tr_b16 a[236:237], v24 offset:12288
    s_waitcnt lgkmcnt(7)
    v_mfma_f32_16x16x32_bf16 v[96:99], a[192:195], a[20:23], v[96:99]
    ds_read_b128 a[0:3], v33 offset:0
    ds_read_b64_tr_b16 a[238:239], v24 offset:14336
    v_mfma_f32_16x16x32_bf16 v[100:103], a[192:195], a[24:27], v[100:103]
    buffer_load_dwordx4 v16, s[32:35], s91 offen offset:3072  lds
    v_mfma_f32_16x16x32_bf16 v[104:107], a[192:195], a[28:31], v[104:107]
    ds_read_b128 a[4:7], v33 offset:1024
    v_mfma_f32_16x16x32_bf16 v[108:111], a[192:195], a[32:35], v[108:111]
    v_fma_f32 v220, v220, s96, v52
    v_fma_f32 v221, v221, s96, v52
    v_mfma_f32_16x16x32_bf16 v[112:115], a[192:195], a[36:39], v[112:115]
    ds_read_b128 a[8:11], v33 offset:2048
    v_exp_f32 v220, v220
    v_mfma_f32_16x16x32_bf16 v[116:119], a[196:199], a[20:23], v[116:119]
    v_exp_f32 v221, v221
    v_mfma_f32_16x16x32_bf16 v[120:123], a[196:199], a[24:27], v[120:123]
    ds_read_b128 a[12:15], v33 offset:3072
    v_fma_f32 v222, v222, s96, v52
    v_mfma_f32_16x16x32_bf16 v[124:127], a[196:199], a[28:31], v[124:127]
    s_add_u32 m0, s98, 12288
    s_xor_b32 s91, s90, 212992
    v_fma_f32 v223, v223, s96, v52
    v_mfma_f32_16x16x32_bf16 v[128:131], a[196:199], a[32:35], v[128:131]
    ds_read_b128 a[16:19], v33 offset:4096
    ds_write_b128 v35, v[4:7] offset:61440
    v_mfma_f32_16x16x32_bf16 v[56:59], v[76:79], v[4:7], v[56:59]
    v_exp_f32 v222, v222
    v_mfma_f32_16x16x32_bf16 v[132:135], a[196:199], a[36:39], v[132:135]
    v_exp_f32 v223, v223
    v_mfma_f32_16x16x32_bf16 v[136:139], a[200:203], a[20:23], v[136:139]
    v_fma_f32 v240, v240, s96, v52
    v_fma_f32 v241, v241, s96, v52
    v_mfma_f32_16x16x32_bf16 v[140:143], a[200:203], a[24:27], v[140:143]
    s_waitcnt lgkmcnt(3)
    buffer_load_dwordx4 v13, s[32:35], s91 offen  lds
    v_exp_f32 v240, v240
    v_mfma_f32_16x16x32_bf16 v[144:147], a[200:203], a[28:31], v[144:147]
    v_exp_f32 v241, v241
    v_mfma_f32_16x16x32_bf16 v[148:151], a[200:203], a[32:35], v[148:151]
    v_fma_f32 v242, v242, s96, v52
    v_fma_f32 v243, v243, s96, v52
    v_mfma_f32_16x16x32_bf16 v[152:155], a[200:203], a[36:39], v[152:155]
    v_exp_f32 v242, v242
    v_cvt_pk_bf16_f32 v8, v220, v221
    v_mfma_f32_16x16x32_bf16 v[156:159], a[204:207], a[20:23], v[156:159]
    v_cvt_pk_bf16_f32 v9, v222, v223
    v_exp_f32 v243, v243
    v_mfma_f32_16x16x32_bf16 v[160:163], a[204:207], a[24:27], v[160:163]
    buffer_load_dwordx4 v14, s[32:35], s91 offen offset:1024  lds
    v_cvt_pk_bf16_f32 v10, v240, v241
    v_cvt_pk_bf16_f32 v11, v242, v243
    v_mfma_f32_16x16x32_bf16 v[164:167], a[204:207], a[28:31], v[164:167]
    v_mfma_f32_16x16x32_bf16 v[168:171], a[204:207], a[32:35], v[168:171]
    v_mfma_f32_16x16x32_bf16 v[172:175], a[204:207], a[36:39], v[172:175]
    s_bitcmp1_b32 s4, 2
    s_cbranch_scc1 L_rs5_2
L_rb5_2:
    v_mfma_f32_16x16x32_bf16 v[96:99], a[240:243], a[0:3], v[96:99]
    ds_read_b128 a[20:23], v33 offset:5120
    v_fma_f32 v224, v224, s96, v53
    v_fma_f32 v225, v225, s96, v53
    v_mfma_f32_16x16x32_bf16 v[100:103], a[240:243], a[4:7], v[100:103]
    s_waitcnt vmcnt(10)
    ds_read_b64_tr_b16 a[208:209], v21 offset:0
    v_mfma_f32_16x16x32_bf16 v[104:107], a[240:243], a[8:11], v[104:107]
    ds_read_b128 a[24:27], v33 offset:6144
    ds_read_b64_tr_b16 a[210:211], v21 offset:2048
    v_exp_f32 v224, v224
    s_waitcnt lgkmcnt(5)
    v_mfma_f32_16x16x32_bf16 v[108:111], a[240:243], a[12:15], v[108:111]
    ds_read_b64_tr_b16 a[212:213], v22 offset:0
    ds_read_b64_tr_b16 a[214:215], v22 offset:2048
    v_mfma_f32_16x16x32_bf16 v[112:115], a[240:243], a[16:19], v[112:115]
    ds_read_b128 a[28:31], v33 offset:7168
    ds_read_b64_tr_b16 a[216:217], v23 offset:0
    v_mfma_f32_16x16x32_bf16 v[116:119], a[244:247], a[0:3], v[116:119]
    ds_read_b64_tr_b16 a[218:219], v23 offset:2048
    buffer_load_dwordx4 v15, s[32:35], s91 offen offset:2048  lds
    v_exp_f32 v225, v225
    v_mfma_f32_16x16x32_bf16 v[120:123], a[244:247], a[4:7], v[120:123]
    ds_read_b128 a[32:35], v33 offset:8192
    ds_read_b64_tr_b16 a[220:221], v24 offset:0
    v_mfma_f32_16x16x32_bf16 v[124:127], a[244:247], a[8:11], v[124:127]
    ds_read_b64_tr_b16 a[222:223], v24 offset:2048
    buffer_load_dwordx4 v16, s[32:35], s91 offen offset:3072  lds
    v_fma_f32 v226, v226, s96, v53
    v_mfma_f32_16x16x32_bf16 v[128:131], a[244:247], a[12:15], v[128:131]
    ds_read_b128 a[36:39], v33 offset:9216
    ds_write_b128 v35, v[8:11] offset:62464
    v_mfma_f32_16x16x32_bf16 v[60:63], v[76:79], v[8:11], v[60:63]
    v_fma_f32 v227, v227, s96, v53
    v_mfma_f32_16x16x32_bf16 v[132:135], a[244:247], a[16:19], v[132:135]
    v_exp_f32 v226, v226
    v_mfma_f32_16x16x32_bf16 v[136:139], a[248:251], a[0:3], v[136:139]
    v_exp_f32 v227, v227
    v_fma_f32 v244, v244, s96, v53
    v_mfma_f32_16x16x32_bf16 v[140:143], a[248:251], a[4:7], v[140:143]
    v_fma_f32 v245, v245, s96, v53
    v_exp_f32 v244, v244
    v_mfma_f32_16x16x32_bf16 v[144:147], a[248:251], a[8:11], v[144:147]
    v_exp_f32 v245, v245
    v_fma_f32 v246, v246, s96, v53
    v_mfma_f32_16x16x32_bf16 v[148:151], a[248:251], a[12:15], v[148:151]
    s_add_u32 m0, s98, 0
    s_xor_b32 s91, s90, 229376
    v_mfma_f32_16x16x32_bf16 v[152:155], a[248:251], a[16:19], v[152:155]
    v_fma_f32 v247, v247, s96, v53
    v_exp_f32 v246, v246
    v_mfma_f32_16x16x32_bf16 v[156:159], a[252:255], a[0:3], v[156:159]
    v_cvt_pk_bf16_f32 v4, v224, v225
    v_cvt_pk_bf16_f32 v5, v226, v227
    v_mfma_f32_16x16x32_bf16 v[160:163], a[252:255], a[4:7], v[160:163]
    v_exp_f32 v247, v247
    v_cvt_pk_bf16_f32 v6, v244, v245
    v_mfma_f32_16x16x32_bf16 v[164:167], a[252:255], a[8:11], v[164:167]
    v_cvt_pk_bf16_f32 v7, v246, v247
    v_mfma_f32_16x16x32_bf16 v[168:171], a[252:255], a[12:15], v[168:171]
    s_waitcnt lgkmcnt(1)
    buffer_load_dwordx4 v13, s[32:35], s91 offen  lds
    v_mfma_f32_16x16x32_bf16 v[172:175], a[252:255], a[16:19], v[172:175]
    v_mfma_f32_16x16x32_bf16 v[96:99], a[224:227], a[20:23], v[96:99]
    ds_read_b128 a[0:3], v33 offset:10240
    ds_write_b128 v35, v[4:7] offset:63488
    v_mfma_f32_16x16x32_bf16 v[64:67], v[76:79], v[4:7], v[64:67]
    v_mfma_f32_16x16x32_bf16 v[100:103], a[224:227], a[24:27], v[100:103]
    v_fma_f32 v228, v228, s96, v54
    v_fma_f32 v229, v229, s96, v54
    v_mfma_f32_16x16x32_bf16 v[104:107], a[224:227], a[28:31], v[104:107]
    ds_read_b128 a[4:7], v33 offset:11264
    v_exp_f32 v228, v228
    v_mfma_f32_16x16x32_bf16 v[108:111], a[224:227], a[32:35], v[108:111]
    buffer_load_dwordx4 v14, s[32:35], s91 offen offset:1024  lds
    v_exp_f32 v229, v229
    v_mfma_f32_16x16x32_bf16 v[112:115], a[224:227], a[36:39], v[112:115]
    ds_read_b128 a[8:11], v33 offset:12288
    v_fma_f32 v230, v230, s96, v54
    v_mfma_f32_16x16x32_bf16 v[116:119], a[228:231], a[20:23], v[116:119]
    v_fma_f32 v231, v231, s96, v54
    v_exp_f32 v230, v230
    v_mfma_f32_16x16x32_bf16 v[120:123], a[228:231], a[24:27], v[120:123]
    ds_read_b128 a[12:15], v33 offset:13312
    v_exp_f32 v231, v231
    v_mfma_f32_16x16x32_bf16 v[124:127], a[228:231], a[28:31], v[124:127]
    s_waitcnt vmcnt(10)
    ds_read_b64_tr_b16 a[240:241], v21 offset:4096
    v_mfma_f32_16x16x32_bf16 v[128:131], a[228:231], a[32:35], v[128:131]
    ds_read_b128 a[16:19], v33 offset:14336
    ds_read_b64_tr_b16 a[242:243], v21 offset:6144
    v_fma_f32 v248, v248, s96, v54
    v_mfma_f32_16x16x32_bf16 v[132:135], a[228:231], a[36:39], v[132:135]
    ds_read_b64_tr_b16 a[244:245], v22 offset:4096
    ds_read_b64_tr_b16 a[246:247], v22 offset:6144
    v_mfma_f32_16x16x32_bf16 v[136:139], a[232:235], a[20:23], v[136:139]
    ds_read_b64_tr_b16 a[248:249], v23 offset:4096
    buffer_load_dwordx4 v15, s[32:35], s91 offen offset:2048  lds
    v_fma_f32 v249, v249, s96, v54
    v_mfma_f32_16x16x32_bf16 v[140:143], a[232:235], a[24:27], v[140:143]
    ds_read_b64_tr_b16 a[250:251], v23 offset:6144
    v_exp_f32 v248, v248
    v_mfma_f32_16x16x32_bf16 v[144:147], a[232:235], a[28:31], v[144:147]
    ds_read_b64_tr_b16 a[252:253], v24 offset:4096
    v_mfma_f32_16x16x32_bf16 v[148:151], a[232:235], a[32:35], v[148:151]
    ds_read_b64_tr_b16 a[254:255], v24 offset:6144
    buffer_load_dwordx4 v16, s[32:35], s91 offen offset:3072  lds
    v_exp_f32 v249, v249
    v_mfma_f32_16x16x32_bf16 v[152:155], a[232:235], a[36:39], v[152:155]
    v_fma_f32 v250, v250, s96, v54
    v_fma_f32 v251, v251, s96, v54
    v_mfma_f32_16x16x32_bf16 v[156:159], a[236:239], a[20:23], v[156:159]
    v_exp_f32 v250, v250
    v_cvt_pk_bf16_f32 v8, v228, v229
    v_mfma_f32_16x16x32_bf16 v[160:163], a[236:239], a[24:27], v[160:163]
    v_cvt_pk_bf16_f32 v9, v230, v231
    v_exp_f32 v251, v251
    v_mfma_f32_16x16x32_bf16 v[164:167], a[236:239], a[28:31], v[164:167]
    v_cvt_pk_bf16_f32 v10, v248, v249
    v_cvt_pk_bf16_f32 v11, v250, v251
    v_mfma_f32_16x16x32_bf16 v[168:171], a[236:239], a[32:35], v[168:171]
    v_mfma_f32_16x16x32_bf16 v[172:175], a[236:239], a[36:39], v[172:175]
    s_add_u32 m0, s98, 4096
    s_xor_b32 s91, s90, 245760
    s_waitcnt lgkmcnt(1)
    v_mfma_f32_16x16x32_bf16 v[96:99], a[208:211], a[0:3], v[96:99]
    ds_read_b128 a[20:23], v33 offset:15360
    v_mfma_f32_16x16x32_bf16 v[100:103], a[208:211], a[4:7], v[100:103]
    v_mfma_f32_16x16x32_bf16 v[104:107], a[208:211], a[8:11], v[104:107]
    ds_read_b128 a[24:27], v33 offset:16384
    v_fma_f32 v232, v232, s96, v55
    v_fma_f32 v233, v233, s96, v55
    v_mfma_f32_16x16x32_bf16 v[108:111], a[208:211], a[12:15], v[108:111]
    v_exp_f32 v232, v232
    v_mfma_f32_16x16x32_bf16 v[112:115], a[208:211], a[16:19], v[112:115]
    ds_read_b128 a[28:31], v33 offset:17408
    v_exp_f32 v233, v233
    v_mfma_f32_16x16x32_bf16 v[116:119], a[212:215], a[0:3], v[116:119]
    s_waitcnt lgkmcnt(3)
    buffer_load_dwordx4 v13, s[32:35], s91 offen  lds
    v_fma_f32 v234, v234, s96, v55
    v_mfma_f32_16x16x32_bf16 v[120:123], a[212:215], a[4:7], v[120:123]
    ds_read_b128 a[32:35], v33 offset:18432
    v_fma_f32 v235, v235, s96, v55
    v_mfma_f32_16x16x32_bf16 v[124:127], a[212:215], a[8:11], v[124:127]
    v_exp_f32 v234, v234
    v_exp_f32 v235, v235
    v_mfma_f32_16x16x32_bf16 v[128:131], a[212:215], a[12:15], v[128:131]
    ds_read_b128 a[36:39], v33 offset:19456
    ds_write_b128 v35, v[8:11] offset:64512
    v_mfma_f32_16x16x32_bf16 v[68:71], v[76:79], v[8:11], v[68:71]
    v_fma_f32 v252, v252, s96, v55
    v_mfma_f32_16x16x32_bf16 v[132:135], a[212:215], a[16:19], v[132:135]
    buffer_load_dwordx4 v14, s[32:35], s91 offen offset:1024  lds
    v_fma_f32 v253, v253, s96, v55
    v_mfma_f32_16x16x32_bf16 v[136:139], a[216:219], a[0:3], v[136:139]
    v_exp_f32 v252, v252
    v_exp_f32 v253, v253
    v_mfma_f32_16x16x32_bf16 v[140:143], a[216:219], a[4:7], v[140:143]
    v_fma_f32 v254, v254, s96, v55
    v_fma_f32 v255, v255, s96, v55
    v_mfma_f32_16x16x32_bf16 v[144:147], a[216:219], a[8:11], v[144:147]
    v_exp_f32 v254, v254
    v_mfma_f32_16x16x32_bf16 v[148:151], a[216:219], a[12:15], v[148:151]
    s_waitcnt vmcnt(10)
    ds_read_b64_tr_b16 a[224:225], v21 offset:8192
    v_cvt_pk_bf16_f32 v4, v232, v233
    v_mfma_f32_16x16x32_bf16 v[152:155], a[216:219], a[16:19], v[152:155]
    ds_read_b64_tr_b16 a[226:227], v21 offset:10240
    v_cvt_pk_bf16_f32 v5, v234, v235
    v_mfma_f32_16x16x32_bf16 v[156:159], a[220:223], a[0:3], v[156:159]
    ds_read_b64_tr_b16 a[228:229], v22 offset:8192
    buffer_load_dwordx4 v15, s[32:35], s91 offen offset:2048  lds
    v_exp_f32 v255, v255
    v_mfma_f32_16x16x32_bf16 v[160:163], a[220:223], a[4:7], v[160:163]
    ds_read_b64_tr_b16 a[230:231], v22 offset:10240
    v_cvt_pk_bf16_f32 v6, v252, v253
    v_mfma_f32_16x16x32_bf16 v[164:167], a[220:223], a[8:11], v[164:167]
    ds_read_b64_tr_b16 a[232:233], v23 offset:8192
    v_cvt_pk_bf16_f32 v7, v254, v255
    v_mfma_f32_16x16x32_bf16 v[168:171], a[220:223], a[12:15], v[168:171]
    ds_read_b64_tr_b16 a[234:235], v23 offset:10240
    v_mfma_f32_16x16x32_bf16 v[172:175], a[220:223], a[16:19], v[172:175]
    ds_read_b64_tr_b16 a[236:237], v24 offset:8192
    s_waitcnt lgkmcnt(8)
    v_mfma_f32_16x16x32_bf16 v[96:99], a[240:243], a[20:23], v[96:99]
    ds_read_b64_tr_b16 a[238:239], v24 offset:10240
    buffer_load_dwordx4 v16, s[32:35], s91 offen offset:3072  lds
    ds_write_b128 v45, v[4:7] offset:24576
    v_mfma_f32_16x16x32_bf16 v[72:75], v[76:79], v[4:7], v[72:75]
    v_mfma_f32_16x16x32_bf16 v[100:103], a[240:243], a[24:27], v[100:103]
    v_mfma_f32_16x16x32_bf16 v[104:107], a[240:243], a[28:31], v[104:107]
    ds_write_b32 v37, v56 offset:2048
    ds_write_b32 v37, v60 offset:2304
    v_mfma_f32_16x16x32_bf16 v[108:111], a[240:243], a[32:35], v[108:111]
    ds_write_b32 v37, v64 offset:2560
    ds_write_b32 v37, v68 offset:2816
    s_nop 0
    ds_write_b32 v37, v72 offset:3072
    v_mfma_f32_16x16x32_bf16 v[112:115], a[240:243], a[36:39], v[112:115]
    v_mfma_f32_16x16x32_bf16 v[116:119], a[244:247], a[20:23], v[116:119]
    v_mfma_f32_16x16x32_bf16 v[120:123], a[244:247], a[24:27], v[120:123]
    s_add_u32 m0, s98, 8192
    v_mfma_f32_16x16x32_bf16 v[124:127], a[244:247], a[28:31], v[124:127]
    v_mfma_f32_16x16x32_bf16 v[128:131], a[244:247], a[32:35], v[128:131]
    s_waitcnt lgkmcnt(0)
    s_barrier
    v_mfma_f32_16x16x32_bf16 v[132:135], a[244:247], a[36:39], v[132:135]
    ds_read_b128 a[0:3], v33 offset:20480
    ds_read_b128 a[4:7], v33 offset:21504
    v_mfma_f32_16x16x32_bf16 v[136:139], a[248:251], a[20:23], v[136:139]
    ds_read_b128 a[8:11], v33 offset:22528
    v_mfma_f32_16x16x32_bf16 v[140:143], a[248:251], a[24:27], v[140:143]
    ds_read_b128 a[12:15], v33 offset:23552
    v_mfma_f32_16x16x32_bf16 v[144:147], a[248:251], a[28:31], v[144:147]
    ds_read_b128 a[16:19], v33 offset:24576
    v_mfma_f32_16x16x32_bf16 v[148:151], a[248:251], a[32:35], v[148:151]
    buffer_load_dwordx4 v17, s[40:43], s70 offen  lds
    v_mfma_f32_16x16x32_bf16 v[152:155], a[248:251], a[36:39], v[152:155]
    v_mfma_f32_16x16x32_bf16 v[156:159], a[252:255], a[20:23], v[156:159]
    v_mfma_f32_16x16x32_bf16 v[160:163], a[252:255], a[24:27], v[160:163]
    buffer_load_dwordx4 v18, s[40:43], s70 offen offset:1024  lds
    v_mfma_f32_16x16x32_bf16 v[164:167], a[252:255], a[28:31], v[164:167]
    v_mfma_f32_16x16x32_bf16 v[168:171], a[252:255], a[32:35], v[168:171]
    v_mfma_f32_16x16x32_bf16 v[172:175], a[252:255], a[36:39], v[172:175]
    s_bitcmp1_b32 s4, 3
    s_cbranch_scc1 L_rs5_3
L_rb5_3:
    s_waitcnt lgkmcnt(3)
    v_mfma_f32_16x16x32_bf16 v[96:99], a[224:227], a[0:3], v[96:99]
    ds_read_b128 a[20:23], v33 offset:25600
    v_mfma_f32_16x16x32_bf16 v[100:103], a[224:227], a[4:7], v[100:103]
    s_waitcnt vmcnt(10)
    ds_read_b64_tr_b16 a[240:241], v21 offset:12288
    s_waitcnt lgkmcnt(3)
    v_mfma_f32_16x16x32_bf16 v[104:107], a[224:227], a[8:11], v[104:107]
    ds_read_b128 a[24:27], v33 offset:26624
    ds_read_b64_tr_b16 a[242:243], v21 offset:14336
    v_mfma_f32_16x16x32_bf16 v[108:111], a[224:227], a[12:15], v[108:111]
    ds_read_b64_tr_b16 a[244:245], v22 offset:12288
    ds_read_b64_tr_b16 a[246:247], v22 offset:14336
    s_waitcnt lgkmcnt(6)
    v_mfma_f32_16x16x32_bf16 v[112:115], a[224:227], a[16:19], v[112:115]
    ds_read_b128 a[28:31], v33 offset:27648
    ds_read_b64_tr_b16 a[248:249], v23 offset:12288
    v_mfma_f32_16x16x32_bf16 v[116:119], a[228:231], a[0:3], v[116:119]
    ds_read_b64_tr_b16 a[250:251], v23 offset:14336
    buffer_load_dwordx4 v19, s[40:43], s70 offen offset:2048  lds
    v_mfma_f32_16x16x32_bf16 v[120:123], a[228:231], a[4:7], v[120:123]
    ds_read_b128 a[32:35], v33 offset:28672
    ds_read_b64_tr_b16 a[252:253], v24 offset:12288
    v_mfma_f32_16x16x32_bf16 v[124:127], a[228:231], a[8:11], v[124:127]
    ds_read_b64_tr_b16 a[254:255], v24 offset:14336
    buffer_load_dwordx4 v20, s[40:43], s70 offen offset:3072  lds
    v_mfma_f32_16x16x32_bf16 v[128:131], a[228:231], a[12:15], v[128:131]
    ds_read_b128 a[36:39], v33 offset:29696
    v_mfma_f32_16x16x32_bf16 v[132:135], a[228:231], a[16:19], v[132:135]
    v_mfma_f32_16x16x32_bf16 v[136:139], a[232:235], a[0:3], v[136:139]
    v_mfma_f32_16x16x32_bf16 v[140:143], a[232:235], a[4:7], v[140:143]
    v_mfma_f32_16x16x32_bf16 v[144:147], a[232:235], a[8:11], v[144:147]
    v_mfma_f32_16x16x32_bf16 v[148:151], a[232:235], a[12:15], v[148:151]
    s_add_u32 m0, s98, 12288
    s_add_u32 s91, s70, 28672
    v_mfma_f32_16x16x32_bf16 v[152:155], a[232:235], a[16:19], v[152:155]
    v_mfma_f32_16x16x32_bf16 v[156:159], a[236:239], a[0:3], v[156:159]
    v_mfma_f32_16x16x32_bf16 v[160:163], a[236:239], a[4:7], v[160:163]
    s_waitcnt lgkmcnt(1)
    buffer_load_dwordx4 v17, s[40:43], s91 offen  lds
    v_mfma_f32_16x16x32_bf16 v[164:167], a[236:239], a[8:11], v[164:167]
    v_mfma_f32_16x16x32_bf16 v[168:171], a[236:239], a[12:15], v[168:171]
    v_mfma_f32_16x16x32_bf16 v[172:175], a[236:239], a[16:19], v[172:175]
    s_waitcnt vmcnt(9)
    ds_read_b64_tr_b16 a[224:225], v21 offset:0
    v_mfma_f32_16x16x32_bf16 v[96:99], a[240:243], a[20:23], v[96:99]
    ds_read_b128 a[0:3], v33 offset:30720
    ds_read_b64_tr_b16 a[226:227], v21 offset:2048
    v_mfma_f32_16x16x32_bf16 v[100:103], a[240:243], a[24:27], v[100:103]
    ds_read_b64_tr_b16 a[228:229], v22 offset:0
    buffer_load_dwordx4 v18, s[40:43], s91 offen offset:1024  lds
    v_mfma_f32_16x16x32_bf16 v[104:107], a[240:243], a[28:31], v[104:107]
    ds_read_b128 a[4:7], v33 offset:31744
    ds_read_b64_tr_b16 a[230:231], v22 offset:2048
    v_mfma_f32_16x16x32_bf16 v[108:111], a[240:243], a[32:35], v[108:111]
    ds_read_b64_tr_b16 a[232:233], v23 offset:0
    s_waitcnt lgkmcnt(7)
    v_mfma_f32_16x16x32_bf16 v[112:115], a[240:243], a[36:39], v[112:115]
    ds_read_b128 a[8:11], v33 offset:32768
    ds_read_b64_tr_b16 a[234:235], v23 offset:2048
    v_mfma_f32_16x16x32_bf16 v[116:119], a[244:247], a[20:23], v[116:119]
    ds_read_b64_tr_b16 a[236:237], v24 offset:0
    buffer_load_dwordx4 v19, s[40:43], s91 offen offset:2048  lds
    v_mfma_f32_16x16x32_bf16 v[120:123], a[244:247], a[24:27], v[120:123]
    ds_read_b128 a[12:15], v33 offset:33792
    ds_read_b64_tr_b16 a[238:239], v24 offset:2048
    v_mfma_f32_16x16x32_bf16 v[124:127], a[244:247], a[28:31], v[124:127]
    v_mfma_f32_16x16x32_bf16 v[128:131], a[244:247], a[32:35], v[128:131]
    ds_read_b128 a[16:19], v33 offset:34816
    buffer_load_dwordx4 v20, s[40:43], s91 offen offset:3072  lds
    v_mfma_f32_16x16x32_bf16 v[132:135], a[244:247], a[36:39], v[132:135]
    v_mfma_f32_16x16x32_bf16 v[136:139], a[248:251], a[20:23], v[136:139]
    ds_read_b128 v[236:239], v38 offset:2048
    v_mfma_f32_16x16x32_bf16 v[140:143], a[248:251], a[24:27], v[140:143]
    v_mfma_f32_16x16x32_bf16 v[144:147], a[248:251], a[28:31], v[144:147]
    ds_read_b128 v[240:243], v38 offset:2304
    s_add_u32 m0, s98, 0
    v_mfma_f32_16x16x32_bf16 v[148:151], a[248:251], a[32:35], v[148:151]
    v_mfma_f32_16x16x32_bf16 v[152:155], a[248:251], a[36:39], v[152:155]
    ds_read_b128 v[244:247], v38 offset:2560
    v_mfma_f32_16x16x32_bf16 v[156:159], a[252:255], a[20:23], v[156:159]
    s_waitcnt lgkmcnt(4)
    buffer_load_dwordx4 v17, s[40:43], s71 offen  lds
    v_mfma_f32_16x16x32_bf16 v[160:163], a[252:255], a[24:27], v[160:163]
    ds_read_b128 v[248:251], v38 offset:2816
    v_mfma_f32_16x16x32_bf16 v[164:167], a[252:255], a[28:31], v[164:167]
    v_mfma_f32_16x16x32_bf16 v[168:171], a[252:255], a[32:35], v[168:171]
    ds_read_b128 v[252:255], v38 offset:3072
    v_mfma_f32_16x16x32_bf16 v[172:175], a[252:255], a[36:39], v[172:175]
    s_waitcnt vmcnt(9)
    ds_read_b64_tr_b16 a[240:241], v21 offset:4096
    buffer_load_dwordx4 v18, s[40:43], s71 offen offset:1024  lds
    v_mfma_f32_16x16x32_bf16 v[96:99], a[224:227], a[0:3], v[96:99]
    ds_read_b128 a[20:23], v33 offset:35840
    s_lshl_b32 s22, s16, 5
    buffer_load_dword v30, off, s[84:87], s22 sc1
    v_mfma_f32_16x16x32_bf16 v[100:103], a[224:227], a[4:7], v[100:103]
    ds_read_b64_tr_b16 a[242:243], v21 offset:6144
    ds_read_b64_tr_b16 a[244:245], v22 offset:4096
    v_mfma_f32_16x16x32_bf16 v[104:107], a[224:227], a[8:11], v[104:107]
    ds_read_b128 a[24:27], v33 offset:36864
    ds_read_b64_tr_b16 a[246:247], v22 offset:6144
    v_mfma_f32_16x16x32_bf16 v[108:111], a[224:227], a[12:15], v[108:111]
    ds_read_b64_tr_b16 a[248:249], v23 offset:4096
    ds_read_b64_tr_b16 a[250:251], v23 offset:6144
    s_waitcnt lgkmcnt(10)
    v_mfma_f32_16x16x32_bf16 v[112:115], a[224:227], a[16:19], v[112:115]
    ds_read_b128 a[28:31], v33 offset:37888
    ds_read_b64_tr_b16 a[252:253], v24 offset:4096
    v_mfma_f32_16x16x32_bf16 v[116:119], a[228:231], a[0:3], v[116:119]
    ds_read_b64_tr_b16 a[254:255], v24 offset:6144
    buffer_load_dwordx4 v19, s[40:43], s71 offen offset:2048  lds
    v_mfma_f32_16x16x32_bf16 v[120:123], a[228:231], a[4:7], v[120:123]
    ds_read_b128 a[32:35], v33 offset:38912
    v_add_f32 v236, v236, v237
    v_mfma_f32_16x16x32_bf16 v[124:127], a[228:231], a[8:11], v[124:127]
    buffer_load_dwordx4 v20, s[40:43], s71 offen offset:3072  lds
    v_add_f32 v238, v238, v239
    v_mfma_f32_16x16x32_bf16 v[128:131], a[228:231], a[12:15], v[128:131]
    ds_read_b128 a[36:39], v33 offset:39936
    v_add_f32 v236, v236, v238
    v_mfma_f32_16x16x32_bf16 v[132:135], a[228:231], a[16:19], v[132:135]
    v_rcp_f32 v46, v236
    v_add_f32 v240, v240, v241
    v_mfma_f32_16x16x32_bf16 v[136:139], a[232:235], a[0:3], v[136:139]
    v_add_f32 v242, v242, v243
    v_add_f32 v240, v240, v242
    v_mfma_f32_16x16x32_bf16 v[140:143], a[232:235], a[4:7], v[140:143]
    s_add_u32 m0, s98, 4096
    s_add_u32 s91, s71, 28672
    v_mfma_f32_16x16x32_bf16 v[144:147], a[232:235], a[8:11], v[144:147]
    v_rcp_f32 v47, v240
    v_mfma_f32_16x16x32_bf16 v[148:151], a[232:235], a[12:15], v[148:151]
    s_waitcnt lgkmcnt(2)
    buffer_load_dwordx4 v17, s[40:43], s91 offen  lds
    v_add_f32 v244, v244, v245
    v_mfma_f32_16x16x32_bf16 v[152:155], a[232:235], a[16:19], v[152:155]
    v_add_f32 v246, v246, v247
    v_add_f32 v244, v244, v246
    v_mfma_f32_16x16x32_bf16 v[156:159], a[236:239], a[0:3], v[156:159]
    buffer_load_dwordx4 v18, s[40:43], s91 offen offset:1024  lds
    v_mfma_f32_16x16x32_bf16 v[160:163], a[236:239], a[4:7], v[160:163]
    v_rcp_f32 v48, v244
    v_add_f32 v248, v248, v249
    v_mfma_f32_16x16x32_bf16 v[164:167], a[236:239], a[8:11], v[164:167]
    buffer_load_dwordx4 v19, s[40:43], s91 offen offset:2048  lds
    v_add_f32 v250, v250, v251
    v_mfma_f32_16x16x32_bf16 v[168:171], a[236:239], a[12:15], v[168:171]
    v_add_f32 v248, v248, v250
    v_rcp_f32 v49, v248
    v_mfma_f32_16x16x32_bf16 v[172:175], a[236:239], a[16:19], v[172:175]
    buffer_load_dwordx4 v20, s[40:43], s91 offen offset:3072  lds
    v_add_f32 v252, v252, v253
    v_mfma_f32_16x16x32_bf16 v[96:99], a[240:243], a[20:23], v[96:99]
    v_add_f32 v254, v254, v255
    v_add_f32 v252, v252, v254
    v_mfma_f32_16x16x32_bf16 v[116:119], a[244:247], a[20:23], v[116:119]
    v_rcp_f32 v50, v252
    v_mfma_f32_16x16x32_bf16 v[100:103], a[240:243], a[24:27], v[100:103]
    v_mfma_f32_16x16x32_bf16 v[120:123], a[244:247], a[24:27], v[120:123]
    v_mfma_f32_16x16x32_bf16 v[104:107], a[240:243], a[28:31], v[104:107]
    s_nop 0
    v_cvt_pk_bf16_f32 v4, v96, v97
    v_cvt_pk_bf16_f32 v5, v98, v99
    v_mfma_f32_16x16x32_bf16 v[124:127], a[244:247], a[28:31], v[124:127]
    v_cvt_pk_bf16_f32 v6, v116, v117
    v_cvt_pk_bf16_f32 v7, v118, v119
    s_waitcnt lgkmcnt(0)
    v_mfma_f32_16x16x32_bf16 v[108:111], a[240:243], a[32:35], v[108:111]
    ds_write_b128 v36, v[4:7] offset:0
    v_cvt_pk_bf16_f32 v8, v100, v101
    v_cvt_pk_bf16_f32 v9, v102, v103
    v_mfma_f32_16x16x32_bf16 v[128:131], a[244:247], a[32:35], v[128:131]
    v_cvt_pk_bf16_f32 v10, v120, v121
    v_cvt_pk_bf16_f32 v11, v122, v123
    v_mfma_f32_16x16x32_bf16 v[112:115], a[240:243], a[36:39], v[112:115]
    ds_write_b128 v36, v[8:11] offset:1024
    v_cvt_pk_bf16_f32 v4, v104, v105
    v_cvt_pk_bf16_f32 v5, v106, v107
    v_mfma_f32_16x16x32_bf16 v[132:135], a[244:247], a[36:39], v[132:135]
    v_cvt_pk_bf16_f32 v6, v124, v125
    v_cvt_pk_bf16_f32 v7, v126, v127
    v_mfma_f32_16x16x32_bf16 v[136:139], a[248:251], a[20:23], v[136:139]
    ds_write_b128 v36, v[4:7] offset:2048
    v_cvt_pk_bf16_f32 v8, v108, v109
    v_cvt_pk_bf16_f32 v9, v110, v111
    v_mfma_f32_16x16x32_bf16 v[156:159], a[252:255], a[20:23], v[156:159]
    v_cvt_pk_bf16_f32 v10, v128, v129
    v_cvt_pk_bf16_f32 v11, v130, v131
    v_mfma_f32_16x16x32_bf16 v[140:143], a[248:251], a[24:27], v[140:143]
    ds_write_b128 v36, v[8:11] offset:3072
    v_cvt_pk_bf16_f32 v4, v112, v113
    v_cvt_pk_bf16_f32 v5, v114, v115
    v_mfma_f32_16x16x32_bf16 v[160:163], a[252:255], a[24:27], v[160:163]
    v_cvt_pk_bf16_f32 v6, v132, v133
    v_cvt_pk_bf16_f32 v7, v134, v135
    v_mfma_f32_16x16x32_bf16 v[144:147], a[248:251], a[28:31], v[144:147]
    ds_write_b128 v36, v[4:7] offset:4096
    v_cvt_pk_bf16_f32 v8, v136, v137
    v_cvt_pk_bf16_f32 v9, v138, v139
    v_mfma_f32_16x16x32_bf16 v[164:167], a[252:255], a[28:31], v[164:167]
    v_cvt_pk_bf16_f32 v10, v156, v157
    v_cvt_pk_bf16_f32 v11, v158, v159
    v_mfma_f32_16x16x32_bf16 v[148:151], a[248:251], a[32:35], v[148:151]
    ds_write_b128 v36, v[8:11] offset:5120
    v_cvt_pk_bf16_f32 v4, v140, v141
    v_cvt_pk_bf16_f32 v5, v142, v143
    v_mfma_f32_16x16x32_bf16 v[168:171], a[252:255], a[32:35], v[168:171]
    v_cvt_pk_bf16_f32 v6, v160, v161
    v_cvt_pk_bf16_f32 v7, v162, v163
    v_mfma_f32_16x16x32_bf16 v[152:155], a[248:251], a[36:39], v[152:155]
    ds_write_b128 v36, v[4:7] offset:6144
    v_cvt_pk_bf16_f32 v8, v144, v145
    v_cvt_pk_bf16_f32 v9, v146, v147
    v_mfma_f32_16x16x32_bf16 v[172:175], a[252:255], a[36:39], v[172:175]
    v_cvt_pk_bf16_f32 v10, v164, v165
    v_cvt_pk_bf16_f32 v11, v166, v167
    ds_write_b128 v36, v[8:11] offset:7168
    v_cvt_pk_bf16_f32 v176, v148, v149
    v_cvt_pk_bf16_f32 v177, v150, v151
    v_cvt_pk_bf16_f32 v178, v168, v169
    v_cvt_pk_bf16_f32 v179, v170, v171
    v_cvt_pk_bf16_f32 v180, v152, v153
    v_cvt_pk_bf16_f32 v181, v154, v155
    v_cvt_pk_bf16_f32 v182, v172, v173
    v_cvt_pk_bf16_f32 v183, v174, v175
    ds_write_b128 v36, v[176:179] offset:8192
    ds_write_b128 v36, v[180:183] offset:9216
    s_waitcnt vmcnt(9)
    s_waitcnt lgkmcnt(0)
    s_barrier
    ds_read_b64_tr_b16 a[240:241], v25 offset:8192
    ds_read_b64_tr_b16 a[242:243], v25 offset:10240
    ds_read_b128 a[0:3], v32 offset:0
    ds_read_b128 a[4:7], v32 offset:1024
    ds_read_b128 a[8:11], v32 offset:2048
    ds_read_b128 a[12:15], v32 offset:3072
    ds_read_b128 a[16:19], v32 offset:4096
    ds_read_b64_tr_b16 a[244:245], v25 offset:12288
    ds_read_b64_tr_b16 a[246:247], v25 offset:14336
    ds_read_b128 a[20:23], v32 offset:5120
    ds_read_b128 a[24:27], v32 offset:6144
    ds_read_b128 a[28:31], v32 offset:7168
    s_waitcnt lgkmcnt(9)
    v_mfma_f32_16x16x32_bf16 v[96:99], a[240:243], a[0:3], 0
    ds_read_b128 a[32:35], v32 offset:8192
    ds_read_b128 a[36:39], v32 offset:9216
    s_waitcnt lgkmcnt(10)
    v_mfma_f32_16x16x32_bf16 v[100:103], a[240:243], a[4:7], 0
    ds_read_b64_tr_b16 a[248:249], v25 offset:24576
    s_lshl_b32 s20, s3, 13
    s_add_u32 m0, s20, 40960
    s_waitcnt lgkmcnt(10)
    v_mfma_f32_16x16x32_bf16 v[104:107], a[240:243], a[8:11], 0
    ds_read_b64_tr_b16 a[250:251], v25 offset:26624
    ds_read_b128 a[40:43], v32 offset:10240
    s_waitcnt lgkmcnt(11)
    v_mfma_f32_16x16x32_bf16 v[108:111], a[240:243], a[12:15], 0
    ds_read_b128 a[44:47], v32 offset:11264
    buffer_load_dwordx4 v17, s[40:43], s72 offen  lds
    s_waitcnt lgkmcnt(11)
    v_mfma_f32_16x16x32_bf16 v[112:115], a[240:243], a[16:19], 0
    ds_read_b128 a[48:51], v32 offset:12288
    ds_read_b128 a[52:55], v32 offset:13312
    s_waitcnt lgkmcnt(10)
    v_mfma_f32_16x16x32_bf16 v[96:99], a[244:247], a[20:23], v[96:99]
    ds_read_b128 a[56:59], v32 offset:14336
    s_waitcnt lgkmcnt(10)
    v_mfma_f32_16x16x32_bf16 v[100:103], a[244:247], a[24:27], v[100:103]
    ds_read_b64_tr_b16 a[252:253], v25 offset:28672
    ds_read_b64_tr_b16 a[254:255], v25 offset:30720
    s_waitcnt lgkmcnt(11)
    v_mfma_f32_16x16x32_bf16 v[104:107], a[244:247], a[28:31], v[104:107]
    ds_read_b128 a[60:63], v32 offset:15360
    buffer_load_dwordx4 v18, s[40:43], s72 offen offset:1024  lds
    s_waitcnt lgkmcnt(11)
    v_mfma_f32_16x16x32_bf16 v[108:111], a[244:247], a[32:35], v[108:111]
    ds_read_b128 a[64:67], v32 offset:16384
    ds_read_b128 a[68:71], v32 offset:17408
    s_waitcnt lgkmcnt(12)
    v_mfma_f32_16x16x32_bf16 v[112:115], a[244:247], a[36:39], v[112:115]
    ds_read_b128 a[72:75], v32 offset:18432
    buffer_load_dwordx4 v19, s[40:43], s72 offen offset:2048  lds
    s_waitcnt lgkmcnt(10)
    v_mfma_f32_16x16x32_bf16 v[96:99], a[248:251], a[40:43], v[96:99]
    ds_read_b128 a[76:79], v32 offset:19456
    ds_read_b64_tr_b16 a[224:225], v26 offset:8192
    s_waitcnt lgkmcnt(11)
    v_mfma_f32_16x16x32_bf16 v[100:103], a[248:251], a[44:47], v[100:103]
    ds_read_b64_tr_b16 a[226:227], v26 offset:10240
    s_waitcnt lgkmcnt(11)
    v_mfma_f32_16x16x32_bf16 v[104:107], a[248:251], a[48:51], v[104:107]
    ds_read_b128 a[80:83], v32 offset:20480
    ds_read_b128 a[84:87], v32 offset:21504
    s_waitcnt lgkmcnt(12)
    v_mfma_f32_16x16x32_bf16 v[108:111], a[248:251], a[52:55], v[108:111]
    ds_read_b128 a[88:91], v32 offset:22528
    buffer_load_dwordx4 v20, s[40:43], s72 offen offset:3072  lds
    s_waitcnt lgkmcnt(12)
    v_mfma_f32_16x16x32_bf16 v[112:115], a[248:251], a[56:59], v[112:115]
    ds_read_b128 a[92:95], v32 offset:23552
    s_waitcnt lgkmcnt(10)
    v_mfma_f32_16x16x32_bf16 v[96:99], a[252:255], a[60:63], v[96:99]
    ds_read_b128 a[96:99], v32 offset:24576
    ds_read_b64_tr_b16 a[228:229], v26 offset:12288
    s_waitcnt lgkmcnt(11)
    v_mfma_f32_16x16x32_bf16 v[100:103], a[252:255], a[64:67], v[100:103]
    ds_read_b64_tr_b16 a[230:231], v26 offset:14336
    s_lshl_b32 s20, s3, 13
    s_add_u32 m0, s20, 45056
    s_add_u32 s91, s72, 28672
    s_waitcnt lgkmcnt(11)
    v_mfma_f32_16x16x32_bf16 v[104:107], a[252:255], a[68:71], v[104:107]
    ds_read_b128 a[100:103], v32 offset:25600
    ds_read_b128 a[104:107], v32 offset:26624
    s_waitcnt lgkmcnt(12)
    v_mfma_f32_16x16x32_bf16 v[108:111], a[252:255], a[72:75], v[108:111]
    ds_read_b128 a[108:111], v32 offset:27648
    buffer_load_dwordx4 v17, s[40:43], s91 offen  lds
    s_waitcnt lgkmcnt(11)
    v_mfma_f32_16x16x32_bf16 v[112:115], a[252:255], a[76:79], v[112:115]
    ds_read_b128 a[112:115], v32 offset:28672
    ds_read_b128 a[116:119], v32 offset:29696
    s_waitcnt lgkmcnt(11)
    v_mfma_f32_16x16x32_bf16 v[96:99], a[224:227], a[80:83], v[96:99]
    ds_read_b64_tr_b16 a[232:233], v26 offset:24576
    s_waitcnt lgkmcnt(11)
    v_mfma_f32_16x16x32_bf16 v[100:103], a[224:227], a[84:87], v[100:103]
    ds_read_b64_tr_b16 a[234:235], v26 offset:26624
    ds_read_b128 a[120:123], v32 offset:30720
    s_waitcnt lgkmcnt(12)
    v_mfma_f32_16x16x32_bf16 v[104:107], a[224:227], a[88:91], v[104:107]
    ds_read_b128 a[124:127], v32 offset:31744
    buffer_load_dwordx4 v18, s[40:43], s91 offen offset:1024  lds
    s_waitcnt lgkmcnt(12)
    v_mfma_f32_16x16x32_bf16 v[108:111], a[224:227], a[92:95], v[108:111]
    ds_read_b128 a[128:131], v32 offset:32768
    ds_read_b128 a[132:135], v32 offset:33792
    s_waitcnt lgkmcnt(12)
    v_mfma_f32_16x16x32_bf16 v[112:115], a[224:227], a[96:99], v[112:115]
    ds_read_b128 a[136:139], v32 offset:34816
    buffer_load_dwordx4 v19, s[40:43], s91 offen offset:2048  lds
    s_waitcnt lgkmcnt(11)
    v_mfma_f32_16x16x32_bf16 v[96:99], a[228:231], a[100:103], v[96:99]
    ds_read_b64_tr_b16 a[236:237], v26 offset:28672
    ds_read_b64_tr_b16 a[238:239], v26 offset:30720
    s_waitcnt lgkmcnt(12)
    v_mfma_f32_16x16x32_bf16 v[100:103], a[228:231], a[104:107], v[100:103]
    ds_read_b128 a[140:143], v32 offset:35840
    s_waitcnt lgkmcnt(12)
    v_mfma_f32_16x16x32_bf16 v[104:107], a[228:231], a[108:111], v[104:107]
    ds_read_b128 a[144:147], v32 offset:36864
    ds_read_b128 a[148:151], v32 offset:37888
    s_waitcnt lgkmcnt(12)
    v_mfma_f32_16x16x32_bf16 v[108:111], a[228:231], a[112:115], v[108:111]
    ds_read_b128 a[152:155], v32 offset:38912
    buffer_load_dwordx4 v20, s[40:43], s91 offen offset:3072  lds
    v_mfma_f32_16x16x32_bf16 v[112:115], a[228:231], a[116:119], v[112:115]
    ds_read_b128 a[156:159], v32 offset:39936
    s_waitcnt lgkmcnt(11)
    v_mfma_f32_16x16x32_bf16 v[96:99], a[232:235], a[120:123], v[96:99]
    s_waitcnt lgkmcnt(10)
    v_mfma_f32_16x16x32_bf16 v[100:103], a[232:235], a[124:127], v[100:103]
    s_waitcnt lgkmcnt(9)
    v_mfma_f32_16x16x32_bf16 v[104:107], a[232:235], a[128:131], v[104:107]
    s_waitcnt vmcnt(8)
    s_waitcnt lgkmcnt(5)
    s_barrier
    v_mfma_f32_16x16x32_bf16 v[108:111], a[232:235], a[132:135], v[108:111]
    ds_read_b64_tr_b16 a[240:241], v25 offset:0
    s_add_u32 m0, s98, 8192
    v_mfma_f32_16x16x32_bf16 v[112:115], a[232:235], a[136:139], v[112:115]
    ds_read_b64_tr_b16 a[242:243], v25 offset:2048
    buffer_load_dwordx4 v17, s[40:43], s73 offen  lds
    s_waitcnt lgkmcnt(6)
    v_mfma_f32_16x16x32_bf16 v[96:99], a[236:239], a[140:143], v[96:99]
    ds_read_b64_tr_b16 a[244:245], v25 offset:4096
    s_waitcnt lgkmcnt(6)
    v_mfma_f32_16x16x32_bf16 v[100:103], a[236:239], a[144:147], v[100:103]
    ds_read_b64_tr_b16 a[246:247], v25 offset:6144
    buffer_load_dwordx4 v18, s[40:43], s73 offen offset:1024  lds
    s_waitcnt lgkmcnt(6)
    v_mfma_f32_16x16x32_bf16 v[104:107], a[236:239], a[148:151], v[104:107]
    ds_read_b64_tr_b16 a[248:249], v25 offset:16384
    s_waitcnt lgkmcnt(6)
    v_mfma_f32_16x16x32_bf16 v[108:111], a[236:239], a[152:155], v[108:111]
    ds_read_b64_tr_b16 a[250:251], v25 offset:18432
    buffer_load_dwordx4 v19, s[40:43], s73 offen offset:2048  lds
    s_waitcnt lgkmcnt(6)
    v_mfma_f32_16x16x32_bf16 v[112:115], a[236:239], a[156:159], v[112:115]
    ds_read_b64_tr_b16 a[252:253], v25 offset:20480
    s_waitcnt lgkmcnt(5)
    v_mfma_f32_16x16x32_bf16 v[116:119], a[240:243], a[0:3], 0
    ds_read_b64_tr_b16 a[254:255], v25 offset:22528
    buffer_load_dwordx4 v20, s[40:43], s73 offen offset:3072  lds
    v_mfma_f32_16x16x32_bf16 v[120:123], a[240:243], a[4:7], 0
    ds_read_b64_tr_b16 a[224:225], v26 offset:0
    v_mfma_f32_16x16x32_bf16 v[124:127], a[240:243], a[8:11], 0
    ds_read_b64_tr_b16 a[226:227], v26 offset:2048
    s_add_u32 m0, s98, 12288
    s_add_u32 s91, s73, 28672
    v_mfma_f32_16x16x32_bf16 v[128:131], a[240:243], a[12:15], 0
    ds_read_b64_tr_b16 a[228:229], v26 offset:4096
    buffer_load_dwordx4 v17, s[40:43], s91 offen  lds
    v_mfma_f32_16x16x32_bf16 v[132:135], a[240:243], a[16:19], 0
    ds_read_b64_tr_b16 a[230:231], v26 offset:6144
    v_mul_f32 v96, v46, v96
    v_mul_f32 v97, v46, v97
    s_waitcnt lgkmcnt(8)
    v_mfma_f32_16x16x32_bf16 v[116:119], a[244:247], a[20:23], v[116:119]
    ds_read_b64_tr_b16 a[232:233], v26 offset:16384
    buffer_load_dwordx4 v18, s[40:43], s91 offen offset:1024  lds
    v_mfma_f32_16x16x32_bf16 v[120:123], a[244:247], a[24:27], v[120:123]
    ds_read_b64_tr_b16 a[234:235], v26 offset:18432
    v_mul_f32 v98, v46, v98
    v_mul_f32 v99, v46, v99
    v_mfma_f32_16x16x32_bf16 v[124:127], a[244:247], a[28:31], v[124:127]
    ds_read_b64_tr_b16 a[236:237], v26 offset:20480
    buffer_load_dwordx4 v19, s[40:43], s91 offen offset:2048  lds
    v_mfma_f32_16x16x32_bf16 v[128:131], a[244:247], a[32:35], v[128:131]
    ds_read_b64_tr_b16 a[238:239], v26 offset:22528
    v_cvt_pk_bf16_f32 v56, v96, v97
    v_cvt_pk_bf16_f32 v57, v98, v99
    v_mfma_f32_16x16x32_bf16 v[132:135], a[244:247], a[36:39], v[132:135]
    buffer_load_dwordx4 v20, s[40:43], s91 offen offset:3072  lds
    v_mul_f32 v100, v47, v100
    s_waitcnt lgkmcnt(6)
    v_mfma_f32_16x16x32_bf16 v[116:119], a[248:251], a[40:43], v[116:119]
    v_mul_f32 v101, v47, v101
    v_mul_f32 v102, v47, v102
    v_mul_f32 v103, v47, v103
    v_mfma_f32_16x16x32_bf16 v[120:123], a[248:251], a[44:47], v[120:123]
    v_cvt_pk_bf16_f32 v58, v100, v101
    v_cvt_pk_bf16_f32 v59, v102, v103
    v_mfma_f32_16x16x32_bf16 v[124:127], a[248:251], a[48:51], v[124:127]
    s_mov_b32 s21, 57344
    buffer_store_dwordx4 v[56:59], v39, s[44:47], s21 offen sc1
    v_mfma_f32_16x16x32_bf16 v[128:131], a[248:251], a[52:55], v[128:131]
    v_mfma_f32_16x16x32_bf16 v[132:135], a[248:251], a[56:59], v[132:135]
    v_mul_f32 v104, v48, v104
    v_mul_f32 v105, v48, v105
    v_mfma_f32_16x16x32_bf16 v[116:119], a[252:255], a[60:63], v[116:119]
    v_mul_f32 v106, v48, v106
    v_mul_f32 v107, v48, v107
    v_cvt_pk_bf16_f32 v60, v104, v105
    v_mfma_f32_16x16x32_bf16 v[120:123], a[252:255], a[64:67], v[120:123]
    v_cvt_pk_bf16_f32 v61, v106, v107
    v_mul_f32 v108, v49, v108
    v_mfma_f32_16x16x32_bf16 v[124:127], a[252:255], a[68:71], v[124:127]
    v_mul_f32 v109, v49, v109
    v_mul_f32 v110, v49, v110
    v_mul_f32 v111, v49, v111
    v_mfma_f32_16x16x32_bf16 v[128:131], a[252:255], a[72:75], v[128:131]
    v_cvt_pk_bf16_f32 v62, v108, v109
    v_cvt_pk_bf16_f32 v63, v110, v111
    v_mfma_f32_16x16x32_bf16 v[132:135], a[252:255], a[76:79], v[132:135]
    buffer_store_dwordx4 v[60:63], v40, s[44:47], s21 offen sc1
    v_mfma_f32_16x16x32_bf16 v[116:119], a[224:227], a[80:83], v[116:119]
    v_mul_f32 v112, v50, v112
    v_mfma_f32_16x16x32_bf16 v[120:123], a[224:227], a[84:87], v[120:123]
    v_mul_f32 v113, v50, v113
    v_mul_f32 v114, v50, v114
    v_mfma_f32_16x16x32_bf16 v[124:127], a[224:227], a[88:91], v[124:127]
    s_waitcnt vmcnt(10)
    s_waitcnt lgkmcnt(0)
    s_barrier
    v_mfma_f32_16x16x32_bf16 v[128:131], a[224:227], a[92:95], v[128:131]
    ds_read_b64_tr_b16 a[240:241], v27 offset:0
    ds_read_b64_tr_b16 a[242:243], v27 offset:2048
    v_mul_f32 v115, v50, v115
    v_mfma_f32_16x16x32_bf16 v[132:135], a[224:227], a[96:99], v[132:135]
    ds_read_b64_tr_b16 a[244:245], v27 offset:4096
    s_add_u32 m0, s98, 0
    v_mfma_f32_16x16x32_bf16 v[116:119], a[228:231], a[100:103], v[116:119]
    ds_read_b64_tr_b16 a[246:247], v27 offset:6144
    buffer_load_dwordx4 v17, s[40:43], s74 offen  lds
    v_cvt_pk_bf16_f32 v64, v112, v113
    v_mfma_f32_16x16x32_bf16 v[120:123], a[228:231], a[104:107], v[120:123]
    ds_read_b64_tr_b16 a[248:249], v27 offset:8192
    buffer_load_dwordx4 v18, s[40:43], s74 offen offset:1024  lds
    v_mfma_f32_16x16x32_bf16 v[124:127], a[228:231], a[108:111], v[124:127]
    ds_read_b64_tr_b16 a[250:251], v27 offset:10240
    v_cvt_pk_bf16_f32 v65, v114, v115
    v_mov_b32 v66, 0
    v_mfma_f32_16x16x32_bf16 v[128:131], a[228:231], a[112:115], v[128:131]
    ds_read_b64_tr_b16 a[252:253], v27 offset:12288
    buffer_load_dwordx4 v19, s[40:43], s74 offen offset:2048  lds
    v_mov_b32 v67, 0
    v_mfma_f32_16x16x32_bf16 v[132:135], a[228:231], a[116:119], v[132:135]
    ds_read_b64_tr_b16 a[254:255], v27 offset:14336
    v_mfma_f32_16x16x32_bf16 v[116:119], a[232:235], a[120:123], v[116:119]
    ds_read_b64_tr_b16 a[208:209], v27 offset:16384
    buffer_load_dwordx4 v20, s[40:43], s74 offen offset:3072  lds
    v_mfma_f32_16x16x32_bf16 v[120:123], a[232:235], a[124:127], v[120:123]
    ds_read_b64_tr_b16 a[210:211], v27 offset:18432
    s_mov_b32 s21, 114688
    buffer_store_dwordx4 v[64:67], v39, s[44:47], s21 offen sc1
    v_mfma_f32_16x16x32_bf16 v[124:127], a[232:235], a[128:131], v[124:127]
    ds_read_b64_tr_b16 a[212:213], v27 offset:20480
    s_add_u32 m0, s98, 4096
    s_add_u32 s91, s74, 28672
    v_mfma_f32_16x16x32_bf16 v[128:131], a[232:235], a[132:135], v[128:131]
    ds_read_b64_tr_b16 a[214:215], v27 offset:22528
    buffer_load_dwordx4 v17, s[40:43], s91 offen  lds
    v_mfma_f32_16x16x32_bf16 v[132:135], a[232:235], a[136:139], v[132:135]
    ds_read_b64_tr_b16 a[216:217], v27 offset:24576
    v_mfma_f32_16x16x32_bf16 v[116:119], a[236:239], a[140:143], v[116:119]
    ds_read_b64_tr_b16 a[218:219], v27 offset:26624
    buffer_load_dwordx4 v18, s[40:43], s91 offen offset:1024  lds
    v_mfma_f32_16x16x32_bf16 v[120:123], a[236:239], a[144:147], v[120:123]
    ds_read_b64_tr_b16 a[220:221], v27 offset:28672
    v_mfma_f32_16x16x32_bf16 v[124:127], a[236:239], a[148:151], v[124:127]
    ds_read_b64_tr_b16 a[222:223], v27 offset:30720
    buffer_load_dwordx4 v19, s[40:43], s91 offen offset:2048  lds
    v_mfma_f32_16x16x32_bf16 v[128:131], a[236:239], a[152:155], v[128:131]
    v_mfma_f32_16x16x32_bf16 v[132:135], a[236:239], a[156:159], v[132:135]
    buffer_load_dwordx4 v20, s[40:43], s91 offen offset:3072  lds
    s_waitcnt lgkmcnt(6)
    v_mfma_f32_16x16x32_bf16 v[136:139], a[240:243], a[0:3], 0
    v_mfma_f32_16x16x32_bf16 v[140:143], a[240:243], a[4:7], 0
    v_mfma_f32_16x16x32_bf16 v[144:147], a[240:243], a[8:11], 0
    v_mfma_f32_16x16x32_bf16 v[148:151], a[240:243], a[12:15], 0
    v_mfma_f32_16x16x32_bf16 v[152:155], a[240:243], a[16:19], 0
    v_mul_f32 v116, v46, v116
    v_mul_f32 v117, v46, v117
    v_mfma_f32_16x16x32_bf16 v[136:139], a[244:247], a[20:23], v[136:139]
    v_mul_f32 v118, v46, v118
    v_mul_f32 v119, v46, v119
    v_cvt_pk_bf16_f32 v68, v116, v117
    v_mfma_f32_16x16x32_bf16 v[140:143], a[244:247], a[24:27], v[140:143]
    v_cvt_pk_bf16_f32 v69, v118, v119
    v_mul_f32 v120, v47, v120
    v_mfma_f32_16x16x32_bf16 v[144:147], a[244:247], a[28:31], v[144:147]
    v_mul_f32 v121, v47, v121
    v_mul_f32 v122, v47, v122
    v_mfma_f32_16x16x32_bf16 v[148:151], a[244:247], a[32:35], v[148:151]
    v_mul_f32 v123, v47, v123
    v_cvt_pk_bf16_f32 v70, v120, v121
    v_mfma_f32_16x16x32_bf16 v[152:155], a[244:247], a[36:39], v[152:155]
    v_cvt_pk_bf16_f32 v71, v122, v123
    v_mfma_f32_16x16x32_bf16 v[136:139], a[248:251], a[40:43], v[136:139]
    s_mov_b32 s21, 65536
    buffer_store_dwordx4 v[68:71], v39, s[44:47], s21 offen sc1
    v_mfma_f32_16x16x32_bf16 v[140:143], a[248:251], a[44:47], v[140:143]
    v_mfma_f32_16x16x32_bf16 v[144:147], a[248:251], a[48:51], v[144:147]
    v_mul_f32 v124, v48, v124
    v_mul_f32 v125, v48, v125
    v_mul_f32 v126, v48, v126
    v_mfma_f32_16x16x32_bf16 v[148:151], a[248:251], a[52:55], v[148:151]
    v_mul_f32 v127, v48, v127
    v_cvt_pk_bf16_f32 v72, v124, v125
    v_mfma_f32_16x16x32_bf16 v[152:155], a[248:251], a[56:59], v[152:155]
    v_cvt_pk_bf16_f32 v73, v126, v127
    v_mul_f32 v128, v49, v128
    v_mfma_f32_16x16x32_bf16 v[136:139], a[252:255], a[60:63], v[136:139]
    v_mul_f32 v129, v49, v129
    v_mul_f32 v130, v49, v130
    v_mfma_f32_16x16x32_bf16 v[140:143], a[252:255], a[64:67], v[140:143]
    v_mul_f32 v131, v49, v131
    v_cvt_pk_bf16_f32 v74, v128, v129
    v_cvt_pk_bf16_f32 v75, v130, v131
    v_mfma_f32_16x16x32_bf16 v[144:147], a[252:255], a[68:71], v[144:147]
    v_mfma_f32_16x16x32_bf16 v[148:151], a[252:255], a[72:75], v[148:151]
    buffer_store_dwordx4 v[72:75], v40, s[44:47], s21 offen sc1
    v_mfma_f32_16x16x32_bf16 v[152:155], a[252:255], a[76:79], v[152:155]
    v_mul_f32 v132, v50, v132
    v_mfma_f32_16x16x32_bf16 v[136:139], a[208:211], a[80:83], v[136:139]
    v_mul_f32 v133, v50, v133
    v_mul_f32 v134, v50, v134
    v_mul_f32 v135, v50, v135
    v_mfma_f32_16x16x32_bf16 v[140:143], a[208:211], a[84:87], v[140:143]
    v_cvt_pk_bf16_f32 v76, v132, v133
    v_cvt_pk_bf16_f32 v77, v134, v135
    v_mfma_f32_16x16x32_bf16 v[144:147], a[208:211], a[88:91], v[144:147]
    s_waitcnt vmcnt(13)
    s_waitcnt lgkmcnt(0)
    s_barrier
    v_mfma_f32_16x16x32_bf16 v[148:151], a[208:211], a[92:95], v[148:151]
    ds_read_b64_tr_b16 a[240:241], v25 offset:8192
    ds_read_b64_tr_b16 a[242:243], v25 offset:10240
    v_mfma_f32_16x16x32_bf16 v[152:155], a[208:211], a[96:99], v[152:155]
    ds_read_b64_tr_b16 a[244:245], v25 offset:12288
    s_lshl_b32 s20, s3, 13
    s_add_u32 m0, s20, 40960
    v_mfma_f32_16x16x32_bf16 v[136:139], a[212:215], a[100:103], v[136:139]
    ds_read_b64_tr_b16 a[246:247], v25 offset:14336
    buffer_load_dwordx4 v17, s[40:43], s75 offen  lds
    v_mfma_f32_16x16x32_bf16 v[140:143], a[212:215], a[104:107], v[140:143]
    ds_read_b64_tr_b16 a[248:249], v25 offset:24576
    buffer_load_dwordx4 v18, s[40:43], s75 offen offset:1024  lds
    v_mfma_f32_16x16x32_bf16 v[144:147], a[212:215], a[108:111], v[144:147]
    ds_read_b64_tr_b16 a[250:251], v25 offset:26624
    v_mfma_f32_16x16x32_bf16 v[148:151], a[212:215], a[112:115], v[148:151]
    ds_read_b64_tr_b16 a[252:253], v25 offset:28672
    buffer_load_dwordx4 v19, s[40:43], s75 offen offset:2048  lds
    v_mfma_f32_16x16x32_bf16 v[152:155], a[212:215], a[116:119], v[152:155]
    ds_read_b64_tr_b16 a[254:255], v25 offset:30720
    v_mfma_f32_16x16x32_bf16 v[136:139], a[216:219], a[120:123], v[136:139]
    ds_read_b64_tr_b16 a[224:225], v26 offset:8192
    buffer_load_dwordx4 v20, s[40:43], s75 offen offset:3072  lds
    v_mfma_f32_16x16x32_bf16 v[140:143], a[216:219], a[124:127], v[140:143]
    ds_read_b64_tr_b16 a[226:227], v26 offset:10240
    v_mfma_f32_16x16x32_bf16 v[144:147], a[216:219], a[128:131], v[144:147]
    ds_read_b64_tr_b16 a[228:229], v26 offset:12288
    s_lshl_b32 s20, s3, 13
    s_add_u32 m0, s20, 45056
    s_add_u32 s91, s75, 28672
    v_mfma_f32_16x16x32_bf16 v[148:151], a[216:219], a[132:135], v[148:151]
    ds_read_b64_tr_b16 a[230:231], v26 offset:14336
    buffer_load_dwordx4 v17, s[40:43], s91 offen  lds
    v_mfma_f32_16x16x32_bf16 v[152:155], a[216:219], a[136:139], v[152:155]
    ds_read_b64_tr_b16 a[232:233], v26 offset:24576
    v_mfma_f32_16x16x32_bf16 v[136:139], a[220:223], a[140:143], v[136:139]
    ds_read_b64_tr_b16 a[234:235], v26 offset:26624
    buffer_load_dwordx4 v18, s[40:43], s91 offen offset:1024  lds
    v_mfma_f32_16x16x32_bf16 v[140:143], a[220:223], a[144:147], v[140:143]
    ds_read_b64_tr_b16 a[236:237], v26 offset:28672
    v_mfma_f32_16x16x32_bf16 v[144:147], a[220:223], a[148:151], v[144:147]
    ds_read_b64_tr_b16 a[238:239], v26 offset:30720
    buffer_load_dwordx4 v19, s[40:43], s91 offen offset:2048  lds
    v_mfma_f32_16x16x32_bf16 v[148:151], a[220:223], a[152:155], v[148:151]
    v_mfma_f32_16x16x32_bf16 v[152:155], a[220:223], a[156:159], v[152:155]
    buffer_load_dwordx4 v20, s[40:43], s91 offen offset:3072  lds
    s_waitcnt lgkmcnt(7)
    v_mfma_f32_16x16x32_bf16 v[156:159], a[240:243], a[0:3], 0
    v_mfma_f32_16x16x32_bf16 v[160:163], a[240:243], a[4:7], 0
    v_mfma_f32_16x16x32_bf16 v[164:167], a[240:243], a[8:11], 0
    v_mfma_f32_16x16x32_bf16 v[168:171], a[240:243], a[12:15], 0
    v_mfma_f32_16x16x32_bf16 v[172:175], a[240:243], a[16:19], 0
    v_mul_f32 v136, v46, v136
    v_mul_f32 v137, v46, v137
    v_mul_f32 v138, v46, v138
    v_mfma_f32_16x16x32_bf16 v[156:159], a[244:247], a[20:23], v[156:159]
    v_mul_f32 v139, v46, v139
    v_cvt_pk_bf16_f32 v80, v136, v137
    v_mfma_f32_16x16x32_bf16 v[160:163], a[244:247], a[24:27], v[160:163]
    v_cvt_pk_bf16_f32 v81, v138, v139
    v_mul_f32 v140, v47, v140
    v_mul_f32 v141, v47, v141
    v_mfma_f32_16x16x32_bf16 v[164:167], a[244:247], a[28:31], v[164:167]
    v_mul_f32 v142, v47, v142
    v_mul_f32 v143, v47, v143
    v_mfma_f32_16x16x32_bf16 v[168:171], a[244:247], a[32:35], v[168:171]
    v_cvt_pk_bf16_f32 v82, v140, v141
    v_cvt_pk_bf16_f32 v83, v142, v143
    v_mfma_f32_16x16x32_bf16 v[172:175], a[244:247], a[36:39], v[172:175]
    s_mov_b32 s21, 73728
    buffer_store_dwordx4 v[80:83], v39, s[44:47], s21 offen sc1
    v_mfma_f32_16x16x32_bf16 v[156:159], a[248:251], a[40:43], v[156:159]
    v_mfma_f32_16x16x32_bf16 v[160:163], a[248:251], a[44:47], v[160:163]
    v_mul_f32 v144, v48, v144
    v_mul_f32 v145, v48, v145
    v_mul_f32 v146, v48, v146
    v_mfma_f32_16x16x32_bf16 v[164:167], a[248:251], a[48:51], v[164:167]
    v_mul_f32 v147, v48, v147
    v_cvt_pk_bf16_f32 v84, v144, v145
    v_cvt_pk_bf16_f32 v85, v146, v147
    v_mfma_f32_16x16x32_bf16 v[168:171], a[248:251], a[52:55], v[168:171]
    v_mul_f32 v148, v49, v148
    v_mul_f32 v149, v49, v149
    v_mfma_f32_16x16x32_bf16 v[172:175], a[248:251], a[56:59], v[172:175]
    v_mul_f32 v150, v49, v150
    v_mul_f32 v151, v49, v151
    v_cvt_pk_bf16_f32 v86, v148, v149
    v_mfma_f32_16x16x32_bf16 v[156:159], a[252:255], a[60:63], v[156:159]
    v_cvt_pk_bf16_f32 v87, v150, v151
    v_mfma_f32_16x16x32_bf16 v[160:163], a[252:255], a[64:67], v[160:163]
    buffer_store_dwordx4 v[84:87], v40, s[44:47], s21 offen sc1
    v_mfma_f32_16x16x32_bf16 v[164:167], a[252:255], a[68:71], v[164:167]
    v_mul_f32 v152, v50, v152
    v_mul_f32 v153, v50, v153
    v_mfma_f32_16x16x32_bf16 v[168:171], a[252:255], a[72:75], v[168:171]
    v_mul_f32 v154, v50, v154
    v_mul_f32 v155, v50, v155
    v_mfma_f32_16x16x32_bf16 v[172:175], a[252:255], a[76:79], v[172:175]
    v_cvt_pk_bf16_f32 v78, v152, v153
    v_cvt_pk_bf16_f32 v79, v154, v155
    s_waitcnt lgkmcnt(0)
    v_mfma_f32_16x16x32_bf16 v[156:159], a[224:227], a[80:83], v[156:159]
    s_mov_b32 s21, 118784
    buffer_store_dwordx4 v[76:79], v39, s[44:47], s21 offen sc1
    v_mfma_f32_16x16x32_bf16 v[160:163], a[224:227], a[84:87], v[160:163]
    v_mfma_f32_16x16x32_bf16 v[164:167], a[224:227], a[88:91], v[164:167]
    s_waitcnt vmcnt(13)
    s_barrier
    v_mfma_f32_16x16x32_bf16 v[168:171], a[224:227], a[92:95], v[168:171]
    ds_read_b64_tr_b16 a[240:241], v25 offset:0
    ds_read_b64_tr_b16 a[242:243], v25 offset:2048
    v_mfma_f32_16x16x32_bf16 v[172:175], a[224:227], a[96:99], v[172:175]
    ds_read_b64_tr_b16 a[244:245], v25 offset:4096
    s_add_u32 m0, s98, 8192
    v_mfma_f32_16x16x32_bf16 v[156:159], a[228:231], a[100:103], v[156:159]
    ds_read_b64_tr_b16 a[246:247], v25 offset:6144
    buffer_load_dwordx4 v17, s[40:43], s76 offen  lds
    v_mfma_f32_16x16x32_bf16 v[160:163], a[228:231], a[104:107], v[160:163]
    ds_read_b64_tr_b16 a[248:249], v25 offset:16384
    buffer_load_dwordx4 v18, s[40:43], s76 offen offset:1024  lds
    v_mfma_f32_16x16x32_bf16 v[164:167], a[228:231], a[108:111], v[164:167]
    ds_read_b64_tr_b16 a[250:251], v25 offset:18432
    v_mfma_f32_16x16x32_bf16 v[168:171], a[228:231], a[112:115], v[168:171]
    ds_read_b64_tr_b16 a[252:253], v25 offset:20480
    buffer_load_dwordx4 v19, s[40:43], s76 offen offset:2048  lds
    v_mfma_f32_16x16x32_bf16 v[172:175], a[228:231], a[116:119], v[172:175]
    ds_read_b64_tr_b16 a[254:255], v25 offset:22528
    v_mfma_f32_16x16x32_bf16 v[156:159], a[232:235], a[120:123], v[156:159]
    ds_read_b64_tr_b16 a[208:209], v26 offset:0
    buffer_load_dwordx4 v20, s[40:43], s76 offen offset:3072  lds
    v_mfma_f32_16x16x32_bf16 v[160:163], a[232:235], a[124:127], v[160:163]
    ds_read_b64_tr_b16 a[210:211], v26 offset:2048
    v_mfma_f32_16x16x32_bf16 v[164:167], a[232:235], a[128:131], v[164:167]
    ds_read_b64_tr_b16 a[212:213], v26 offset:4096
    s_add_u32 m0, s98, 12288
    s_add_u32 s91, s76, 28672
    v_mfma_f32_16x16x32_bf16 v[168:171], a[232:235], a[132:135], v[168:171]
    ds_read_b64_tr_b16 a[214:215], v26 offset:6144
    buffer_load_dwordx4 v17, s[40:43], s91 offen  lds
    v_mfma_f32_16x16x32_bf16 v[172:175], a[232:235], a[136:139], v[172:175]
    ds_read_b64_tr_b16 a[216:217], v26 offset:16384
    v_mfma_f32_16x16x32_bf16 v[156:159], a[236:239], a[140:143], v[156:159]
    ds_read_b64_tr_b16 a[218:219], v26 offset:18432
    buffer_load_dwordx4 v18, s[40:43], s91 offen offset:1024  lds
    v_mfma_f32_16x16x32_bf16 v[160:163], a[236:239], a[144:147], v[160:163]
    ds_read_b64_tr_b16 a[220:221], v26 offset:20480
    v_mfma_f32_16x16x32_bf16 v[164:167], a[236:239], a[148:151], v[164:167]
    ds_read_b64_tr_b16 a[222:223], v26 offset:22528
    buffer_load_dwordx4 v19, s[40:43], s91 offen offset:2048  lds
    v_mfma_f32_16x16x32_bf16 v[168:171], a[236:239], a[152:155], v[168:171]
    v_mfma_f32_16x16x32_bf16 v[172:175], a[236:239], a[156:159], v[172:175]
    buffer_load_dwordx4 v20, s[40:43], s91 offen offset:3072  lds
    s_waitcnt lgkmcnt(7)
    v_mfma_f32_16x16x32_bf16 v[176:179], a[240:243], a[0:3], 0
    v_mfma_f32_16x16x32_bf16 v[180:183], a[240:243], a[4:7], 0
    v_mfma_f32_16x16x32_bf16 v[184:187], a[240:243], a[8:11], 0
    s_xor_b32 s51, s19, 1
    v_mfma_f32_16x16x32_bf16 v[188:191], a[240:243], a[12:15], 0
    v_mfma_f32_16x16x32_bf16 v[192:195], a[240:243], a[16:19], 0
    v_readfirstlane_b32 s22, v30
    s_nop 1
    s_cmp_ge_u32 s22, 32
    s_cbranch_scc0 L_cnt5
L_cntok5:
    v_mfma_f32_16x16x32_bf16 v[176:179], a[244:247], a[20:23], v[176:179]
    s_mov_b64 exec, 0x1000c000
    buffer_atomic_or v34, v2, s[80:83], 0 offen sc1
    s_mov_b64 exec, -1
    v_mfma_f32_16x16x32_bf16 v[180:183], a[244:247], a[24:27], v[180:183]
    s_mul_i32 s51, s51, 7
    s_lshr_b32 s50, s51, 4
    v_mul_f32 v156, v46, v156
    v_mfma_f32_16x16x32_bf16 v[184:187], a[244:247], a[28:31], v[184:187]
    v_mul_f32 v157, v46, v157
    v_mul_f32 v158, v46, v158
    v_mul_f32 v159, v46, v159
    v_mfma_f32_16x16x32_bf16 v[188:191], a[244:247], a[32:35], v[188:191]
    v_cvt_pk_bf16_f32 v56, v156, v157
    v_cvt_pk_bf16_f32 v57, v158, v159
    v_mul_f32 v160, v47, v160
    v_mfma_f32_16x16x32_bf16 v[192:195], a[244:247], a[36:39], v[192:195]
    v_mul_f32 v161, v47, v161
    v_mul_f32 v162, v47, v162
    v_mfma_f32_16x16x32_bf16 v[176:179], a[248:251], a[40:43], v[176:179]
    v_mul_f32 v163, v47, v163
    v_cvt_pk_bf16_f32 v58, v160, v161
    v_cvt_pk_bf16_f32 v59, v162, v163
    v_mfma_f32_16x16x32_bf16 v[180:183], a[248:251], a[44:47], v[180:183]
    s_lshr_b32 s48, s8, 1
    s_and_b32 s49, s8, 1
    v_mfma_f32_16x16x32_bf16 v[184:187], a[248:251], a[48:51], v[184:187]
    s_mov_b32 s21, 81920
    buffer_store_dwordx4 v[56:59], v39, s[44:47], s21 offen sc1
    v_mfma_f32_16x16x32_bf16 v[188:191], a[248:251], a[52:55], v[188:191]
    s_mul_i32 s79, s49, 28672
    v_mul_f32 v164, v48, v164
    v_mul_f32 v165, v48, v165
    v_mfma_f32_16x16x32_bf16 v[192:195], a[248:251], a[56:59], v[192:195]
    s_cmp_ge_u32 s8, 14
    s_cselect_b32 s48, 0, s48
    s_cselect_b32 s50, s23, s50
    s_cselect_b32 s51, 0, 71680
    v_mul_f32 v166, v48, v166
    v_mul_f32 v167, v48, v167
    v_mfma_f32_16x16x32_bf16 v[176:179], a[252:255], a[60:63], v[176:179]
    v_cvt_pk_bf16_f32 v60, v164, v165
    v_cvt_pk_bf16_f32 v61, v166, v167
    v_mul_f32 v168, v49, v168
    v_mfma_f32_16x16x32_bf16 v[180:183], a[252:255], a[64:67], v[180:183]
    v_mul_f32 v169, v49, v169
    v_mul_f32 v170, v49, v170
    v_mul_f32 v171, v49, v171
    v_mfma_f32_16x16x32_bf16 v[184:187], a[252:255], a[68:71], v[184:187]
    v_cvt_pk_bf16_f32 v62, v168, v169
    v_cvt_pk_bf16_f32 v63, v170, v171
    v_mfma_f32_16x16x32_bf16 v[188:191], a[252:255], a[72:75], v[188:191]
    buffer_store_dwordx4 v[60:63], v40, s[44:47], s21 offen sc1
    v_mfma_f32_16x16x32_bf16 v[192:195], a[252:255], a[76:79], v[192:195]
    s_add_u32 s79, s79, s51
    s_add_u32 s48, s48, s50
    v_mul_f32 v172, v50, v172
    s_waitcnt lgkmcnt(0)
    v_mfma_f32_16x16x32_bf16 v[176:179], a[208:211], a[80:83], v[176:179]
    s_cmp_ge_u32 s48, 7
    s_cselect_b32 s52, 7, 0
    v_mul_f32 v173, v50, v173
    v_mul_f32 v174, v50, v174
    v_mfma_f32_16x16x32_bf16 v[180:183], a[208:211], a[84:87], v[180:183]
    v_mul_f32 v175, v50, v175
    v_cvt_pk_bf16_f32 v88, v172, v173
    v_cvt_pk_bf16_f32 v89, v174, v175
    v_mfma_f32_16x16x32_bf16 v[184:187], a[208:211], a[88:91], v[184:187]
    s_waitcnt vmcnt(14)
    s_barrier
    v_mfma_f32_16x16x32_bf16 v[188:191], a[208:211], a[92:95], v[188:191]
    ds_read_b64_tr_b16 a[240:241], v27 offset:0
    ds_read_b64_tr_b16 a[242:243], v27 offset:2048
    v_mfma_f32_16x16x32_bf16 v[192:195], a[208:211], a[96:99], v[192:195]
    ds_read_b64_tr_b16 a[244:245], v27 offset:4096
    s_sub_u32 s48, s48, s52
    v_mfma_f32_16x16x32_bf16 v[176:179], a[212:215], a[100:103], v[176:179]
    ds_read_b64_tr_b16 a[246:247], v27 offset:6144
    s_lshl_b32 s52, s48, 7
    v_mfma_f32_16x16x32_bf16 v[180:183], a[212:215], a[104:107], v[180:183]
    ds_read_b64_tr_b16 a[248:249], v27 offset:8192
    s_add_u32 s79, s79, s52
    v_mfma_f32_16x16x32_bf16 v[184:187], a[212:215], a[108:111], v[184:187]
    ds_read_b64_tr_b16 a[250:251], v27 offset:10240
    v_mfma_f32_16x16x32_bf16 v[188:191], a[212:215], a[112:115], v[188:191]
    ds_read_b64_tr_b16 a[252:253], v27 offset:12288
    s_add_u32 s78, s79, 14336
    v_mfma_f32_16x16x32_bf16 v[192:195], a[212:215], a[116:119], v[192:195]
    ds_read_b64_tr_b16 a[254:255], v27 offset:14336
    v_mfma_f32_16x16x32_bf16 v[176:179], a[216:219], a[120:123], v[176:179]
    ds_read_b64_tr_b16 a[224:225], v27 offset:16384
    s_add_u32 s51, s8, 0
    v_mfma_f32_16x16x32_bf16 v[180:183], a[216:219], a[124:127], v[180:183]
    ds_read_b64_tr_b16 a[226:227], v27 offset:18432
    v_mfma_f32_16x16x32_bf16 v[184:187], a[216:219], a[128:131], v[184:187]
    ds_read_b64_tr_b16 a[228:229], v27 offset:20480
    s_lshl_b32 s51, s51, 12
    v_mfma_f32_16x16x32_bf16 v[188:191], a[216:219], a[132:135], v[188:191]
    ds_read_b64_tr_b16 a[230:231], v27 offset:22528
    v_mfma_f32_16x16x32_bf16 v[192:195], a[216:219], a[136:139], v[192:195]
    ds_read_b64_tr_b16 a[232:233], v27 offset:24576
    s_lshl_b32 s49, s3, 5
    v_mfma_f32_16x16x32_bf16 v[176:179], a[220:223], a[140:143], v[176:179]
    ds_read_b64_tr_b16 a[234:235], v27 offset:26624
    v_mfma_f32_16x16x32_bf16 v[180:183], a[220:223], a[144:147], v[180:183]
    ds_read_b64_tr_b16 a[236:237], v27 offset:28672
    s_mov_b32 s77, 0xffff
    v_mfma_f32_16x16x32_bf16 v[184:187], a[220:223], a[148:151], v[184:187]
    ds_read_b64_tr_b16 a[238:239], v27 offset:30720
    v_mfma_f32_16x16x32_bf16 v[188:191], a[220:223], a[152:155], v[188:191]
    v_mfma_f32_16x16x32_bf16 v[192:195], a[220:223], a[156:159], v[192:195]
    s_waitcnt lgkmcnt(7)
    v_mfma_f32_16x16x32_bf16 v[196:199], a[240:243], a[0:3], 0
    v_add_u32 v3, s51, v39
    v_mfma_f32_16x16x32_bf16 v[200:203], a[240:243], a[4:7], 0
    v_and_b32 v13, 15, v0
    v_mfma_f32_16x16x32_bf16 v[204:207], a[240:243], a[8:11], 0
    v_mul_u32_u24 v13, 896, v13
    v_mfma_f32_16x16x32_bf16 v[208:211], a[240:243], a[12:15], 0
    v_lshrrev_b32 v14, 4, v0
    v_lshl_add_u32 v13, v14, 3, v13
    v_mfma_f32_16x16x32_bf16 v[212:215], a[240:243], a[16:19], 0
    s_mov_b64 exec, 0x30000
    buffer_atomic_or v34, v2, s[80:83], 0 offen sc1
    s_mov_b64 exec, -1
    v_mfma_f32_16x16x32_bf16 v[196:199], a[244:247], a[20:23], v[196:199]
    v_mul_f32 v176, v46, v176
    v_mul_f32 v177, v46, v177
    v_mfma_f32_16x16x32_bf16 v[200:203], a[244:247], a[24:27], v[200:203]
    v_mul_f32 v178, v46, v178
    v_mul_f32 v179, v46, v179
    v_cvt_pk_bf16_f32 v68, v176, v177
    v_mfma_f32_16x16x32_bf16 v[204:207], a[244:247], a[28:31], v[204:207]
    v_cvt_pk_bf16_f32 v69, v178, v179
    v_mul_f32 v180, v47, v180
    v_mul_f32 v181, v47, v181
    v_mfma_f32_16x16x32_bf16 v[208:211], a[244:247], a[32:35], v[208:211]
    v_mul_f32 v182, v47, v182
    v_mul_f32 v183, v47, v183
    v_mfma_f32_16x16x32_bf16 v[212:215], a[244:247], a[36:39], v[212:215]
    v_cvt_pk_bf16_f32 v70, v180, v181
    v_cvt_pk_bf16_f32 v71, v182, v183
    v_mfma_f32_16x16x32_bf16 v[196:199], a[248:251], a[40:43], v[196:199]
    s_mov_b32 s21, 90112
    buffer_store_dwordx4 v[68:71], v39, s[44:47], s21 offen sc1
    v_mfma_f32_16x16x32_bf16 v[200:203], a[248:251], a[44:47], v[200:203]
    v_mul_f32 v184, v48, v184
    v_mfma_f32_16x16x32_bf16 v[204:207], a[248:251], a[48:51], v[204:207]
    v_mul_f32 v185, v48, v185
    v_mul_f32 v186, v48, v186
    v_mul_f32 v187, v48, v187
    v_mfma_f32_16x16x32_bf16 v[208:211], a[248:251], a[52:55], v[208:211]
    v_cvt_pk_bf16_f32 v72, v184, v185
    v_cvt_pk_bf16_f32 v73, v186, v187
    v_mfma_f32_16x16x32_bf16 v[212:215], a[248:251], a[56:59], v[212:215]
    v_mul_f32 v188, v49, v188
    v_mul_f32 v189, v49, v189
    v_mul_f32 v190, v49, v190
    v_mfma_f32_16x16x32_bf16 v[196:199], a[252:255], a[60:63], v[196:199]
    v_mul_f32 v191, v49, v191
    v_cvt_pk_bf16_f32 v74, v188, v189
    v_cvt_pk_bf16_f32 v75, v190, v191
    v_mfma_f32_16x16x32_bf16 v[200:203], a[252:255], a[64:67], v[200:203]
    buffer_store_dwordx4 v[72:75], v40, s[44:47], s21 offen sc1
    v_mfma_f32_16x16x32_bf16 v[204:207], a[252:255], a[68:71], v[204:207]
    v_mul_f32 v192, v50, v192
    v_mfma_f32_16x16x32_bf16 v[208:211], a[252:255], a[72:75], v[208:211]
    v_mul_f32 v193, v50, v193
    v_mul_f32 v194, v50, v194
    v_mul_f32 v195, v50, v195
    v_mfma_f32_16x16x32_bf16 v[212:215], a[252:255], a[76:79], v[212:215]
    v_cvt_pk_bf16_f32 v90, v192, v193
    v_cvt_pk_bf16_f32 v91, v194, v195
    s_waitcnt lgkmcnt(0)
    v_mfma_f32_16x16x32_bf16 v[196:199], a[224:227], a[80:83], v[196:199]
    s_mov_b32 s21, 122880
    buffer_store_dwordx4 v[88:91], v39, s[44:47], s21 offen sc1
    v_mfma_f32_16x16x32_bf16 v[200:203], a[224:227], a[84:87], v[200:203]
    v_add_u32 v28, s49, v13
    v_mfma_f32_16x16x32_bf16 v[204:207], a[224:227], a[88:91], v[204:207]
    s_waitcnt vmcnt(7)
    s_barrier
    v_mfma_f32_16x16x32_bf16 v[208:211], a[224:227], a[92:95], v[208:211]
    ds_read_b64_tr_b16 a[240:241], v25 offset:8192
    ds_read_b64_tr_b16 a[242:243], v25 offset:10240
    v_mfma_f32_16x16x32_bf16 v[212:215], a[224:227], a[96:99], v[212:215]
    ds_read_b64_tr_b16 a[244:245], v25 offset:12288
    v_mfma_f32_16x16x32_bf16 v[196:199], a[228:231], a[100:103], v[196:199]
    ds_read_b64_tr_b16 a[246:247], v25 offset:14336
    v_mfma_f32_16x16x32_bf16 v[200:203], a[228:231], a[104:107], v[200:203]
    ds_read_b64_tr_b16 a[248:249], v25 offset:24576
    v_mfma_f32_16x16x32_bf16 v[204:207], a[228:231], a[108:111], v[204:207]
    ds_read_b64_tr_b16 a[250:251], v25 offset:26624
    v_mfma_f32_16x16x32_bf16 v[208:211], a[228:231], a[112:115], v[208:211]
    ds_read_b64_tr_b16 a[252:253], v25 offset:28672
    v_mfma_f32_16x16x32_bf16 v[212:215], a[228:231], a[116:119], v[212:215]
    ds_read_b64_tr_b16 a[254:255], v25 offset:30720
    v_mfma_f32_16x16x32_bf16 v[196:199], a[232:235], a[120:123], v[196:199]
    ds_read_b64_tr_b16 a[208:209], v26 offset:8192
    v_mfma_f32_16x16x32_bf16 v[200:203], a[232:235], a[124:127], v[200:203]
    ds_read_b64_tr_b16 a[210:211], v26 offset:10240
    v_mfma_f32_16x16x32_bf16 v[204:207], a[232:235], a[128:131], v[204:207]
    ds_read_b64_tr_b16 a[212:213], v26 offset:12288
    v_mfma_f32_16x16x32_bf16 v[208:211], a[232:235], a[132:135], v[208:211]
    ds_read_b64_tr_b16 a[214:215], v26 offset:14336
    v_mfma_f32_16x16x32_bf16 v[212:215], a[232:235], a[136:139], v[212:215]
    ds_read_b64_tr_b16 a[216:217], v26 offset:24576
    v_mfma_f32_16x16x32_bf16 v[196:199], a[236:239], a[140:143], v[196:199]
    ds_read_b64_tr_b16 a[218:219], v26 offset:26624
    v_mfma_f32_16x16x32_bf16 v[200:203], a[236:239], a[144:147], v[200:203]
    ds_read_b64_tr_b16 a[220:221], v26 offset:28672
    v_mfma_f32_16x16x32_bf16 v[204:207], a[236:239], a[148:151], v[204:207]
    ds_read_b64_tr_b16 a[222:223], v26 offset:30720
    v_mfma_f32_16x16x32_bf16 v[208:211], a[236:239], a[152:155], v[208:211]
    v_mfma_f32_16x16x32_bf16 v[212:215], a[236:239], a[156:159], v[212:215]
    v_mov_b32 v31, 0
    s_waitcnt lgkmcnt(8)
    v_mfma_f32_16x16x32_bf16 v[216:219], a[240:243], a[0:3], 0
    buffer_atomic_or v31, v1, s[80:83], 0 offen sc0 sc1
    v_mfma_f32_16x16x32_bf16 v[216:219], a[244:247], a[20:23], v[216:219]
    v_mfma_f32_16x16x32_bf16 v[216:219], a[248:251], a[40:43], v[216:219]
    v_mfma_f32_16x16x32_bf16 v[216:219], a[252:255], a[60:63], v[216:219]
    s_waitcnt lgkmcnt(4)
    v_mfma_f32_16x16x32_bf16 v[216:219], a[208:211], a[80:83], v[216:219]
    s_mov_b64 exec, 0x200c0000
    buffer_atomic_or v34, v2, s[80:83], 0 offen sc1
    s_mov_b64 exec, -1
    v_mfma_f32_16x16x32_bf16 v[216:219], a[212:215], a[100:103], v[216:219]
    v_mul_f32 v196, v46, v196
    v_mul_f32 v197, v46, v197
    s_waitcnt lgkmcnt(2)
    v_mfma_f32_16x16x32_bf16 v[216:219], a[216:219], a[120:123], v[216:219]
    v_mul_f32 v198, v46, v198
    v_mul_f32 v199, v46, v199
    v_cvt_pk_bf16_f32 v80, v196, v197
    s_waitcnt lgkmcnt(0)
    v_mfma_f32_16x16x32_bf16 v[216:219], a[220:223], a[140:143], v[216:219]
    v_cvt_pk_bf16_f32 v81, v198, v199
    v_mul_f32 v200, v47, v200
    v_mfma_f32_16x16x32_bf16 v[220:223], a[240:243], a[4:7], 0
    v_mul_f32 v201, v47, v201
    v_mul_f32 v202, v47, v202
    v_mul_f32 v203, v47, v203
    v_mfma_f32_16x16x32_bf16 v[220:223], a[244:247], a[24:27], v[220:223]
    v_cvt_pk_bf16_f32 v82, v200, v201
    v_cvt_pk_bf16_f32 v83, v202, v203
    v_mfma_f32_16x16x32_bf16 v[220:223], a[248:251], a[44:47], v[220:223]
    s_mov_b32 s21, 98304
    buffer_store_dwordx4 v[80:83], v39, s[44:47], s21 offen sc1
    v_mfma_f32_16x16x32_bf16 v[220:223], a[252:255], a[64:67], v[220:223]
    v_mul_f32 v204, v48, v204
    v_mfma_f32_16x16x32_bf16 v[220:223], a[208:211], a[84:87], v[220:223]
    v_mul_f32 v205, v48, v205
    v_mul_f32 v206, v48, v206
    v_mfma_f32_16x16x32_bf16 v[220:223], a[212:215], a[104:107], v[220:223]
    v_mul_f32 v207, v48, v207
    v_cvt_pk_bf16_f32 v84, v204, v205
    v_cvt_pk_bf16_f32 v85, v206, v207
    v_mfma_f32_16x16x32_bf16 v[220:223], a[216:219], a[124:127], v[220:223]
    v_mul_f32 v208, v49, v208
    v_mul_f32 v209, v49, v209
    v_mul_f32 v210, v49, v210
    v_mfma_f32_16x16x32_bf16 v[220:223], a[220:223], a[144:147], v[220:223]
    v_mul_f32 v211, v49, v211
    v_cvt_pk_bf16_f32 v86, v208, v209
    v_cvt_pk_bf16_f32 v87, v210, v211
    v_mfma_f32_16x16x32_bf16 v[224:227], a[240:243], a[8:11], 0
    buffer_store_dwordx4 v[84:87], v40, s[44:47], s21 offen sc1
    v_mfma_f32_16x16x32_bf16 v[224:227], a[244:247], a[28:31], v[224:227]
    v_mfma_f32_16x16x32_bf16 v[224:227], a[248:251], a[48:51], v[224:227]
    v_mul_f32 v212, v50, v212
    v_mul_f32 v213, v50, v213
    v_mul_f32 v214, v50, v214
    v_mfma_f32_16x16x32_bf16 v[224:227], a[252:255], a[68:71], v[224:227]
    v_mul_f32 v215, v50, v215
    v_cvt_pk_bf16_f32 v64, v212, v213
    v_cvt_pk_bf16_f32 v65, v214, v215
    v_mfma_f32_16x16x32_bf16 v[224:227], a[208:211], a[88:91], v[224:227]
    s_waitcnt vmcnt(8)
    s_mov_b64 exec, 0x300000
    buffer_atomic_or v34, v2, s[80:83], 0 offen sc1
    s_mov_b64 exec, -1
    v_mfma_f32_16x16x32_bf16 v[224:227], a[212:215], a[108:111], v[224:227]
    v_mul_f32 v216, v46, v216
    v_mul_f32 v217, v46, v217
    v_mul_f32 v218, v46, v218
    v_mfma_f32_16x16x32_bf16 v[224:227], a[216:219], a[128:131], v[224:227]
    v_mul_f32 v219, v46, v219
    v_cvt_pk_bf16_f32 v56, v216, v217
    v_cvt_pk_bf16_f32 v57, v218, v219
    v_mfma_f32_16x16x32_bf16 v[224:227], a[220:223], a[148:151], v[224:227]
    v_mul_f32 v220, v47, v220
    v_mul_f32 v221, v47, v221
    v_mul_f32 v222, v47, v222
    v_mul_f32 v223, v47, v223
    v_mfma_f32_16x16x32_bf16 v[228:231], a[240:243], a[12:15], 0
    v_cvt_pk_bf16_f32 v58, v220, v221
    v_cvt_pk_bf16_f32 v59, v222, v223
    v_mfma_f32_16x16x32_bf16 v[228:231], a[244:247], a[32:35], v[228:231]
    s_mov_b32 s21, 106496
    buffer_store_dwordx4 v[56:59], v39, s[44:47], s21 offen sc1
    v_mfma_f32_16x16x32_bf16 v[228:231], a[248:251], a[52:55], v[228:231]
    v_mfma_f32_16x16x32_bf16 v[228:231], a[252:255], a[72:75], v[228:231]
    v_mfma_f32_16x16x32_bf16 v[228:231], a[208:211], a[92:95], v[228:231]
    v_mul_f32 v224, v48, v224
    v_mul_f32 v225, v48, v225
    v_mfma_f32_16x16x32_bf16 v[228:231], a[212:215], a[112:115], v[228:231]
    v_mul_f32 v226, v48, v226
    v_mul_f32 v227, v48, v227
    v_mfma_f32_16x16x32_bf16 v[228:231], a[216:219], a[132:135], v[228:231]
    v_cvt_pk_bf16_f32 v60, v224, v225
    v_cvt_pk_bf16_f32 v61, v226, v227
    v_mfma_f32_16x16x32_bf16 v[228:231], a[220:223], a[152:155], v[228:231]
    v_mfma_f32_16x16x32_bf16 v[232:235], a[240:243], a[16:19], 0
    v_mfma_f32_16x16x32_bf16 v[232:235], a[244:247], a[36:39], v[232:235]
    v_mfma_f32_16x16x32_bf16 v[232:235], a[248:251], a[56:59], v[232:235]
    v_mfma_f32_16x16x32_bf16 v[232:235], a[252:255], a[76:79], v[232:235]
    v_mfma_f32_16x16x32_bf16 v[232:235], a[208:211], a[96:99], v[232:235]
    s_nop 2
    v_mul_f32 v228, v49, v228
    v_mul_f32 v229, v49, v229
    v_mul_f32 v230, v49, v230
    v_mul_f32 v231, v49, v231
    v_mfma_f32_16x16x32_bf16 v[232:235], a[212:215], a[116:119], v[232:235]
    v_cvt_pk_bf16_f32 v62, v228, v229
    v_cvt_pk_bf16_f32 v63, v230, v231
    v_mfma_f32_16x16x32_bf16 v[232:235], a[216:219], a[136:139], v[232:235]
    buffer_store_dwordx4 v[60:63], v40, s[44:47], s21 offen sc1
    v_mfma_f32_16x16x32_bf16 v[232:235], a[220:223], a[156:159], v[232:235]
    s_nop 7
    v_mul_f32 v232, v50, v232
    v_mul_f32 v233, v50, v233
    v_mul_f32 v234, v50, v234
    v_mul_f32 v235, v50, v235
    v_cvt_pk_bf16_f32 v66, v232, v233
    v_cvt_pk_bf16_f32 v67, v234, v235
    s_mov_b32 s21, 126976
    buffer_store_dwordx4 v[64:67], v39, s[44:47], s21 offen sc1
    s_mul_i32 s20, s16, 2129920
    s_add_u32 s24, s14, s20
    s_addc_u32 s25, s15, 0
    s_mov_b32 s26, 2129920
    s_mov_b32 s27, 0x20000
    s_waitcnt vmcnt(7)
    v_readfirstlane_b32 s22, v31
    s_nop 1
    s_cmp_eq_u32 s22, s77
    s_cbranch_scc0 L_slow5
    s_mov_b32 s21, 0
    buffer_load_dwordx4 v[96:99], v3, s[24:27], s21 offen sc1
    s_mov_b32 s21, 133120
    buffer_load_dwordx4 v[100:103], v3, s[24:27], s21 offen sc1
    s_mov_b32 s21, 266240
    buffer_load_dwordx4 v[104:107], v3, s[24:27], s21 offen sc1
    s_mov_b32 s21, 399360
    buffer_load_dwordx4 v[108:111], v3, s[24:27], s21 offen sc1
    s_waitcnt vmcnt(4)
    s_mov_b32 exec_lo, 0xcfc00000
    s_mov_b32 exec_hi, 0
    buffer_atomic_or v34, v2, s[80:83], 0 offen sc1
    s_mov_b64 exec, -1
    s_branch L_join5
L_slow5:
    v_mov_b32 v31, 0
    buffer_atomic_or v31, v1, s[80:83], 0 offen sc0 sc1
    s_mov_b32 s20, 0
    s_waitcnt vmcnt(1)
    s_mov_b32 exec_lo, 0xcfc00000
    s_mov_b32 exec_hi, 0
    buffer_atomic_or v34, v2, s[80:83], 0 offen sc1
    s_mov_b64 exec, -1
    s_waitcnt vmcnt(1)
    s_branch L_got5
L_poll5:
    s_sleep 1
    v_mov_b32 v31, 0
    buffer_atomic_or v31, v1, s[80:83], 0 offen sc0 sc1
    s_waitcnt vmcnt(0)
L_got5:
    v_readfirstlane_b32 s22, v31
    s_add_u32 s20, s20, 1
    s_cmp_ge_u32 s20, 400000
    s_cselect_b32 s22, s77, s22
    s_cmp_eq_u32 s22, s77
    s_cbranch_scc0 L_poll5
    s_mov_b32 s21, 0
    buffer_load_dwordx4 v[96:99], v3, s[24:27], s21 offen sc1
    s_mov_b32 s21, 133120
    buffer_load_dwordx4 v[100:103], v3, s[24:27], s21 offen sc1
    s_mov_b32 s21, 266240
    buffer_load_dwordx4 v[104:107], v3, s[24:27], s21 offen sc1
    s_mov_b32 s21, 399360
    buffer_load_dwordx4 v[108:111], v3, s[24:27], s21 offen sc1
L_join5:
    s_mov_b32 s21, 532480
    buffer_load_dwordx4 v[112:115], v3, s[24:27], s21 offen sc1
    s_mov_b32 s21, 665600
    buffer_load_dwordx4 v[116:119], v3, s[24:27], s21 offen sc1
    s_mov_b32 s21, 798720
    buffer_load_dwordx4 v[120:123], v3, s[24:27], s21 offen sc1
    s_mov_b32 s21, 931840
    buffer_load_dwordx4 v[124:127], v3, s[24:27], s21 offen sc1
    s_mov_b32 s21, 1064960
    buffer_load_dwordx4 v[128:131], v3, s[24:27], s21 offen sc1
    s_mov_b32 s21, 1198080
    buffer_load_dwordx4 v[132:135], v3, s[24:27], s21 offen sc1
    s_mov_b32 s21, 1331200
    buffer_load_dwordx4 v[136:139], v3, s[24:27], s21 offen sc1
    s_mov_b32 s21, 1464320
    buffer_load_dwordx4 v[140:143], v3, s[24:27], s21 offen sc1
    s_mov_b32 s21, 1597440
    buffer_load_dwordx4 v[144:147], v3, s[24:27], s21 offen sc1
    s_mov_b32 s21, 1730560
    buffer_load_dwordx4 v[148:151], v3, s[24:27], s21 offen sc1
    s_mov_b32 s21, 1863680
    buffer_load_dwordx4 v[152:155], v3, s[24:27], s21 offen sc1
    s_mov_b32 s21, 1996800
    buffer_load_dwordx4 v[156:159], v3, s[24:27], s21 offen sc1
    s_mul_i32 s20, s16, 129024
    s_add_u32 s28, s88, s20
    s_addc_u32 s29, s89, 0
    s_mov_b32 s30, 129024
    s_mov_b32 s31, 0x20000
    s_mov_b32 s22, 0xffff0000
    s_waitcnt vmcnt(15)
    v_lshlrev_b32 v240, 16, v96
    v_and_b32 v241, s22, v96
    v_lshlrev_b32 v242, 16, v97
    v_and_b32 v243, s22, v97
    v_lshlrev_b32 v244, 16, v98
    v_and_b32 v245, s22, v98
    v_lshlrev_b32 v246, 16, v99
    v_and_b32 v247, s22, v99
    s_waitcnt vmcnt(14)
    v_lshlrev_b32 v248, 16, v100
    v_and_b32 v249, s22, v100
    v_pk_add_f32 v[240:241], v[240:241], v[248:249]
    v_lshlrev_b32 v250, 16, v101
    v_and_b32 v251, s22, v101
    v_pk_add_f32 v[242:243], v[242:243], v[250:251]
    v_lshlrev_b32 v248, 16, v102
    v_and_b32 v249, s22, v102
    v_pk_add_f32 v[244:245], v[244:245], v[248:249]
    v_lshlrev_b32 v250, 16, v103
    v_and_b32 v251, s22, v103
    v_pk_add_f32 v[246:247], v[246:247], v[250:251]
    s_waitcnt vmcnt(13)
    v_lshlrev_b32 v248, 16, v104
    v_and_b32 v249, s22, v104
    v_pk_add_f32 v[240:241], v[240:241], v[248:249]
    v_lshlrev_b32 v250, 16, v105
    v_and_b32 v251, s22, v105
    v_pk_add_f32 v[242:243], v[242:243], v[250:251]
    v_lshlrev_b32 v248, 16, v106
    v_and_b32 v249, s22, v106
    v_pk_add_f32 v[244:245], v[244:245], v[248:249]
    v_lshlrev_b32 v250, 16, v107
    v_and_b32 v251, s22, v107
    v_pk_add_f32 v[246:247], v[246:247], v[250:251]
    s_waitcnt vmcnt(12)
    v_lshlrev_b32 v248, 16, v108
    v_and_b32 v249, s22, v108
    v_pk_add_f32 v[240:241], v[240:241], v[248:249]
    v_lshlrev_b32 v250, 16, v109
    v_and_b32 v251, s22, v109
    v_pk_add_f32 v[242:243], v[242:243], v[250:251]
    v_lshlrev_b32 v248, 16, v110
    v_and_b32 v249, s22, v110
    v_pk_add_f32 v[244:245], v[244:245], v[248:249]
    v_lshlrev_b32 v250, 16, v111
    v_and_b32 v251, s22, v111
    v_pk_add_f32 v[246:247], v[246:247], v[250:251]
    s_waitcnt vmcnt(11)
    v_lshlrev_b32 v248, 16, v112
    v_and_b32 v249, s22, v112
    v_pk_add_f32 v[240:241], v[240:241], v[248:249]
    v_lshlrev_b32 v250, 16, v113
    v_and_b32 v251, s22, v113
    v_pk_add_f32 v[242:243], v[242:243], v[250:251]
    v_lshlrev_b32 v248, 16, v114
    v_and_b32 v249, s22, v114
    v_pk_add_f32 v[244:245], v[244:245], v[248:249]
    v_lshlrev_b32 v250, 16, v115
    v_and_b32 v251, s22, v115
    v_pk_add_f32 v[246:247], v[246:247], v[250:251]
    s_waitcnt vmcnt(10)
    v_lshlrev_b32 v248, 16, v116
    v_and_b32 v249, s22, v116
    v_pk_add_f32 v[240:241], v[240:241], v[248:249]
    v_lshlrev_b32 v250, 16, v117
    v_and_b32 v251, s22, v117
    v_pk_add_f32 v[242:243], v[242:243], v[250:251]
    v_lshlrev_b32 v248, 16, v118
    v_and_b32 v249, s22, v118
    v_pk_add_f32 v[244:245], v[244:245], v[248:249]
    v_lshlrev_b32 v250, 16, v119
    v_and_b32 v251, s22, v119
    v_pk_add_f32 v[246:247], v[246:247], v[250:251]
    s_waitcnt vmcnt(9)
    v_lshlrev_b32 v248, 16, v120
    v_and_b32 v249, s22, v120
    v_pk_add_f32 v[240:241], v[240:241], v[248:249]
    v_lshlrev_b32 v250, 16, v121
    v_and_b32 v251, s22, v121
    v_pk_add_f32 v[242:243], v[242:243], v[250:251]
    v_lshlrev_b32 v248, 16, v122
    v_and_b32 v249, s22, v122
    v_pk_add_f32 v[244:245], v[244:245], v[248:249]
    v_lshlrev_b32 v250, 16, v123
    v_and_b32 v251, s22, v123
    v_pk_add_f32 v[246:247], v[246:247], v[250:251]
    s_waitcnt vmcnt(8)
    v_lshlrev_b32 v248, 16, v124
    v_and_b32 v249, s22, v124
    v_pk_add_f32 v[240:241], v[240:241], v[248:249]
    v_lshlrev_b32 v250, 16, v125
    v_and_b32 v251, s22, v125
    v_pk_add_f32 v[242:243], v[242:243], v[250:251]
    v_lshlrev_b32 v248, 16, v126
    v_and_b32 v249, s22, v126
    v_pk_add_f32 v[244:245], v[244:245], v[248:249]
    v_lshlrev_b32 v250, 16, v127
    v_and_b32 v251, s22, v127
    v_pk_add_f32 v[246:247], v[246:247], v[250:251]
    s_waitcnt vmcnt(7)
    v_lshlrev_b32 v248, 16, v128
    v_and_b32 v249, s22, v128
    v_pk_add_f32 v[240:241], v[240:241], v[248:249]
    v_lshlrev_b32 v250, 16, v129
    v_and_b32 v251, s22, v129
    v_pk_add_f32 v[242:243], v[242:243], v[250:251]
    v_lshlrev_b32 v248, 16, v130
    v_and_b32 v249, s22, v130
    v_pk_add_f32 v[244:245], v[244:245], v[248:249]
    v_lshlrev_b32 v250, 16, v131
    v_and_b32 v251, s22, v131
    v_pk_add_f32 v[246:247], v[246:247], v[250:251]
    s_waitcnt vmcnt(6)
    v_lshlrev_b32 v248, 16, v132
    v_and_b32 v249, s22, v132
    v_pk_add_f32 v[240:241], v[240:241], v[248:249]
    v_lshlrev_b32 v250, 16, v133
    v_and_b32 v251, s22, v133
    v_pk_add_f32 v[242:243], v[242:243], v[250:251]
    v_lshlrev_b32 v248, 16, v134
    v_and_b32 v249, s22, v134
    v_pk_add_f32 v[244:245], v[244:245], v[248:249]
    v_lshlrev_b32 v250, 16, v135
    v_and_b32 v251, s22, v135
    v_pk_add_f32 v[246:247], v[246:247], v[250:251]
    s_waitcnt vmcnt(5)
    v_lshlrev_b32 v248, 16, v136
    v_and_b32 v249, s22, v136
    v_pk_add_f32 v[240:241], v[240:241], v[248:249]
    v_lshlrev_b32 v250, 16, v137
    v_and_b32 v251, s22, v137
    v_pk_add_f32 v[242:243], v[242:243], v[250:251]
    v_lshlrev_b32 v248, 16, v138
    v_and_b32 v249, s22, v138
    v_pk_add_f32 v[244:245], v[244:245], v[248:249]
    v_lshlrev_b32 v250, 16, v139
    v_and_b32 v251, s22, v139
    v_pk_add_f32 v[246:247], v[246:247], v[250:251]
    s_waitcnt vmcnt(4)
    v_lshlrev_b32 v248, 16, v140
    v_and_b32 v249, s22, v140
    v_pk_add_f32 v[240:241], v[240:241], v[248:249]
    v_lshlrev_b32 v250, 16, v141
    v_and_b32 v251, s22, v141
    v_pk_add_f32 v[242:243], v[242:243], v[250:251]
    v_lshlrev_b32 v248, 16, v142
    v_and_b32 v249, s22, v142
    v_pk_add_f32 v[244:245], v[244:245], v[248:249]
    v_lshlrev_b32 v250, 16, v143
    v_and_b32 v251, s22, v143
    v_pk_add_f32 v[246:247], v[246:247], v[250:251]
    s_waitcnt vmcnt(3)
    v_lshlrev_b32 v248, 16, v144
    v_and_b32 v249, s22, v144
    v_pk_add_f32 v[240:241], v[240:241], v[248:249]
    v_lshlrev_b32 v250, 16, v145
    v_and_b32 v251, s22, v145
    v_pk_add_f32 v[242:243], v[242:243], v[250:251]
    v_lshlrev_b32 v248, 16, v146
    v_and_b32 v249, s22, v146
    v_pk_add_f32 v[244:245], v[244:245], v[248:249]
    v_lshlrev_b32 v250, 16, v147
    v_and_b32 v251, s22, v147
    v_pk_add_f32 v[246:247], v[246:247], v[250:251]
    s_waitcnt vmcnt(2)
    v_lshlrev_b32 v248, 16, v148
    v_and_b32 v249, s22, v148
    v_pk_add_f32 v[240:241], v[240:241], v[248:249]
    v_lshlrev_b32 v250, 16, v149
    v_and_b32 v251, s22, v149
    v_pk_add_f32 v[242:243], v[242:243], v[250:251]
    v_lshlrev_b32 v248, 16, v150
    v_and_b32 v249, s22, v150
    v_pk_add_f32 v[244:245], v[244:245], v[248:249]
    v_lshlrev_b32 v250, 16, v151
    v_and_b32 v251, s22, v151
    v_pk_add_f32 v[246:247], v[246:247], v[250:251]
    s_waitcnt vmcnt(1)
    v_lshlrev_b32 v248, 16, v152
    v_and_b32 v249, s22, v152
    v_pk_add_f32 v[240:241], v[240:241], v[248:249]
    v_lshlrev_b32 v250, 16, v153
    v_and_b32 v251, s22, v153
    v_pk_add_f32 v[242:243], v[242:243], v[250:251]
    v_lshlrev_b32 v248, 16, v154
    v_and_b32 v249, s22, v154
    v_pk_add_f32 v[244:245], v[244:245], v[248:249]
    v_lshlrev_b32 v250, 16, v155
    v_and_b32 v251, s22, v155
    v_pk_add_f32 v[246:247], v[246:247], v[250:251]
    s_waitcnt vmcnt(0)
    v_lshlrev_b32 v248, 16, v156
    v_and_b32 v249, s22, v156
    v_pk_add_f32 v[240:241], v[240:241], v[248:249]
    v_lshlrev_b32 v250, 16, v157
    v_and_b32 v251, s22, v157
    v_pk_add_f32 v[242:243], v[242:243], v[250:251]
    v_lshlrev_b32 v248, 16, v158
    v_and_b32 v249, s22, v158
    v_pk_add_f32 v[244:245], v[244:245], v[248:249]
    v_lshlrev_b32 v250, 16, v159
    v_and_b32 v251, s22, v159
    v_pk_add_f32 v[246:247], v[246:247], v[250:251]
    v_cvt_pk_bf16_f32 v96, v240, v241
    v_cvt_pk_bf16_f32 v97, v242, v243
    v_cvt_pk_bf16_f32 v98, v244, v245
    v_cvt_pk_bf16_f32 v99, v246, v247
    buffer_store_dwordx2 v[96:97], v28, s[28:31], s79 offen
    buffer_store_dwordx2 v[98:99], v28, s[28:31], s78 offen
L_k1_end5:
    s_endpgm
L_cnt5:
    s_mov_b32 s92, 0
    s_lshl_b32 s93, s16, 5
L_cntl5:
    s_sleep 8
    buffer_load_dword v30, off, s[84:87], s93 sc1
    s_add_u32 s92, s92, 1
    s_waitcnt vmcnt(0)
    v_readfirstlane_b32 s22, v30
    s_cmp_ge_u32 s92, 400000
    s_cbranch_scc1 L_cntok5
    s_cmp_ge_u32 s22, 32
    s_cbranch_scc1 L_cntok5
    s_branch L_cntl5
L_ar5_0:
    s_mov_b64 exec, 1
    v_mov_b32 v3, 1
    s_lshl_b32 s6, s16, 5
    buffer_atomic_add v3, off, s[84:87], s6 sc1
    s_mov_b64 exec, -1
    s_branch L_ab5_0
L_ar5_1:
    s_mov_b64 exec, 1
    v_mov_b32 v3, 1
    s_lshl_b32 s6, s16, 5
    buffer_atomic_add v3, off, s[84:87], s6 sc1
    s_mov_b64 exec, -1
    s_branch L_ab5_1
L_ar5_2:
    s_mov_b64 exec, 1
    v_mov_b32 v3, 1
    s_lshl_b32 s6, s16, 5
    buffer_atomic_add v3, off, s[84:87], s6 sc1
    s_mov_b64 exec, -1
    s_branch L_ab5_2
L_ar5_3:
    s_mov_b64 exec, 1
    v_mov_b32 v3, 1
    s_lshl_b32 s6, s16, 5
    buffer_atomic_add v3, off, s[84:87], s6 sc1
    s_mov_b64 exec, -1
    s_branch L_ab5_3
L_ar5_4:
    s_mov_b64 exec, 1
    v_mov_b32 v3, 1
    s_lshl_b32 s6, s16, 5
    buffer_atomic_add v3, off, s[84:87], s6 sc1
    s_mov_b64 exec, -1
    s_branch L_ab5_4
L_ar5_5:
    s_mov_b64 exec, 1
    v_mov_b32 v3, 1
    s_lshl_b32 s6, s16, 5
    buffer_atomic_add v3, off, s[84:87], s6 sc1
    s_mov_b64 exec, -1
    s_branch L_ab5_5
L_ar5_6:
    s_mov_b64 exec, 1
    v_mov_b32 v3, 1
    s_lshl_b32 s6, s16, 5
    buffer_atomic_add v3, off, s[84:87], s6 sc1
    s_mov_b64 exec, -1
    s_branch L_ab5_6
L_ar5_7:
    s_mov_b64 exec, 1
    v_mov_b32 v3, 1
    s_lshl_b32 s6, s16, 5
    buffer_atomic_add v3, off, s[84:87], s6 sc1
    s_mov_b64 exec, -1
    s_branch L_ab5_7
L_rs5_1:
    s_nop 7
    v_mul_f32 v96, v80, v96
    v_mul_f32 v97, v80, v97
    v_mul_f32 v98, v80, v98
    v_mul_f32 v99, v80, v99
    v_mul_f32 v100, v81, v100
    v_mul_f32 v101, v81, v101
    v_mul_f32 v102, v81, v102
    v_mul_f32 v103, v81, v103
    v_mul_f32 v104, v82, v104
    v_mul_f32 v105, v82, v105
    v_mul_f32 v106, v82, v106
    v_mul_f32 v107, v82, v107
    v_mul_f32 v108, v83, v108
    v_mul_f32 v109, v83, v109
    v_mul_f32 v110, v83, v110
    v_mul_f32 v111, v83, v111
    v_mul_f32 v112, v84, v112
    v_mul_f32 v113, v84, v113
    v_mul_f32 v114, v84, v114
    v_mul_f32 v115, v84, v115
    v_mul_f32 v116, v80, v116
    v_mul_f32 v117, v80, v117
    v_mul_f32 v118, v80, v118
    v_mul_f32 v119, v80, v119
    v_mul_f32 v120, v81, v120
    v_mul_f32 v121, v81, v121
    v_mul_f32 v122, v81, v122
    v_mul_f32 v123, v81, v123
    v_mul_f32 v124, v82, v124
    v_mul_f32 v125, v82, v125
    v_mul_f32 v126, v82, v126
    v_mul_f32 v127, v82, v127
    v_mul_f32 v128, v83, v128
    v_mul_f32 v129, v83, v129
    v_mul_f32 v130, v83, v130
    v_mul_f32 v131, v83, v131
    v_mul_f32 v132, v84, v132
    v_mul_f32 v133, v84, v133
    v_mul_f32 v134, v84, v134
    v_mul_f32 v135, v84, v135
    v_mul_f32 v136, v80, v136
    v_mul_f32 v137, v80, v137
    v_mul_f32 v138, v80, v138
    v_mul_f32 v139, v80, v139
    v_mul_f32 v140, v81, v140
    v_mul_f32 v141, v81, v141
    v_mul_f32 v142, v81, v142
    v_mul_f32 v143, v81, v143
    v_mul_f32 v144, v82, v144
    v_mul_f32 v145, v82, v145
    v_mul_f32 v146, v82, v146
    v_mul_f32 v147, v82, v147
    v_mul_f32 v148, v83, v148
    v_mul_f32 v149, v83, v149
    v_mul_f32 v150, v83, v150
    v_mul_f32 v151, v83, v151
    v_mul_f32 v152, v84, v152
    v_mul_f32 v153, v84, v153
    v_mul_f32 v154, v84, v154
    v_mul_f32 v155, v84, v155
    v_mul_f32 v156, v80, v156
    v_mul_f32 v157, v80, v157
    v_mul_f32 v158, v80, v158
    v_mul_f32 v159, v80, v159
    v_mul_f32 v160, v81, v160
    v_mul_f32 v161, v81, v161
    v_mul_f32 v162, v81, v162
    v_mul_f32 v163, v81, v163
    v_mul_f32 v164, v82, v164
    v_mul_f32 v165, v82, v165
    v_mul_f32 v166, v82, v166
    v_mul_f32 v167, v82, v167
    v_mul_f32 v168, v83, v168
    v_mul_f32 v169, v83, v169
    v_mul_f32 v170, v83, v170
    v_mul_f32 v171, v83, v171
    v_mul_f32 v172, v84, v172
    v_mul_f32 v173, v84, v173
    v_mul_f32 v174, v84, v174
    v_mul_f32 v175, v84, v175
    s_nop 1
    s_branch L_rb5_1
L_rs5_2:
    s_nop 7
    v_mul_f32 v96, v85, v96
    v_mul_f32 v97, v85, v97
    v_mul_f32 v98, v85, v98
    v_mul_f32 v99, v85, v99
    v_mul_f32 v100, v86, v100
    v_mul_f32 v101, v86, v101
    v_mul_f32 v102, v86, v102
    v_mul_f32 v103, v86, v103
    v_mul_f32 v104, v87, v104
    v_mul_f32 v105, v87, v105
    v_mul_f32 v106, v87, v106
    v_mul_f32 v107, v87, v107
    v_mul_f32 v108, v88, v108
    v_mul_f32 v109, v88, v109
    v_mul_f32 v110, v88, v110
    v_mul_f32 v111, v88, v111
    v_mul_f32 v112, v89, v112
    v_mul_f32 v113, v89, v113
    v_mul_f32 v114, v89, v114
    v_mul_f32 v115, v89, v115
    v_mul_f32 v116, v85, v116
    v_mul_f32 v117, v85, v117
    v_mul_f32 v118, v85, v118
    v_mul_f32 v119, v85, v119
    v_mul_f32 v120, v86, v120
    v_mul_f32 v121, v86, v121
    v_mul_f32 v122, v86, v122
    v_mul_f32 v123, v86, v123
    v_mul_f32 v124, v87, v124
    v_mul_f32 v125, v87, v125
    v_mul_f32 v126, v87, v126
    v_mul_f32 v127, v87, v127
    v_mul_f32 v128, v88, v128
    v_mul_f32 v129, v88, v129
    v_mul_f32 v130, v88, v130
    v_mul_f32 v131, v88, v131
    v_mul_f32 v132, v89, v132
    v_mul_f32 v133, v89, v133
    v_mul_f32 v134, v89, v134
    v_mul_f32 v135, v89, v135
    v_mul_f32 v136, v85, v136
    v_mul_f32 v137, v85, v137
    v_mul_f32 v138, v85, v138
    v_mul_f32 v139, v85, v139
    v_mul_f32 v140, v86, v140
    v_mul_f32 v141, v86, v141
    v_mul_f32 v142, v86, v142
    v_mul_f32 v143, v86, v143
    v_mul_f32 v144, v87, v144
    v_mul_f32 v145, v87, v145
    v_mul_f32 v146, v87, v146
    v_mul_f32 v147, v87, v147
    v_mul_f32 v148, v88, v148
    v_mul_f32 v149, v88, v149
    v_mul_f32 v150, v88, v150
    v_mul_f32 v151, v88, v151
    v_mul_f32 v152, v89, v152
    v_mul_f32 v153, v89, v153
    v_mul_f32 v154, v89, v154
    v_mul_f32 v155, v89, v155
    v_mul_f32 v156, v85, v156
    v_mul_f32 v157, v85, v157
    v_mul_f32 v158, v85, v158
    v_mul_f32 v159, v85, v159
    v_mul_f32 v160, v86, v160
    v_mul_f32 v161, v86, v161
    v_mul_f32 v162, v86, v162
    v_mul_f32 v163, v86, v163
    v_mul_f32 v164, v87, v164
    v_mul_f32 v165, v87, v165
    v_mul_f32 v166, v87, v166
    v_mul_f32 v167, v87, v167
    v_mul_f32 v168, v88, v168
    v_mul_f32 v169, v88, v169
    v_mul_f32 v170, v88, v170
    v_mul_f32 v171, v88, v171
    v_mul_f32 v172, v89, v172
    v_mul_f32 v173, v89, v173
    v_mul_f32 v174, v89, v174
    v_mul_f32 v175, v89, v175
    s_nop 1
    s_branch L_rb5_2
L_rs5_3:
    s_nop 7
    v_mul_f32 v96, v90, v96
    v_mul_f32 v97, v90, v97
    v_mul_f32 v98, v90, v98
    v_mul_f32 v99, v90, v99
    v_mul_f32 v100, v91, v100
    v_mul_f32 v101, v91, v101
    v_mul_f32 v102, v91, v102
    v_mul_f32 v103, v91, v103
    v_mul_f32 v104, v92, v104
    v_mul_f32 v105, v92, v105
    v_mul_f32 v106, v92, v106
    v_mul_f32 v107, v92, v107
    v_mul_f32 v108, v93, v108
    v_mul_f32 v109, v93, v109
    v_mul_f32 v110, v93, v110
    v_mul_f32 v111, v93, v111
    v_mul_f32 v112, v94, v112
    v_mul_f32 v113, v94, v113
    v_mul_f32 v114, v94, v114
    v_mul_f32 v115, v94, v115
    v_mul_f32 v116, v90, v116
    v_mul_f32 v117, v90, v117
    v_mul_f32 v118, v90, v118
    v_mul_f32 v119, v90, v119
    v_mul_f32 v120, v91, v120
    v_mul_f32 v121, v91, v121
    v_mul_f32 v122, v91, v122
    v_mul_f32 v123, v91, v123
    v_mul_f32 v124, v92, v124
    v_mul_f32 v125, v92, v125
    v_mul_f32 v126, v92, v126
    v_mul_f32 v127, v92, v127
    v_mul_f32 v128, v93, v128
    v_mul_f32 v129, v93, v129
    v_mul_f32 v130, v93, v130
    v_mul_f32 v131, v93, v131
    v_mul_f32 v132, v94, v132
    v_mul_f32 v133, v94, v133
    v_mul_f32 v134, v94, v134
    v_mul_f32 v135, v94, v135
    v_mul_f32 v136, v90, v136
    v_mul_f32 v137, v90, v137
    v_mul_f32 v138, v90, v138
    v_mul_f32 v139, v90, v139
    v_mul_f32 v140, v91, v140
    v_mul_f32 v141, v91, v141
    v_mul_f32 v142, v91, v142
    v_mul_f32 v143, v91, v143
    v_mul_f32 v144, v92, v144
    v_mul_f32 v145, v92, v145
    v_mul_f32 v146, v92, v146
    v_mul_f32 v147, v92, v147
    v_mul_f32 v148, v93, v148
    v_mul_f32 v149, v93, v149
    v_mul_f32 v150, v93, v150
    v_mul_f32 v151, v93, v151
    v_mul_f32 v152, v94, v152
    v_mul_f32 v153, v94, v153
    v_mul_f32 v154, v94, v154
    v_mul_f32 v155, v94, v155
    v_mul_f32 v156, v90, v156
    v_mul_f32 v157, v90, v157
    v_mul_f32 v158, v90, v158
    v_mul_f32 v159, v90, v159
    v_mul_f32 v160, v91, v160
    v_mul_f32 v161, v91, v161
    v_mul_f32 v162, v91, v162
    v_mul_f32 v163, v91, v163
    v_mul_f32 v164, v92, v164
    v_mul_f32 v165, v92, v165
    v_mul_f32 v166, v92, v166
    v_mul_f32 v167, v92, v167
    v_mul_f32 v168, v93, v168
    v_mul_f32 v169, v93, v169
    v_mul_f32 v170, v93, v170
    v_mul_f32 v171, v93, v171
    v_mul_f32 v172, v94, v172
    v_mul_f32 v173, v94, v173
    v_mul_f32 v174, v94, v174
    v_mul_f32 v175, v94, v175
    s_nop 1
    s_branch L_rb5_3
L_mv5_1:
    s_nop 7
    v_mul_f32 v96, 0xbdb8aa3b, v96
    v_mul_f32 v97, 0xbdb8aa3b, v97
    v_mul_f32 v98, 0xbdb8aa3b, v98
    v_mul_f32 v99, 0xbdb8aa3b, v99
    v_mul_f32 v100, 0xbdb8aa3b, v100
    v_min_f32 v96, v96, v51
    v_min_f32 v97, v97, v52
    v_min_f32 v98, v98, v53
    v_min_f32 v99, v99, v54
    v_min_f32 v100, v100, v55
    v_sub_f32 v80, v96, v51
    v_sub_f32 v81, v97, v52
    v_sub_f32 v82, v98, v53
    v_sub_f32 v83, v99, v54
    v_sub_f32 v84, v100, v55
    v_exp_f32 v80, v80
    v_exp_f32 v81, v81
    v_exp_f32 v82, v82
    v_exp_f32 v83, v83
    v_exp_f32 v84, v84
    v_mov_b32 v51, v96
    v_mov_b32 v52, v97
    v_mov_b32 v53, v98
    v_mov_b32 v54, v99
    v_mov_b32 v55, v100
    v_mul_f32 v56, v80, v56
    v_mul_f32 v60, v81, v60
    v_mul_f32 v64, v82, v64
    v_mul_f32 v68, v83, v68
    v_mul_f32 v72, v84, v72
    s_bitset1_b32 s4, 1
    s_nop 1
    s_branch L_mb5_1
L_mv5_2:
    s_nop 7
    v_mul_f32 v4, 0xbdb8aa3b, v4
    v_mul_f32 v5, 0xbdb8aa3b, v5
    v_mul_f32 v6, 0xbdb8aa3b, v6
    v_mul_f32 v7, 0xbdb8aa3b, v7
    v_mul_f32 v8, 0xbdb8aa3b, v8
    v_min_f32 v4, v4, v51
    v_min_f32 v5, v5, v52
    v_min_f32 v6, v6, v53
    v_min_f32 v7, v7, v54
    v_min_f32 v8, v8, v55
    v_sub_f32 v85, v4, v51
    v_sub_f32 v86, v5, v52
    v_sub_f32 v87, v6, v53
    v_sub_f32 v88, v7, v54
    v_sub_f32 v89, v8, v55
    v_exp_f32 v85, v85
    v_exp_f32 v86, v86
    v_exp_f32 v87, v87
    v_exp_f32 v88, v88
    v_exp_f32 v89, v89
    v_mov_b32 v51, v4
    v_mov_b32 v52, v5
    v_mov_b32 v53, v6
    v_mov_b32 v54, v7
    v_mov_b32 v55, v8
    v_mul_f32 v56, v85, v56
    v_mul_f32 v60, v86, v60
    v_mul_f32 v64, v87, v64
    v_mul_f32 v68, v88, v68
    v_mul_f32 v72, v89, v72
    s_bitset1_b32 s4, 2
    s_nop 1
    s_branch L_mb5_2
L_mv5_3:
    s_nop 7
    v_mul_f32 v4, 0xbdb8aa3b, v4
    v_mul_f32 v5, 0xbdb8aa3b, v5
    v_mul_f32 v6, 0xbdb8aa3b, v6
    v_mul_f32 v7, 0xbdb8aa3b, v7
    v_mul_f32 v8, 0xbdb8aa3b, v8
    v_min_f32 v4, v4, v51
    v_min_f32 v5, v5, v52
    v_min_f32 v6, v6, v53
    v_min_f32 v7, v7, v54
    v_min_f32 v8, v8, v55
    v_sub_f32 v90, v4, v51
    v_sub_f32 v91, v5, v52
    v_sub_f32 v92, v6, v53
    v_sub_f32 v93, v7, v54
    v_sub_f32 v94, v8, v55
    v_exp_f32 v90, v90
    v_exp_f32 v91, v91
    v_exp_f32 v92, v92
    v_exp_f32 v93, v93
    v_exp_f32 v94, v94
    v_mov_b32 v51, v4
    v_mov_b32 v52, v5
    v_mov_b32 v53, v6
    v_mov_b32 v54, v7
    v_mov_b32 v55, v8
    v_mul_f32 v56, v90, v56
    v_mul_f32 v60, v91, v60
    v_mul_f32 v64, v92, v64
    v_mul_f32 v68, v93, v68
    v_mul_f32 v72, v94, v72
    s_bitset1_b32 s4, 3
    s_nop 1
    s_branch L_mb5_3
L_pend5:
.p2align 7
L_k1_nt4:
L_path4:
    s_mul_i32 s20, s19, 7
    s_lshr_b32 s21, s20, 3
    s_mul_i32 s22, s22, 7
    s_add_u32 s21, s21, s22
    s_cmp_ge_u32 s21, 14
    s_cselect_b32 s22, 14, 0
    s_sub_u32 s21, s21, s22
    s_and_b32 s55, s21, 1
    s_lshr_b32 s21, s21, 1
    s_lshr_b32 s23, s20, 4
    s_lshl_b32 s48, s21, 7
    s_add_u32 s49, s48, 128
    s_cmp_eq_u32 s49, 896
    s_cselect_b32 s49, 0, s49
    s_add_u32 s50, s49, 128
    s_cmp_eq_u32 s50, 896
    s_cselect_b32 s50, 0, s50
    s_add_u32 s51, s50, 128
    s_cmp_eq_u32 s51, 896
    s_cselect_b32 s51, 0, s51
    s_add_u32 s52, s51, 128
    s_cmp_eq_u32 s52, 896
    s_cselect_b32 s52, 0, s52
    s_add_u32 s53, s52, 128
    s_cmp_eq_u32 s53, 896
    s_cselect_b32 s53, 0, s53
    s_add_u32 s54, s53, 128
    s_cmp_eq_u32 s54, 896
    s_cselect_b32 s54, 0, s54
    v_lshrrev_b32 v46, 3, v0
    v_and_b32 v47, 7, v0
    v_and_b32 v48, 6, v46
    v_xor_b32 v47, v47, v48
    v_lshlrev_b32 v47, 4, v47
    v_mul_u32_u24 v48, 896, v46
    v_add_u32 v48, v48, v47
    s_mul_i32 s20, s3, 7168
    v_add_u32 v2, s20, v48
    v_add_u32 v3, 28672, v2
    s_lshl_b32 s99, s3, 10
    s_add_u32 s99, s99, 8192
    s_mul_i32 s98, s3, 20480
    s_add_u32 s98, s98, 65536
    v_and_b32 v49, 3, v46
    v_lshrrev_b32 v50, 2, v46
    v_lshl_add_u32 v49, v50, 3, v49
    v_lshl_add_u32 v49, v49, 13, v47
    s_lshl_b32 s20, s3, 7
    v_add_u32 v5, s20, v49
    v_add_u32 v6, 130048, v5
    v_add_u32 v7, 30720, v5
    v_add_u32 v8, 160768, v5
    s_lshl_b32 s22, s55, 18
    s_lshl_b32 s56, s48, 12
    s_add_u32 s56, s56, s22
    s_mul_i32 s20, s16, 129024
    s_add_u32 s20, s20, 71680
    s_lshl_b32 s21, s17, 9
    s_mov_b32 s26, 57344
    s_mov_b32 s27, 0x20000
    s_sub_u32 s38, 3670016, s21
    s_mov_b32 s39, 0x20000
    s_waitcnt lgkmcnt(0)
    s_add_u32 s24, s4, s20
    s_addc_u32 s25, s5, 0
    s_add_u32 s36, s10, s21
    s_addc_u32 s37, s11, 0
    s_xor_b32 s57, s56, 262144
    s_add_u32 m0, s99, 0
    s_nop 0
    buffer_load_dwordx4 v2, s[24:27], s48 offen lds
    s_add_u32 m0, s99, 4096
    s_nop 0
    buffer_load_dwordx4 v3, s[24:27], s48 offen lds
    s_add_u32 m0, s99, 8192
    s_nop 0
    buffer_load_dwordx4 v2, s[24:27], s49 offen lds
    s_add_u32 m0, s99, 12288
    s_nop 0
    buffer_load_dwordx4 v3, s[24:27], s49 offen lds
    s_add_u32 m0, s99, 16384
    s_nop 0
    buffer_load_dwordx4 v2, s[24:27], s50 offen lds
    s_add_u32 m0, s99, 20480
    s_nop 0
    buffer_load_dwordx4 v3, s[24:27], s50 offen lds
    s_add_u32 m0, s99, 24576
    s_nop 0
    buffer_load_dwordx4 v2, s[24:27], s51 offen lds
    s_add_u32 m0, s99, 28672
    s_nop 0
    buffer_load_dwordx4 v3, s[24:27], s51 offen lds
    s_add_u32 m0, s98, 0
    s_nop 0
    buffer_load_dwordx4 v5, s[36:39], s56 offen  lds
    s_lshl_b32 s58, s49, 12
    s_add_u32 s58, s58, s22
    s_xor_b32 s59, s58, 262144
    s_lshl_b32 s60, s50, 12
    s_add_u32 s60, s60, s22
    s_xor_b32 s61, s60, 262144
    s_lshl_b32 s62, s51, 12
    s_add_u32 s62, s62, s22
    s_xor_b32 s63, s62, 262144
    s_lshl_b32 s64, s52, 12
    s_add_u32 s64, s64, s22
    s_xor_b32 s65, s64, 262144
    s_lshl_b32 s66, s53, 12
    s_add_u32 s66, s66, s22
    s_xor_b32 s67, s66, 262144
    s_lshl_b32 s68, s54, 12
    s_add_u32 s68, s68, s22
    s_xor_b32 s69, s68, 262144
    s_lshl_b32 s20, s16, 4
    s_add_u32 s21, s20, s17
    s_lshl_b32 s20, s21, 18
    s_add_u32 s28, s6, s20
    s_addc_u32 s29, s7, 0
    s_sub_u32 s28, s28, 2048
    s_subb_u32 s29, s29, 0
    s_mov_b32 s30, 264192
    s_mov_b32 s31, 0x20000
    s_add_u32 s32, s8, s20
    s_addc_u32 s33, s9, 0
    s_mov_b32 s34, 262144
    s_mov_b32 s35, 0x20000
    s_mul_i32 s20, s17, 229376
    s_add_u32 s40, s12, s20
    s_addc_u32 s41, s13, 0
    s_mov_b32 s42, 229376
    s_mov_b32 s43, 0x20000
    s_mul_i32 s20, s21, 133120
    s_add_u32 s44, s14, s20
    s_addc_u32 s45, s15, 0
    s_mov_b32 s46, 133120
    s_mov_b32 s47, 0x20000
    s_mov_b32 s96, 0x3db8aa3b
    s_and_b32 s90, s16, 3
    s_lshl_b32 s90, s90, 16
    s_and_b32 s18, s17, 1
    s_lshl_b32 s18, s18, 8
    s_or_b32 s18, s18, s90
    v_lshl_add_u32 v49, v46, 9, v47
    s_lshl_b32 s20, s3, 14
    s_add_u32 s20, s20, 2048
    v_add_u32 v9, s20, v49
    v_add_u32 v10, 3072, v9
    v_subrev_u32 v11, 1920, v9
    v_add_u32 v12, 1152, v9
    s_lshl_b32 s20, s3, 7
    v_add_u32 v13, s20, v49
    v_add_u32 v14, 3072, v13
    v_add_u32 v15, 6144, v13
    v_add_u32 v16, 9216, v13
    s_mul_i32 s20, s3, 57344
    v_add_u32 v17, s20, v48
    v_add_u32 v18, 6144, v17
    v_add_u32 v19, 12288, v17
    v_add_u32 v20, 18432, v17
    s_lshl_b32 s70, s23, 7
    s_add_u32 s71, s70, 128
    s_cmp_eq_u32 s71, 896
    s_cselect_b32 s71, 0, s71
    s_add_u32 s72, s71, 128
    s_cmp_eq_u32 s72, 896
    s_cselect_b32 s72, 0, s72
    s_add_u32 s73, s72, 128
    s_cmp_eq_u32 s73, 896
    s_cselect_b32 s73, 0, s73
    s_add_u32 s74, s73, 128
    s_cmp_eq_u32 s74, 896
    s_cselect_b32 s74, 0, s74
    s_add_u32 s75, s74, 128
    s_cmp_eq_u32 s75, 896
    s_cselect_b32 s75, 0, s75
    s_add_u32 s76, s75, 128
    s_cmp_eq_u32 s76, 896
    s_cselect_b32 s76, 0, s76
    s_mul_i32 s20, s16, 16384
    s_add_u32 s20, s20, 25165824
    s_add_u32 s80, s14, s20
    s_addc_u32 s81, s15, 0
    s_mov_b32 s82, 16384
    s_mov_b32 s83, 0x20000
    s_mov_b32 s86, 256
    s_mov_b32 s87, 0x20000
    s_mul_i32 s8, s16, 2
    s_add_u32 s8, s8, s17
    s_and_b32 s8, s8, 15
    s_lshl_b32 s20, s8, 2
    s_add_u32 s20, s20, s3
    s_add_u32 s20, s20, 64
    s_mul_i32 s20, s20, 128
    v_lshlrev_b32 v1, 24, v0
    v_add_u32 v1, s20, v1
    v_mov_b32 v58, 0
    buffer_store_dword v58, v1, s[80:83], 0 offen sc1
    v_lshrrev_b32 v46, 2, v0
    v_bfe_u32 v47, v0, 3, 2
    v_and_b32 v48, 3, v0
    v_lshlrev_b32 v48, 3, v48
    v_lshl_add_u32 v48, v46, 7, v48
    v_lshl_add_u32 v49, v47, 5, v48
    v_add_u32 v21, s98, v49
    v_xor_b32 v22, 32, v21
    v_xor_b32 v23, 64, v21
    v_xor_b32 v24, 96, v21
    s_lshl_b32 s20, s3, 5
    v_xor_b32 v49, s20, v49
    v_add_u32 v25, 65536, v49
    v_add_u32 v26, 106496, v49
    v_add_u32 v27, 32768, v49
    v_and_b32 v46, 15, v0
    v_lshrrev_b32 v47, 4, v0
    v_and_b32 v48, 6, v0
    v_xor_b32 v48, v48, v47
    v_lshlrev_b32 v48, 4, v48
    v_lshl_add_u32 v48, v46, 7, v48
    v_add_u32 v30, s98, v48
    v_xor_b32 v31, 64, v30
    s_lshl_b32 s20, s55, 6
    v_xor_b32 v48, s20, v48
    v_add_u32 v28, 8192, v48
    v_xor_b32 v29, 64, v28
    v_lshlrev_b32 v32, 4, v0
    v_add_u32 v33, 40960, v32
    s_mul_i32 s20, s3, 8192
    v_add_u32 v36, s20, v32
    s_mul_i32 s22, s3, 4096
    v_add_u32 v35, s22, v32
    v_add_u32 v45, 40960, v35
    v_lshrrev_b32 v48, 1, v47
    v_lshlrev_b32 v48, 8, v48
    v_lshl_add_u32 v48, v46, 4, v48
    v_and_b32 v49, 1, v47
    v_lshl_add_u32 v48, v49, 3, v48
    v_add_u32 v34, s20, v48
    v_lshlrev_b32 v48, 4, v46
    v_add_u32 v38, 147456, v48
    s_lshl_b32 s20, s3, 2
    v_add_u32 v37, s20, v38
    v_lshl_add_u32 v44, v47, 2, v38
    v_lshlrev_b32 v48, 3, v0
    s_lshl_b32 s20, s3, 9
    s_add_u32 s20, s20, 147456
    v_add_u32 v49, s20, v48
    v_mov_b32 v56, 0xff800000
    v_mov_b32 v57, 0xff800000
    ds_write_b64 v49, v[56:57]
    s_lshl_b32 s20, s3, 10
    v_add_u32 v39, s20, v32
    v_add_u32 v40, 4096, v39
    buffer_load_dwordx4 v6, s[36:39], s56 offen offset:1024  lds
    buffer_load_dwordx4 v7, s[36:39], s56 offen offset:2048  lds
    buffer_load_dwordx4 v8, s[36:39], s56 offen offset:3072  lds
    s_add_u32 m0, s98, 4096
    s_nop 0
    buffer_load_dwordx4 v5, s[36:39], s57 offen  lds
    buffer_load_dwordx4 v6, s[36:39], s57 offen offset:1024  lds
    buffer_load_dwordx4 v7, s[36:39], s57 offen offset:2048  lds
    buffer_load_dwordx4 v8, s[36:39], s57 offen offset:3072  lds
    s_add_u32 m0, s98, 8192
    s_nop 0
    buffer_load_dwordx4 v5, s[36:39], s58 offen  lds
    buffer_load_dwordx4 v6, s[36:39], s58 offen offset:1024  lds
    buffer_load_dwordx4 v7, s[36:39], s58 offen offset:2048  lds
    buffer_load_dwordx4 v8, s[36:39], s58 offen offset:3072  lds
    s_add_u32 m0, s98, 12288
    s_nop 0
    buffer_load_dwordx4 v5, s[36:39], s59 offen  lds
    buffer_load_dwordx4 v6, s[36:39], s59 offen offset:1024  lds
    buffer_load_dwordx4 v7, s[36:39], s59 offen offset:2048  lds
    buffer_load_dwordx4 v8, s[36:39], s59 offen offset:3072  lds
    s_waitcnt vmcnt(21)
    s_waitcnt vmcnt(17)
    s_waitcnt lgkmcnt(0)
    s_barrier
    ds_read_b128 v[56:59], v28 offset:0
    ds_read_b128 v[60:63], v28 offset:2048
    ds_read_b128 v[64:67], v28 offset:4096
    ds_read_b128 v[68:71], v28 offset:6144
    s_waitcnt vmcnt(12)
    ds_read_b64_tr_b16 a[0:1], v21 offset:0
    ds_read_b64_tr_b16 a[2:3], v21 offset:2048
    ds_read_b64_tr_b16 a[4:5], v22 offset:0
    ds_read_b64_tr_b16 a[6:7], v22 offset:2048
    ds_read_b64_tr_b16 a[8:9], v23 offset:0
    ds_read_b64_tr_b16 a[10:11], v23 offset:2048
    ds_read_b64_tr_b16 a[12:13], v24 offset:0
    ds_read_b64_tr_b16 a[14:15], v24 offset:2048
    s_waitcnt lgkmcnt(6)
    v_mfma_f32_16x16x32_bf16 v[96:99], a[0:3], v[56:59], 0
    ds_read_b128 v[76:79], v29 offset:0
    s_add_u32 m0, s99, 32768
    v_mfma_f32_16x16x32_bf16 v[100:103], a[0:3], v[60:63], 0
    s_waitcnt vmcnt(8)
    ds_read_b64_tr_b16 a[16:17], v21 offset:4096
    buffer_load_dwordx4 v2, s[24:27], s52 offen lds
    v_mfma_f32_16x16x32_bf16 v[104:107], a[0:3], v[64:67], 0
    ds_read_b128 v[80:83], v29 offset:2048
    ds_read_b64_tr_b16 a[18:19], v21 offset:6144
    s_add_u32 m0, s99, 36864
    v_mfma_f32_16x16x32_bf16 v[108:111], a[0:3], v[68:71], 0
    ds_read_b64_tr_b16 a[20:21], v22 offset:4096
    ds_read_b64_tr_b16 a[22:23], v22 offset:6144
    buffer_load_dwordx4 v3, s[24:27], s52 offen lds
    s_add_u32 m0, s99, 40960
    s_waitcnt lgkmcnt(10)
    v_mfma_f32_16x16x32_bf16 v[112:115], a[4:7], v[56:59], 0
    ds_read_b128 v[84:87], v29 offset:4096
    ds_read_b64_tr_b16 a[24:25], v23 offset:4096
    buffer_load_dwordx4 v2, s[24:27], s53 offen lds
    s_add_u32 m0, s99, 45056
    v_mfma_f32_16x16x32_bf16 v[116:119], a[4:7], v[60:63], 0
    ds_read_b64_tr_b16 a[26:27], v23 offset:6144
    ds_read_b64_tr_b16 a[28:29], v24 offset:4096
    buffer_load_dwordx4 v3, s[24:27], s53 offen lds
    s_add_u32 m0, s99, 49152
    v_mfma_f32_16x16x32_bf16 v[120:123], a[4:7], v[64:67], 0
    ds_read_b128 v[88:91], v29 offset:6144
    ds_read_b64_tr_b16 a[30:31], v24 offset:6144
    buffer_load_dwordx4 v2, s[24:27], s54 offen lds
    s_add_u32 m0, s99, 53248
    v_mfma_f32_16x16x32_bf16 v[124:127], a[4:7], v[68:71], 0
    s_waitcnt vmcnt(9)
    ds_read_b64_tr_b16 a[32:33], v21 offset:8192
    buffer_load_dwordx4 v3, s[24:27], s54 offen lds
    s_waitcnt lgkmcnt(11)
    v_mfma_f32_16x16x32_bf16 v[128:131], a[8:11], v[56:59], 0
    ds_read_b64_tr_b16 a[34:35], v21 offset:10240
    ds_read_b64_tr_b16 a[36:37], v22 offset:8192
    s_add_u32 m0, s98, 16384
    s_xor_b32 s91, s18, 0
    v_mfma_f32_16x16x32_bf16 v[132:135], a[8:11], v[60:63], 0
    ds_read_b64_tr_b16 a[38:39], v22 offset:10240
    ds_read_b64_tr_b16 a[40:41], v23 offset:8192
    buffer_load_dwordx4 v9, s[28:31], s91 offen  lds
    buffer_load_dwordx4 v10, s[28:31], s91 offen offset:1024  lds
    v_mfma_f32_16x16x32_bf16 v[136:139], a[8:11], v[64:67], 0
    ds_read_b64_tr_b16 a[42:43], v23 offset:10240
    ds_read_b64_tr_b16 a[44:45], v24 offset:8192
    buffer_load_dwordx4 v11, s[28:31], s91 offen offset:2048  lds
    v_mfma_f32_16x16x32_bf16 v[140:143], a[8:11], v[68:71], 0
    ds_read_b64_tr_b16 a[46:47], v24 offset:10240
    buffer_load_dwordx4 v12, s[28:31], s91 offen offset:3072  lds
    v_mfma_f32_16x16x32_bf16 v[144:147], a[12:15], v[56:59], 0
    s_waitcnt vmcnt(10)
    ds_read_b64_tr_b16 a[48:49], v21 offset:12288
    s_add_u32 m0, s98, 0
    s_xor_b32 s91, s18, 256
    v_mfma_f32_16x16x32_bf16 v[148:151], a[12:15], v[60:63], 0
    ds_read_b64_tr_b16 a[50:51], v21 offset:14336
    ds_read_b64_tr_b16 a[52:53], v22 offset:12288
    buffer_load_dwordx4 v9, s[28:31], s91 offen  lds
    buffer_load_dwordx4 v10, s[28:31], s91 offen offset:1024  lds
    v_mfma_f32_16x16x32_bf16 v[152:155], a[12:15], v[64:67], 0
    ds_read_b64_tr_b16 a[54:55], v22 offset:14336
    ds_read_b64_tr_b16 a[56:57], v23 offset:12288
    buffer_load_dwordx4 v11, s[28:31], s91 offen offset:2048  lds
    v_mfma_f32_16x16x32_bf16 v[156:159], a[12:15], v[68:71], 0
    ds_read_b64_tr_b16 a[58:59], v23 offset:14336
    ds_read_b64_tr_b16 a[60:61], v24 offset:12288
    buffer_load_dwordx4 v12, s[28:31], s91 offen offset:3072  lds
    s_waitcnt lgkmcnt(12)
    v_mfma_f32_16x16x32_bf16 v[96:99], a[16:19], v[76:79], v[96:99]
    ds_read_b128 v[56:59], v28 offset:8192
    ds_read_b64_tr_b16 a[62:63], v24 offset:14336
    s_add_u32 m0, s98, 4096
    s_xor_b32 s91, s18, 8192
    buffer_load_dwordx4 v9, s[28:31], s91 offen  lds
    buffer_load_dwordx4 v10, s[28:31], s91 offen offset:1024  lds
    buffer_load_dwordx4 v11, s[28:31], s91 offen offset:2048  lds
    v_mfma_f32_16x16x32_bf16 v[100:103], a[16:19], v[80:83], v[100:103]
    s_waitcnt vmcnt(7)
    ds_read_b128 a[240:243], v30 offset:16384
    buffer_load_dwordx4 v12, s[28:31], s91 offen offset:3072  lds
    v_mfma_f32_16x16x32_bf16 v[104:107], a[16:19], v[84:87], v[104:107]
    ds_read_b128 v[60:63], v28 offset:10240
    ds_read_b128 a[244:247], v31 offset:16384
    s_add_u32 m0, s98, 8192
    s_xor_b32 s91, s18, 8448
    s_waitcnt lgkmcnt(11)
    buffer_load_dwordx4 v9, s[28:31], s91 offen  lds
    buffer_load_dwordx4 v10, s[28:31], s91 offen offset:1024  lds
    buffer_load_dwordx4 v11, s[28:31], s91 offen offset:2048  lds
    v_mfma_f32_16x16x32_bf16 v[108:111], a[16:19], v[88:91], v[108:111]
    ds_read_b128 a[248:251], v30 offset:18432
    ds_read_b128 a[252:255], v31 offset:18432
    buffer_load_dwordx4 v12, s[28:31], s91 offen offset:3072  lds
    v_mfma_f32_16x16x32_bf16 v[112:115], a[20:23], v[76:79], v[112:115]
    ds_read_b128 v[64:67], v28 offset:12288
    s_add_u32 m0, s98, 12288
    s_xor_b32 s91, s18, 65536
    s_waitcnt lgkmcnt(6)
    buffer_load_dwordx4 v9, s[28:31], s91 offen  lds
    buffer_load_dwordx4 v10, s[28:31], s91 offen offset:1024  lds
    buffer_load_dwordx4 v11, s[28:31], s91 offen offset:2048  lds
    v_mfma_f32_16x16x32_bf16 v[116:119], a[20:23], v[80:83], v[116:119]
    s_waitcnt vmcnt(11)
    ds_read_b128 a[224:227], v30 offset:0
    buffer_load_dwordx4 v12, s[28:31], s91 offen offset:3072  lds
    v_mfma_f32_16x16x32_bf16 v[120:123], a[20:23], v[84:87], v[120:123]
    ds_read_b128 v[68:71], v28 offset:14336
    ds_read_b128 a[228:231], v31 offset:0
    s_add_u32 m0, s98, 16384
    s_xor_b32 s91, s18, 65792
    v_mfma_f32_16x16x32_bf16 v[124:127], a[20:23], v[88:91], v[124:127]
    ds_read_b128 a[232:235], v30 offset:2048
    ds_read_b128 a[236:239], v31 offset:2048
    s_waitcnt lgkmcnt(6)
    buffer_load_dwordx4 v9, s[28:31], s91 offen  lds
    buffer_load_dwordx4 v10, s[28:31], s91 offen offset:1024  lds
    v_mfma_f32_16x16x32_bf16 v[128:131], a[24:27], v[76:79], v[128:131]
    buffer_load_dwordx4 v11, s[28:31], s91 offen offset:2048  lds
    buffer_load_dwordx4 v12, s[28:31], s91 offen offset:3072  lds
    v_mfma_f32_16x16x32_bf16 v[132:135], a[24:27], v[80:83], v[132:135]
    s_waitcnt vmcnt(12)
    ds_read_b128 a[208:211], v30 offset:4096
    v_mfma_f32_16x16x32_bf16 v[136:139], a[24:27], v[84:87], v[136:139]
    ds_read_b128 a[212:215], v31 offset:4096
    s_add_u32 m0, s98, 0
    s_xor_b32 s91, s18, 73728
    v_mfma_f32_16x16x32_bf16 v[140:143], a[24:27], v[88:91], v[140:143]
    ds_read_b128 a[216:219], v30 offset:6144
    s_waitcnt lgkmcnt(3)
    buffer_load_dwordx4 v9, s[28:31], s91 offen  lds
    v_mfma_f32_16x16x32_bf16 v[144:147], a[28:31], v[76:79], v[144:147]
    ds_read_b128 a[220:223], v31 offset:6144
    buffer_load_dwordx4 v10, s[28:31], s91 offen offset:1024  lds
    v_mfma_f32_16x16x32_bf16 v[148:151], a[28:31], v[80:83], v[148:151]
    buffer_load_dwordx4 v11, s[28:31], s91 offen offset:2048  lds
    buffer_load_dwordx4 v12, s[28:31], s91 offen offset:3072  lds
    v_mfma_f32_16x16x32_bf16 v[152:155], a[28:31], v[84:87], v[152:155]
    s_waitcnt vmcnt(12)
    ds_read_b128 a[192:195], v30 offset:8192
    v_mfma_f32_16x16x32_bf16 v[156:159], a[28:31], v[88:91], v[156:159]
    ds_read_b128 a[196:199], v31 offset:8192
    s_add_u32 m0, s98, 4096
    s_waitcnt lgkmcnt(2)
    buffer_load_dwordx4 v5, s[36:39], s60 offen  lds
    v_mfma_f32_16x16x32_bf16 v[96:99], a[32:35], v[56:59], v[96:99]
    ds_read_b128 v[76:79], v29 offset:8192
    ds_read_b128 a[200:203], v30 offset:10240
    v_mfma_f32_16x16x32_bf16 v[100:103], a[32:35], v[60:63], v[100:103]
    ds_read_b128 a[204:207], v31 offset:10240
    buffer_load_dwordx4 v6, s[36:39], s60 offen offset:1024  lds
    v_mfma_f32_16x16x32_bf16 v[104:107], a[32:35], v[64:67], v[104:107]
    ds_read_b128 v[80:83], v29 offset:10240
    buffer_load_dwordx4 v7, s[36:39], s60 offen offset:2048  lds
    v_mfma_f32_16x16x32_bf16 v[108:111], a[32:35], v[68:71], v[108:111]
    s_waitcnt vmcnt(11)
    ds_read_b128 a[176:179], v30 offset:12288
    buffer_load_dwordx4 v8, s[36:39], s60 offen offset:3072  lds
    v_mfma_f32_16x16x32_bf16 v[112:115], a[36:39], v[56:59], v[112:115]
    ds_read_b128 v[84:87], v29 offset:12288
    ds_read_b128 a[180:183], v31 offset:12288
    s_add_u32 m0, s98, 8192
    v_mfma_f32_16x16x32_bf16 v[116:119], a[36:39], v[60:63], v[116:119]
    ds_read_b128 a[184:187], v30 offset:14336
    s_waitcnt lgkmcnt(5)
    buffer_load_dwordx4 v5, s[36:39], s61 offen  lds
    v_mfma_f32_16x16x32_bf16 v[120:123], a[36:39], v[64:67], v[120:123]
    ds_read_b128 v[88:91], v29 offset:14336
    ds_read_b128 a[188:191], v31 offset:14336
    buffer_load_dwordx4 v6, s[36:39], s61 offen offset:1024  lds
    v_mfma_f32_16x16x32_bf16 v[124:127], a[36:39], v[68:71], v[124:127]
    s_waitcnt vmcnt(10)
    ds_read_b128 a[160:163], v30 offset:16384
    buffer_load_dwordx4 v7, s[36:39], s61 offen offset:2048  lds
    v_mfma_f32_16x16x32_bf16 v[128:131], a[40:43], v[56:59], v[128:131]
    ds_read_b128 a[164:167], v31 offset:16384
    buffer_load_dwordx4 v8, s[36:39], s61 offen offset:3072  lds
    v_mfma_f32_16x16x32_bf16 v[132:135], a[40:43], v[60:63], v[132:135]
    ds_read_b128 a[168:171], v30 offset:18432
    s_add_u32 m0, s98, 12288
    v_mfma_f32_16x16x32_bf16 v[136:139], a[40:43], v[64:67], v[136:139]
    ds_read_b128 a[172:175], v31 offset:18432
    s_waitcnt lgkmcnt(4)
    buffer_load_dwordx4 v5, s[36:39], s62 offen  lds
    buffer_load_dwordx4 v6, s[36:39], s62 offen offset:1024  lds
    v_mfma_f32_16x16x32_bf16 v[140:143], a[40:43], v[68:71], v[140:143]
    buffer_load_dwordx4 v7, s[36:39], s62 offen offset:2048  lds
    buffer_load_dwordx4 v8, s[36:39], s62 offen offset:3072  lds
    v_mfma_f32_16x16x32_bf16 v[144:147], a[44:47], v[56:59], v[144:147]
    s_waitcnt vmcnt(12)
    ds_read_b128 a[144:147], v30 offset:0
    v_mfma_f32_16x16x32_bf16 v[148:151], a[44:47], v[60:63], v[148:151]
    ds_read_b128 a[148:151], v31 offset:0
    s_add_u32 m0, s98, 16384
    v_mfma_f32_16x16x32_bf16 v[152:155], a[44:47], v[64:67], v[152:155]
    ds_read_b128 a[152:155], v30 offset:2048
    s_waitcnt lgkmcnt(3)
    buffer_load_dwordx4 v5, s[36:39], s63 offen  lds
    v_mfma_f32_16x16x32_bf16 v[156:159], a[44:47], v[68:71], v[156:159]
    ds_read_b128 a[156:159], v31 offset:2048
    buffer_load_dwordx4 v6, s[36:39], s63 offen offset:1024  lds
    v_mfma_f32_16x16x32_bf16 v[96:99], a[48:51], v[76:79], v[96:99]
    ds_read_b128 v[56:59], v28 offset:16384
    buffer_load_dwordx4 v7, s[36:39], s63 offen offset:2048  lds
    v_mfma_f32_16x16x32_bf16 v[100:103], a[48:51], v[80:83], v[100:103]
    s_waitcnt vmcnt(11)
    ds_read_b64_tr_b16 a[0:1], v21 offset:4096
    buffer_load_dwordx4 v8, s[36:39], s63 offen offset:3072  lds
    v_mfma_f32_16x16x32_bf16 v[104:107], a[48:51], v[84:87], v[104:107]
    ds_read_b128 v[60:63], v28 offset:18432
    ds_read_b64_tr_b16 a[2:3], v21 offset:6144
    v_mfma_f32_16x16x32_bf16 v[108:111], a[48:51], v[88:91], v[108:111]
    ds_read_b64_tr_b16 a[4:5], v22 offset:4096
    s_add_u32 m0, s98, 0
    v_mfma_f32_16x16x32_bf16 v[112:115], a[52:55], v[76:79], v[112:115]
    ds_read_b128 v[64:67], v28 offset:20480
    ds_read_b64_tr_b16 a[6:7], v22 offset:6144
    v_mfma_f32_16x16x32_bf16 v[116:119], a[52:55], v[80:83], v[116:119]
    ds_read_b64_tr_b16 a[8:9], v23 offset:4096
    s_waitcnt lgkmcnt(8)
    buffer_load_dwordx4 v5, s[36:39], s64 offen  lds
    v_mfma_f32_16x16x32_bf16 v[120:123], a[52:55], v[84:87], v[120:123]
    ds_read_b128 v[68:71], v28 offset:22528
    ds_read_b64_tr_b16 a[10:11], v23 offset:6144
    buffer_load_dwordx4 v6, s[36:39], s64 offen offset:1024  lds
    v_mfma_f32_16x16x32_bf16 v[124:127], a[52:55], v[88:91], v[124:127]
    ds_read_b64_tr_b16 a[12:13], v24 offset:4096
    buffer_load_dwordx4 v7, s[36:39], s64 offen offset:2048  lds
    v_mfma_f32_16x16x32_bf16 v[128:131], a[56:59], v[76:79], v[128:131]
    ds_read_b64_tr_b16 a[14:15], v24 offset:6144
    buffer_load_dwordx4 v8, s[36:39], s64 offen offset:3072  lds
    v_mfma_f32_16x16x32_bf16 v[132:135], a[56:59], v[80:83], v[132:135]
    s_add_u32 m0, s98, 4096
    v_mfma_f32_16x16x32_bf16 v[136:139], a[56:59], v[84:87], v[136:139]
    v_mfma_f32_16x16x32_bf16 v[140:143], a[56:59], v[88:91], v[140:143]
    v_mfma_f32_16x16x32_bf16 v[144:147], a[60:63], v[76:79], v[144:147]
    s_waitcnt lgkmcnt(0)
    buffer_load_dwordx4 v5, s[36:39], s65 offen  lds
    v_mfma_f32_16x16x32_bf16 v[148:151], a[60:63], v[80:83], v[148:151]
    v_mfma_f32_16x16x32_bf16 v[152:155], a[60:63], v[84:87], v[152:155]
    v_mfma_f32_16x16x32_bf16 v[156:159], a[60:63], v[88:91], v[156:159]
    buffer_load_dwordx4 v6, s[36:39], s65 offen offset:1024  lds
    v_mfma_f32_16x16x32_bf16 v[96:99], a[0:3], v[56:59], v[96:99]
    ds_read_b128 v[76:79], v29 offset:16384
    v_mfma_f32_16x16x32_bf16 v[100:103], a[0:3], v[60:63], v[100:103]
    v_mfma_f32_16x16x32_bf16 v[104:107], a[0:3], v[64:67], v[104:107]
    ds_read_b128 v[80:83], v29 offset:18432
    v_mfma_f32_16x16x32_bf16 v[108:111], a[0:3], v[68:71], v[108:111]
    s_waitcnt vmcnt(14)
    ds_read_b64_tr_b16 a[16:17], v21 offset:8192
    v_mfma_f32_16x16x32_bf16 v[112:115], a[4:7], v[56:59], v[112:115]
    ds_read_b128 v[84:87], v29 offset:20480
    ds_read_b64_tr_b16 a[18:19], v21 offset:10240
    v_mfma_f32_16x16x32_bf16 v[116:119], a[4:7], v[60:63], v[116:119]
    ds_read_b64_tr_b16 a[20:21], v22 offset:8192
    ds_read_b64_tr_b16 a[22:23], v22 offset:10240
    v_mfma_f32_16x16x32_bf16 v[120:123], a[4:7], v[64:67], v[120:123]
    ds_read_b128 v[88:91], v29 offset:22528
    ds_read_b64_tr_b16 a[24:25], v23 offset:8192
    v_mfma_f32_16x16x32_bf16 v[124:127], a[4:7], v[68:71], v[124:127]
    ds_read_b64_tr_b16 a[26:27], v23 offset:10240
    buffer_load_dwordx4 v7, s[36:39], s65 offen offset:2048  lds
    v_mfma_f32_16x16x32_bf16 v[128:131], a[8:11], v[56:59], v[128:131]
    ds_read_b64_tr_b16 a[28:29], v24 offset:8192
    buffer_load_dwordx4 v8, s[36:39], s65 offen offset:3072  lds
    v_mfma_f32_16x16x32_bf16 v[132:135], a[8:11], v[60:63], v[132:135]
    ds_read_b64_tr_b16 a[30:31], v24 offset:10240
    v_mfma_f32_16x16x32_bf16 v[136:139], a[8:11], v[64:67], v[136:139]
    s_add_u32 m0, s98, 8192
    v_mfma_f32_16x16x32_bf16 v[140:143], a[8:11], v[68:71], v[140:143]
    v_mfma_f32_16x16x32_bf16 v[144:147], a[12:15], v[56:59], v[144:147]
    v_mfma_f32_16x16x32_bf16 v[148:151], a[12:15], v[60:63], v[148:151]
    s_waitcnt lgkmcnt(0)
    buffer_load_dwordx4 v5, s[36:39], s66 offen  lds
    v_mfma_f32_16x16x32_bf16 v[152:155], a[12:15], v[64:67], v[152:155]
    v_mfma_f32_16x16x32_bf16 v[156:159], a[12:15], v[68:71], v[156:159]
    v_mfma_f32_16x16x32_bf16 v[96:99], a[16:19], v[76:79], v[96:99]
    ds_read_b128 v[56:59], v28 offset:24576
    buffer_load_dwordx4 v6, s[36:39], s66 offen offset:1024  lds
    v_mfma_f32_16x16x32_bf16 v[100:103], a[16:19], v[80:83], v[100:103]
    v_mfma_f32_16x16x32_bf16 v[104:107], a[16:19], v[84:87], v[104:107]
    ds_read_b128 v[60:63], v28 offset:26624
    v_mfma_f32_16x16x32_bf16 v[108:111], a[16:19], v[88:91], v[108:111]
    s_waitcnt vmcnt(14)
    ds_read_b64_tr_b16 a[0:1], v21 offset:12288
    v_mfma_f32_16x16x32_bf16 v[112:115], a[20:23], v[76:79], v[112:115]
    ds_read_b128 v[64:67], v28 offset:28672
    ds_read_b64_tr_b16 a[2:3], v21 offset:14336
    v_mfma_f32_16x16x32_bf16 v[116:119], a[20:23], v[80:83], v[116:119]
    ds_read_b64_tr_b16 a[4:5], v22 offset:12288
    ds_read_b64_tr_b16 a[6:7], v22 offset:14336
    v_mfma_f32_16x16x32_bf16 v[120:123], a[20:23], v[84:87], v[120:123]
    ds_read_b128 v[68:71], v28 offset:30720
    ds_read_b64_tr_b16 a[8:9], v23 offset:12288
    v_mfma_f32_16x16x32_bf16 v[124:127], a[20:23], v[88:91], v[124:127]
    ds_read_b64_tr_b16 a[10:11], v23 offset:14336
    buffer_load_dwordx4 v7, s[36:39], s66 offen offset:2048  lds
    v_mfma_f32_16x16x32_bf16 v[128:131], a[24:27], v[76:79], v[128:131]
    ds_read_b64_tr_b16 a[12:13], v24 offset:12288
    buffer_load_dwordx4 v8, s[36:39], s66 offen offset:3072  lds
    v_mfma_f32_16x16x32_bf16 v[132:135], a[24:27], v[80:83], v[132:135]
    ds_read_b64_tr_b16 a[14:15], v24 offset:14336
    v_mfma_f32_16x16x32_bf16 v[136:139], a[24:27], v[84:87], v[136:139]
    s_add_u32 m0, s98, 12288
    v_mfma_f32_16x16x32_bf16 v[140:143], a[24:27], v[88:91], v[140:143]
    v_mfma_f32_16x16x32_bf16 v[144:147], a[28:31], v[76:79], v[144:147]
    v_mfma_f32_16x16x32_bf16 v[148:151], a[28:31], v[80:83], v[148:151]
    s_waitcnt lgkmcnt(0)
    buffer_load_dwordx4 v5, s[36:39], s67 offen  lds
    v_mfma_f32_16x16x32_bf16 v[152:155], a[28:31], v[84:87], v[152:155]
    v_mfma_f32_16x16x32_bf16 v[156:159], a[28:31], v[88:91], v[156:159]
    v_mfma_f32_16x16x32_bf16 v[96:99], a[0:3], v[56:59], v[96:99]
    ds_read_b128 v[76:79], v29 offset:24576
    buffer_load_dwordx4 v6, s[36:39], s67 offen offset:1024  lds
    v_mfma_f32_16x16x32_bf16 v[100:103], a[0:3], v[60:63], v[100:103]
    v_mfma_f32_16x16x32_bf16 v[104:107], a[0:3], v[64:67], v[104:107]
    ds_read_b128 v[80:83], v29 offset:26624
    v_mfma_f32_16x16x32_bf16 v[108:111], a[0:3], v[68:71], v[108:111]
    s_waitcnt vmcnt(14)
    ds_read_b64_tr_b16 a[16:17], v21 offset:16384
    v_mfma_f32_16x16x32_bf16 v[112:115], a[4:7], v[56:59], v[112:115]
    ds_read_b128 v[84:87], v29 offset:28672
    ds_read_b64_tr_b16 a[18:19], v21 offset:18432
    v_mfma_f32_16x16x32_bf16 v[116:119], a[4:7], v[60:63], v[116:119]
    ds_read_b64_tr_b16 a[20:21], v22 offset:16384
    ds_read_b64_tr_b16 a[22:23], v22 offset:18432
    v_mfma_f32_16x16x32_bf16 v[120:123], a[4:7], v[64:67], v[120:123]
    ds_read_b128 v[88:91], v29 offset:30720
    ds_read_b64_tr_b16 a[24:25], v23 offset:16384
    v_mfma_f32_16x16x32_bf16 v[124:127], a[4:7], v[68:71], v[124:127]
    ds_read_b64_tr_b16 a[26:27], v23 offset:18432
    buffer_load_dwordx4 v7, s[36:39], s67 offen offset:2048  lds
    v_mfma_f32_16x16x32_bf16 v[128:131], a[8:11], v[56:59], v[128:131]
    ds_read_b64_tr_b16 a[28:29], v24 offset:16384
    buffer_load_dwordx4 v8, s[36:39], s67 offen offset:3072  lds
    v_mfma_f32_16x16x32_bf16 v[132:135], a[8:11], v[60:63], v[132:135]
    ds_read_b64_tr_b16 a[30:31], v24 offset:18432
    v_mfma_f32_16x16x32_bf16 v[136:139], a[8:11], v[64:67], v[136:139]
    s_add_u32 m0, s98, 16384
    v_mfma_f32_16x16x32_bf16 v[140:143], a[8:11], v[68:71], v[140:143]
    v_mfma_f32_16x16x32_bf16 v[144:147], a[12:15], v[56:59], v[144:147]
    v_mfma_f32_16x16x32_bf16 v[148:151], a[12:15], v[60:63], v[148:151]
    s_waitcnt lgkmcnt(0)
    buffer_load_dwordx4 v5, s[36:39], s68 offen  lds
    v_mfma_f32_16x16x32_bf16 v[152:155], a[12:15], v[64:67], v[152:155]
    v_add_u32 v28, 32768, v28
    v_add_u32 v29, 32768, v29
    v_mfma_f32_16x16x32_bf16 v[156:159], a[12:15], v[68:71], v[156:159]
    s_barrier
    v_mfma_f32_16x16x32_bf16 v[96:99], a[16:19], v[76:79], v[96:99]
    ds_read_b128 v[56:59], v28 offset:0
    buffer_load_dwordx4 v6, s[36:39], s68 offen offset:1024  lds
    v_mfma_f32_16x16x32_bf16 v[100:103], a[16:19], v[80:83], v[100:103]
    s_waitcnt vmcnt(14)
    ds_read_b64_tr_b16 a[0:1], v21 offset:0
    v_mfma_f32_16x16x32_bf16 v[104:107], a[16:19], v[84:87], v[104:107]
    ds_read_b128 v[60:63], v28 offset:2048
    ds_read_b64_tr_b16 a[2:3], v21 offset:2048
    v_mfma_f32_16x16x32_bf16 v[108:111], a[16:19], v[88:91], v[108:111]
    ds_read_b64_tr_b16 a[4:5], v22 offset:0
    buffer_load_dwordx4 v7, s[36:39], s68 offen offset:2048  lds
    v_mfma_f32_16x16x32_bf16 v[112:115], a[20:23], v[76:79], v[112:115]
    ds_read_b128 v[64:67], v28 offset:4096
    ds_read_b64_tr_b16 a[6:7], v22 offset:2048
    v_mfma_f32_16x16x32_bf16 v[116:119], a[20:23], v[80:83], v[116:119]
    ds_read_b64_tr_b16 a[8:9], v23 offset:0
    v_mfma_f32_16x16x32_bf16 v[120:123], a[20:23], v[84:87], v[120:123]
    ds_read_b128 v[68:71], v28 offset:6144
    ds_read_b64_tr_b16 a[10:11], v23 offset:2048
    v_mfma_f32_16x16x32_bf16 v[124:127], a[20:23], v[88:91], v[124:127]
    ds_read_b64_tr_b16 a[12:13], v24 offset:0
    buffer_load_dwordx4 v8, s[36:39], s68 offen offset:3072  lds
    v_mfma_f32_16x16x32_bf16 v[128:131], a[24:27], v[76:79], v[128:131]
    ds_read_b64_tr_b16 a[14:15], v24 offset:2048
    v_mfma_f32_16x16x32_bf16 v[132:135], a[24:27], v[80:83], v[132:135]
    s_add_u32 m0, s98, 0
    v_mfma_f32_16x16x32_bf16 v[136:139], a[24:27], v[84:87], v[136:139]
    v_mfma_f32_16x16x32_bf16 v[140:143], a[24:27], v[88:91], v[140:143]
    v_mfma_f32_16x16x32_bf16 v[144:147], a[28:31], v[76:79], v[144:147]
    s_waitcnt lgkmcnt(0)
    buffer_load_dwordx4 v5, s[36:39], s69 offen  lds
    v_mfma_f32_16x16x32_bf16 v[148:151], a[28:31], v[80:83], v[148:151]
    v_mfma_f32_16x16x32_bf16 v[152:155], a[28:31], v[84:87], v[152:155]
    v_mfma_f32_16x16x32_bf16 v[156:159], a[28:31], v[88:91], v[156:159]
    buffer_load_dwordx4 v6, s[36:39], s69 offen offset:1024  lds
    v_mfma_f32_16x16x32_bf16 v[96:99], a[0:3], v[56:59], v[96:99]
    ds_read_b128 v[76:79], v29 offset:0
    v_mfma_f32_16x16x32_bf16 v[100:103], a[0:3], v[60:63], v[100:103]
    v_mfma_f32_16x16x32_bf16 v[104:107], a[0:3], v[64:67], v[104:107]
    ds_read_b128 v[80:83], v29 offset:2048
    v_mfma_f32_16x16x32_bf16 v[108:111], a[0:3], v[68:71], v[108:111]
    s_waitcnt vmcnt(14)
    ds_read_b64_tr_b16 a[16:17], v21 offset:4096
    v_mfma_f32_16x16x32_bf16 v[112:115], a[4:7], v[56:59], v[112:115]
    ds_read_b128 v[84:87], v29 offset:4096
    ds_read_b64_tr_b16 a[18:19], v21 offset:6144
    v_mfma_f32_16x16x32_bf16 v[116:119], a[4:7], v[60:63], v[116:119]
    ds_read_b64_tr_b16 a[20:21], v22 offset:4096
    ds_read_b64_tr_b16 a[22:23], v22 offset:6144
    v_mfma_f32_16x16x32_bf16 v[120:123], a[4:7], v[64:67], v[120:123]
    ds_read_b128 v[88:91], v29 offset:6144
    ds_read_b64_tr_b16 a[24:25], v23 offset:4096
    v_mfma_f32_16x16x32_bf16 v[124:127], a[4:7], v[68:71], v[124:127]
    ds_read_b64_tr_b16 a[26:27], v23 offset:6144
    buffer_load_dwordx4 v7, s[36:39], s69 offen offset:2048  lds
    v_mfma_f32_16x16x32_bf16 v[128:131], a[8:11], v[56:59], v[128:131]
    ds_read_b64_tr_b16 a[28:29], v24 offset:4096
    buffer_load_dwordx4 v8, s[36:39], s69 offen offset:3072  lds
    v_mfma_f32_16x16x32_bf16 v[132:135], a[8:11], v[60:63], v[132:135]
    ds_read_b64_tr_b16 a[30:31], v24 offset:6144
    v_mfma_f32_16x16x32_bf16 v[136:139], a[8:11], v[64:67], v[136:139]
    s_add_u32 m0, s98, 4096
    s_xor_b32 s91, s18, 73984
    v_mfma_f32_16x16x32_bf16 v[140:143], a[8:11], v[68:71], v[140:143]
    v_mfma_f32_16x16x32_bf16 v[144:147], a[12:15], v[56:59], v[144:147]
    v_mfma_f32_16x16x32_bf16 v[148:151], a[12:15], v[60:63], v[148:151]
    s_waitcnt lgkmcnt(0)
    buffer_load_dwordx4 v9, s[28:31], s91 offen  lds
    v_mfma_f32_16x16x32_bf16 v[152:155], a[12:15], v[64:67], v[152:155]
    v_mfma_f32_16x16x32_bf16 v[156:159], a[12:15], v[68:71], v[156:159]
    v_mfma_f32_16x16x32_bf16 v[96:99], a[16:19], v[76:79], v[96:99]
    ds_read_b128 v[56:59], v28 offset:8192
    buffer_load_dwordx4 v10, s[28:31], s91 offen offset:1024  lds
    v_mfma_f32_16x16x32_bf16 v[100:103], a[16:19], v[80:83], v[100:103]
    v_mfma_f32_16x16x32_bf16 v[104:107], a[16:19], v[84:87], v[104:107]
    ds_read_b128 v[60:63], v28 offset:10240
    v_mfma_f32_16x16x32_bf16 v[108:111], a[16:19], v[88:91], v[108:111]
    s_waitcnt vmcnt(14)
    ds_read_b64_tr_b16 a[0:1], v21 offset:8192
    v_mfma_f32_16x16x32_bf16 v[112:115], a[20:23], v[76:79], v[112:115]
    ds_read_b128 v[64:67], v28 offset:12288
    ds_read_b64_tr_b16 a[2:3], v21 offset:10240
    v_mfma_f32_16x16x32_bf16 v[116:119], a[20:23], v[80:83], v[116:119]
    ds_read_b64_tr_b16 a[4:5], v22 offset:8192
    ds_read_b64_tr_b16 a[6:7], v22 offset:10240
    v_mfma_f32_16x16x32_bf16 v[120:123], a[20:23], v[84:87], v[120:123]
    ds_read_b128 v[68:71], v28 offset:14336
    ds_read_b64_tr_b16 a[8:9], v23 offset:8192
    v_mfma_f32_16x16x32_bf16 v[124:127], a[20:23], v[88:91], v[124:127]
    ds_read_b64_tr_b16 a[10:11], v23 offset:10240
    buffer_load_dwordx4 v11, s[28:31], s91 offen offset:2048  lds
    v_mfma_f32_16x16x32_bf16 v[128:131], a[24:27], v[76:79], v[128:131]
    ds_read_b64_tr_b16 a[12:13], v24 offset:8192
    buffer_load_dwordx4 v12, s[28:31], s91 offen offset:3072  lds
    v_mfma_f32_16x16x32_bf16 v[132:135], a[24:27], v[80:83], v[132:135]
    ds_read_b64_tr_b16 a[14:15], v24 offset:10240
    v_mfma_f32_16x16x32_bf16 v[136:139], a[24:27], v[84:87], v[136:139]
    s_add_u32 m0, s98, 8192
    s_xor_b32 s91, s18, 131072
    v_mfma_f32_16x16x32_bf16 v[140:143], a[24:27], v[88:91], v[140:143]
    v_mfma_f32_16x16x32_bf16 v[144:147], a[28:31], v[76:79], v[144:147]
    v_mfma_f32_16x16x32_bf16 v[148:151], a[28:31], v[80:83], v[148:151]
    s_waitcnt lgkmcnt(0)
    buffer_load_dwordx4 v9, s[28:31], s91 offen  lds
    v_mfma_f32_16x16x32_bf16 v[152:155], a[28:31], v[84:87], v[152:155]
    v_mfma_f32_16x16x32_bf16 v[156:159], a[28:31], v[88:91], v[156:159]
    v_mfma_f32_16x16x32_bf16 v[96:99], a[0:3], v[56:59], v[96:99]
    ds_read_b128 v[76:79], v29 offset:8192
    buffer_load_dwordx4 v10, s[28:31], s91 offen offset:1024  lds
    v_mfma_f32_16x16x32_bf16 v[100:103], a[0:3], v[60:63], v[100:103]
    v_mfma_f32_16x16x32_bf16 v[104:107], a[0:3], v[64:67], v[104:107]
    ds_read_b128 v[80:83], v29 offset:10240
    v_mfma_f32_16x16x32_bf16 v[108:111], a[0:3], v[68:71], v[108:111]
    s_waitcnt vmcnt(14)
    ds_read_b64_tr_b16 a[16:17], v21 offset:12288
    v_mfma_f32_16x16x32_bf16 v[112:115], a[4:7], v[56:59], v[112:115]
    ds_read_b128 v[84:87], v29 offset:12288
    ds_read_b64_tr_b16 a[18:19], v21 offset:14336
    v_mfma_f32_16x16x32_bf16 v[116:119], a[4:7], v[60:63], v[116:119]
    ds_read_b64_tr_b16 a[20:21], v22 offset:12288
    ds_read_b64_tr_b16 a[22:23], v22 offset:14336
    v_mfma_f32_16x16x32_bf16 v[120:123], a[4:7], v[64:67], v[120:123]
    ds_read_b128 v[88:91], v29 offset:14336
    ds_read_b64_tr_b16 a[24:25], v23 offset:12288
    v_mfma_f32_16x16x32_bf16 v[124:127], a[4:7], v[68:71], v[124:127]
    ds_read_b64_tr_b16 a[26:27], v23 offset:14336
    buffer_load_dwordx4 v11, s[28:31], s91 offen offset:2048  lds
    v_mfma_f32_16x16x32_bf16 v[128:131], a[8:11], v[56:59], v[128:131]
    ds_read_b64_tr_b16 a[28:29], v24 offset:12288
    buffer_load_dwordx4 v12, s[28:31], s91 offen offset:3072  lds
    v_mfma_f32_16x16x32_bf16 v[132:135], a[8:11], v[60:63], v[132:135]
    ds_read_b64_tr_b16 a[30:31], v24 offset:14336
    v_mfma_f32_16x16x32_bf16 v[136:139], a[8:11], v[64:67], v[136:139]
    s_add_u32 m0, s98, 12288
    s_xor_b32 s91, s18, 131328
    v_mfma_f32_16x16x32_bf16 v[140:143], a[8:11], v[68:71], v[140:143]
    v_mfma_f32_16x16x32_bf16 v[144:147], a[12:15], v[56:59], v[144:147]
    v_mfma_f32_16x16x32_bf16 v[148:151], a[12:15], v[60:63], v[148:151]
    s_waitcnt lgkmcnt(0)
    buffer_load_dwordx4 v9, s[28:31], s91 offen  lds
    v_mfma_f32_16x16x32_bf16 v[152:155], a[12:15], v[64:67], v[152:155]
    v_mfma_f32_16x16x32_bf16 v[156:159], a[12:15], v[68:71], v[156:159]
    v_mfma_f32_16x16x32_bf16 v[96:99], a[16:19], v[76:79], v[96:99]
    ds_read_b128 v[56:59], v28 offset:16384
    buffer_load_dwordx4 v10, s[28:31], s91 offen offset:1024  lds
    v_mfma_f32_16x16x32_bf16 v[100:103], a[16:19], v[80:83], v[100:103]
    v_mfma_f32_16x16x32_bf16 v[104:107], a[16:19], v[84:87], v[104:107]
    ds_read_b128 v[60:63], v28 offset:18432
    v_mfma_f32_16x16x32_bf16 v[108:111], a[16:19], v[88:91], v[108:111]
    s_waitcnt vmcnt(14)
    ds_read_b64_tr_b16 a[0:1], v21 offset:16384
    v_mfma_f32_16x16x32_bf16 v[112:115], a[20:23], v[76:79], v[112:115]
    ds_read_b128 v[64:67], v28 offset:20480
    ds_read_b64_tr_b16 a[2:3], v21 offset:18432
    v_mfma_f32_16x16x32_bf16 v[116:119], a[20:23], v[80:83], v[116:119]
    ds_read_b64_tr_b16 a[4:5], v22 offset:16384
    ds_read_b64_tr_b16 a[6:7], v22 offset:18432
    v_mfma_f32_16x16x32_bf16 v[120:123], a[20:23], v[84:87], v[120:123]
    ds_read_b128 v[68:71], v28 offset:22528
    ds_read_b64_tr_b16 a[8:9], v23 offset:16384
    v_mfma_f32_16x16x32_bf16 v[124:127], a[20:23], v[88:91], v[124:127]
    ds_read_b64_tr_b16 a[10:11], v23 offset:18432
    buffer_load_dwordx4 v11, s[28:31], s91 offen offset:2048  lds
    v_mfma_f32_16x16x32_bf16 v[128:131], a[24:27], v[76:79], v[128:131]
    ds_read_b64_tr_b16 a[12:13], v24 offset:16384
    buffer_load_dwordx4 v12, s[28:31], s91 offen offset:3072  lds
    v_mfma_f32_16x16x32_bf16 v[132:135], a[24:27], v[80:83], v[132:135]
    ds_read_b64_tr_b16 a[14:15], v24 offset:18432
    v_mfma_f32_16x16x32_bf16 v[136:139], a[24:27], v[84:87], v[136:139]
    s_add_u32 m0, s98, 16384
    s_xor_b32 s91, s18, 139264
    v_mfma_f32_16x16x32_bf16 v[140:143], a[24:27], v[88:91], v[140:143]
    v_mfma_f32_16x16x32_bf16 v[144:147], a[28:31], v[76:79], v[144:147]
    v_mfma_f32_16x16x32_bf16 v[148:151], a[28:31], v[80:83], v[148:151]
    s_waitcnt lgkmcnt(0)
    buffer_load_dwordx4 v9, s[28:31], s91 offen  lds
    v_mfma_f32_16x16x32_bf16 v[152:155], a[28:31], v[84:87], v[152:155]
    v_mfma_f32_16x16x32_bf16 v[156:159], a[28:31], v[88:91], v[156:159]
    v_mfma_f32_16x16x32_bf16 v[96:99], a[0:3], v[56:59], v[96:99]
    ds_read_b128 v[76:79], v29 offset:16384
    s_bfe_u32 s21, s18, 0x10008
    s_mul_i32 s21, s21, 16384
    v_mfma_f32_16x16x32_bf16 v[100:103], a[0:3], v[60:63], v[100:103]
    s_sub_u32 s22, 16384, s21
    buffer_load_dwordx4 v10, s[28:31], s91 offen offset:1024  lds
    v_mfma_f32_16x16x32_bf16 v[104:107], a[0:3], v[64:67], v[104:107]
    ds_read_b128 v[80:83], v29 offset:18432
    v_add_u32 v54, s21, v32
    v_add_u32 v55, s22, v32
    v_mfma_f32_16x16x32_bf16 v[108:111], a[0:3], v[68:71], v[108:111]
    s_waitcnt vmcnt(14)
    ds_read_b64_tr_b16 a[16:17], v21 offset:0
    v_mfma_f32_16x16x32_bf16 v[112:115], a[4:7], v[56:59], v[112:115]
    ds_read_b128 v[84:87], v29 offset:20480
    ds_read_b64_tr_b16 a[18:19], v21 offset:2048
    v_mfma_f32_16x16x32_bf16 v[116:119], a[4:7], v[60:63], v[116:119]
    ds_read_b64_tr_b16 a[20:21], v22 offset:0
    ds_read_b64_tr_b16 a[22:23], v22 offset:2048
    v_mfma_f32_16x16x32_bf16 v[120:123], a[4:7], v[64:67], v[120:123]
    ds_read_b128 v[88:91], v29 offset:22528
    ds_read_b64_tr_b16 a[24:25], v23 offset:0
    v_mfma_f32_16x16x32_bf16 v[124:127], a[4:7], v[68:71], v[124:127]
    ds_read_b64_tr_b16 a[26:27], v23 offset:2048
    buffer_load_dwordx4 v11, s[28:31], s91 offen offset:2048  lds
    v_mfma_f32_16x16x32_bf16 v[128:131], a[8:11], v[56:59], v[128:131]
    ds_read_b64_tr_b16 a[28:29], v24 offset:0
    buffer_load_dwordx4 v12, s[28:31], s91 offen offset:3072  lds
    v_mfma_f32_16x16x32_bf16 v[132:135], a[8:11], v[60:63], v[132:135]
    ds_read_b64_tr_b16 a[30:31], v24 offset:2048
    v_mfma_f32_16x16x32_bf16 v[136:139], a[8:11], v[64:67], v[136:139]
    s_add_u32 m0, s98, 0
    s_xor_b32 s91, s18, 139520
    v_mfma_f32_16x16x32_bf16 v[140:143], a[8:11], v[68:71], v[140:143]
    v_mfma_f32_16x16x32_bf16 v[144:147], a[12:15], v[56:59], v[144:147]
    v_mfma_f32_16x16x32_bf16 v[148:151], a[12:15], v[60:63], v[148:151]
    v_mfma_f32_16x16x32_bf16 v[152:155], a[12:15], v[64:67], v[152:155]
    v_mfma_f32_16x16x32_bf16 v[156:159], a[12:15], v[68:71], v[156:159]
    s_waitcnt lgkmcnt(5)
    v_mfma_f32_16x16x32_bf16 v[96:99], a[16:19], v[76:79], v[96:99]
    s_waitcnt lgkmcnt(0)
    buffer_load_dwordx4 v9, s[28:31], s91 offen  lds
    v_mfma_f32_16x16x32_bf16 v[100:103], a[16:19], v[80:83], v[100:103]
    v_mfma_f32_16x16x32_bf16 v[104:107], a[16:19], v[84:87], v[104:107]
    v_mfma_f32_16x16x32_bf16 v[108:111], a[16:19], v[88:91], v[108:111]
    s_nop 2
    v_cvt_pk_bf16_f32 v46, v96, v97
    v_cvt_pk_bf16_f32 v47, v98, v99
    v_mfma_f32_16x16x32_bf16 v[112:115], a[20:23], v[76:79], v[112:115]
    ds_write_b64 v34, v[46:47] offset:0
    v_cvt_pk_bf16_f32 v48, v100, v101
    v_cvt_pk_bf16_f32 v49, v102, v103
    v_mfma_f32_16x16x32_bf16 v[116:119], a[20:23], v[80:83], v[116:119]
    ds_write_b64 v34, v[48:49] offset:1024
    v_cvt_pk_bf16_f32 v50, v104, v105
    v_cvt_pk_bf16_f32 v51, v106, v107
    v_mfma_f32_16x16x32_bf16 v[120:123], a[20:23], v[84:87], v[120:123]
    ds_write_b64 v34, v[50:51] offset:2048
    buffer_load_dwordx4 v10, s[28:31], s91 offen offset:1024  lds
    v_cvt_pk_bf16_f32 v52, v108, v109
    v_cvt_pk_bf16_f32 v53, v110, v111
    v_mfma_f32_16x16x32_bf16 v[124:127], a[20:23], v[88:91], v[124:127]
    ds_write_b64 v34, v[52:53] offset:3072
    v_cvt_pk_bf16_f32 v46, v112, v113
    v_cvt_pk_bf16_f32 v47, v114, v115
    v_mfma_f32_16x16x32_bf16 v[128:131], a[24:27], v[76:79], v[128:131]
    ds_write_b64 v34, v[46:47] offset:512
    v_cvt_pk_bf16_f32 v48, v116, v117
    v_cvt_pk_bf16_f32 v49, v118, v119
    v_mfma_f32_16x16x32_bf16 v[132:135], a[24:27], v[80:83], v[132:135]
    ds_write_b64 v34, v[48:49] offset:1536
    v_cvt_pk_bf16_f32 v50, v120, v121
    v_cvt_pk_bf16_f32 v51, v122, v123
    v_mfma_f32_16x16x32_bf16 v[136:139], a[24:27], v[84:87], v[136:139]
    ds_write_b64 v34, v[50:51] offset:2560
    v_cvt_pk_bf16_f32 v52, v124, v125
    v_cvt_pk_bf16_f32 v53, v126, v127
    v_mfma_f32_16x16x32_bf16 v[140:143], a[24:27], v[88:91], v[140:143]
    ds_write_b64 v34, v[52:53] offset:3584
    v_cvt_pk_bf16_f32 v46, v128, v129
    v_cvt_pk_bf16_f32 v47, v130, v131
    v_mfma_f32_16x16x32_bf16 v[144:147], a[28:31], v[76:79], v[144:147]
    ds_write_b64 v34, v[46:47] offset:4096
    v_cvt_pk_bf16_f32 v48, v132, v133
    v_cvt_pk_bf16_f32 v49, v134, v135
    v_mfma_f32_16x16x32_bf16 v[148:151], a[28:31], v[80:83], v[148:151]
    ds_write_b64 v34, v[48:49] offset:5120
    v_cvt_pk_bf16_f32 v50, v136, v137
    v_cvt_pk_bf16_f32 v51, v138, v139
    v_mfma_f32_16x16x32_bf16 v[152:155], a[28:31], v[84:87], v[152:155]
    ds_write_b64 v34, v[50:51] offset:6144
    v_cvt_pk_bf16_f32 v52, v140, v141
    v_cvt_pk_bf16_f32 v53, v142, v143
    v_mfma_f32_16x16x32_bf16 v[156:159], a[28:31], v[88:91], v[156:159]
    ds_write_b64 v34, v[52:53] offset:7168
    v_cvt_pk_bf16_f32 v46, v144, v145
    v_cvt_pk_bf16_f32 v47, v146, v147
    ds_write_b64 v34, v[46:47] offset:4608
    v_cvt_pk_bf16_f32 v48, v148, v149
    v_cvt_pk_bf16_f32 v49, v150, v151
    v_cvt_pk_bf16_f32 v50, v152, v153
    v_cvt_pk_bf16_f32 v51, v154, v155
    v_cvt_pk_bf16_f32 v52, v156, v157
    v_cvt_pk_bf16_f32 v53, v158, v159
    ds_write_b64 v34, v[48:49] offset:5632
    ds_write_b64 v34, v[50:51] offset:6656
    ds_write_b64 v34, v[52:53] offset:7680
    s_waitcnt lgkmcnt(0)
    s_barrier
    ds_read_b128 a[0:3], v54 offset:0
    ds_read_b128 a[4:7], v54 offset:1024
    ds_read_b128 a[8:11], v54 offset:2048
    ds_read_b128 a[12:15], v54 offset:3072
    ds_read_b128 a[16:19], v54 offset:4096
    ds_read_b128 a[20:23], v54 offset:5120
    ds_read_b128 a[24:27], v54 offset:6144
    ds_read_b128 a[28:31], v54 offset:7168
    buffer_load_dwordx4 v11, s[28:31], s91 offen offset:2048  lds
    s_waitcnt lgkmcnt(7)
    v_mfma_f32_16x16x32_bf16 v[96:99], a[240:243], a[0:3], 0
    ds_read_b128 a[32:35], v54 offset:8192
    s_waitcnt vmcnt(15)
    ds_read_b128 a[128:131], v30 offset:4096
    s_waitcnt lgkmcnt(8)
    v_mfma_f32_16x16x32_bf16 v[100:103], a[240:243], a[4:7], 0
    ds_read_b128 a[36:39], v54 offset:9216
    ds_read_b128 a[132:135], v31 offset:4096
    s_waitcnt lgkmcnt(9)
    v_mfma_f32_16x16x32_bf16 v[104:107], a[240:243], a[8:11], 0
    ds_read_b128 a[40:43], v54 offset:10240
    s_mov_b32 s4, 0
    ds_read_b128 a[136:139], v30 offset:6144
    s_waitcnt lgkmcnt(10)
    v_mfma_f32_16x16x32_bf16 v[108:111], a[240:243], a[12:15], 0
    ds_read_b128 a[44:47], v54 offset:11264
    s_lshl_b32 s21, s3, 3
    s_lshr_b32 s5, s17, 1
    s_waitcnt lgkmcnt(10)
    v_mfma_f32_16x16x32_bf16 v[96:99], a[244:247], a[16:19], v[96:99]
    ds_read_b128 a[48:51], v54 offset:12288
    s_add_u32 s5, s5, s21
    s_waitcnt lgkmcnt(10)
    v_mfma_f32_16x16x32_bf16 v[100:103], a[244:247], a[20:23], v[100:103]
    ds_read_b128 a[52:55], v54 offset:13312
    ds_read_b128 a[140:143], v31 offset:6144
    s_waitcnt lgkmcnt(11)
    v_mfma_f32_16x16x32_bf16 v[104:107], a[244:247], a[24:27], v[104:107]
    ds_read_b128 a[56:59], v54 offset:14336
    buffer_load_dwordx4 v12, s[28:31], s91 offen offset:3072  lds
    s_waitcnt lgkmcnt(11)
    v_mfma_f32_16x16x32_bf16 v[108:111], a[244:247], a[28:31], v[108:111]
    ds_read_b128 a[60:63], v54 offset:15360
    s_add_u32 m0, s98, 4096
    s_xor_b32 s91, s18, 196608
    s_waitcnt lgkmcnt(11)
    v_mfma_f32_16x16x32_bf16 v[96:99], a[248:251], a[32:35], v[96:99]
    ds_read_b128 a[64:67], v55 offset:0
    s_waitcnt lgkmcnt(10)
    v_mfma_f32_16x16x32_bf16 v[100:103], a[248:251], a[36:39], v[100:103]
    ds_read_b128 a[68:71], v55 offset:1024
    s_waitcnt lgkmcnt(4)
    buffer_load_dwordx4 v9, s[28:31], s91 offen  lds
    v_mfma_f32_16x16x32_bf16 v[104:107], a[248:251], a[40:43], v[104:107]
    ds_read_b128 a[72:75], v55 offset:2048
    v_mfma_f32_16x16x32_bf16 v[108:111], a[248:251], a[44:47], v[108:111]
    ds_read_b128 a[76:79], v55 offset:3072
    v_mfma_f32_16x16x32_bf16 v[96:99], a[252:255], a[48:51], v[96:99]
    ds_read_b128 a[80:83], v55 offset:4096
    buffer_load_dwordx4 v10, s[28:31], s91 offen offset:1024  lds
    v_mfma_f32_16x16x32_bf16 v[100:103], a[252:255], a[52:55], v[100:103]
    ds_read_b128 a[84:87], v55 offset:5120
    s_waitcnt lgkmcnt(7)
    v_mfma_f32_16x16x32_bf16 v[104:107], a[252:255], a[56:59], v[104:107]
    ds_read_b128 a[88:91], v55 offset:6144
    s_waitcnt lgkmcnt(7)
    v_mfma_f32_16x16x32_bf16 v[108:111], a[252:255], a[60:63], v[108:111]
    ds_read_b128 a[92:95], v55 offset:7168
    buffer_load_dwordx4 v11, s[28:31], s91 offen offset:2048  lds
    s_waitcnt lgkmcnt(7)
    v_mfma_f32_16x16x32_bf16 v[96:99], a[224:227], a[64:67], v[96:99]
    ds_read_b128 a[96:99], v55 offset:8192
    s_waitcnt lgkmcnt(7)
    v_mfma_f32_16x16x32_bf16 v[100:103], a[224:227], a[68:71], v[100:103]
    ds_read_b128 a[100:103], v55 offset:9216
    s_waitcnt lgkmcnt(7)
    v_mfma_f32_16x16x32_bf16 v[104:107], a[224:227], a[72:75], v[104:107]
    ds_read_b128 a[104:107], v55 offset:10240
    s_waitcnt vmcnt(15)
    ds_read_b128 a[240:243], v30 offset:8192
    s_waitcnt lgkmcnt(8)
    v_mfma_f32_16x16x32_bf16 v[108:111], a[224:227], a[76:79], v[108:111]
    ds_read_b128 a[108:111], v55 offset:11264
    ds_read_b128 a[244:247], v31 offset:8192
    s_waitcnt lgkmcnt(9)
    v_mfma_f32_16x16x32_bf16 v[96:99], a[228:231], a[80:83], v[96:99]
    ds_read_b128 a[112:115], v55 offset:12288
    ds_read_b128 a[248:251], v30 offset:10240
    s_waitcnt lgkmcnt(10)
    v_mfma_f32_16x16x32_bf16 v[100:103], a[228:231], a[84:87], v[100:103]
    ds_read_b128 a[116:119], v55 offset:13312
    ds_read_b128 a[252:255], v31 offset:10240
    s_waitcnt lgkmcnt(11)
    v_mfma_f32_16x16x32_bf16 v[104:107], a[228:231], a[88:91], v[104:107]
    ds_read_b128 a[120:123], v55 offset:14336
    buffer_load_dwordx4 v12, s[28:31], s91 offen offset:3072  lds
    s_waitcnt lgkmcnt(11)
    v_mfma_f32_16x16x32_bf16 v[108:111], a[228:231], a[92:95], v[108:111]
    ds_read_b128 a[124:127], v55 offset:15360
    s_waitcnt lgkmcnt(11)
    v_mfma_f32_16x16x32_bf16 v[96:99], a[232:235], a[96:99], v[96:99]
    s_add_u32 m0, s98, 8192
    s_xor_b32 s91, s18, 196864
    s_waitcnt lgkmcnt(10)
    v_mfma_f32_16x16x32_bf16 v[100:103], a[232:235], a[100:103], v[100:103]
    s_waitcnt lgkmcnt(2)
    buffer_load_dwordx4 v9, s[28:31], s91 offen  lds
    v_mfma_f32_16x16x32_bf16 v[104:107], a[232:235], a[104:107], v[104:107]
    v_mfma_f32_16x16x32_bf16 v[108:111], a[232:235], a[108:111], v[108:111]
    v_mfma_f32_16x16x32_bf16 v[96:99], a[236:239], a[112:115], v[96:99]
    s_cmp_eq_u32 s5, 0
    s_cbranch_scc1 L_ar4_0
L_ab4_0:
    v_mfma_f32_16x16x32_bf16 v[100:103], a[236:239], a[116:119], v[100:103]
    buffer_load_dwordx4 v10, s[28:31], s91 offen offset:1024  lds
    s_waitcnt lgkmcnt(1)
    v_mfma_f32_16x16x32_bf16 v[104:107], a[236:239], a[120:123], v[104:107]
    s_waitcnt lgkmcnt(0)
    v_mfma_f32_16x16x32_bf16 v[108:111], a[236:239], a[124:127], v[108:111]
    v_mfma_f32_16x16x32_bf16 v[112:115], a[208:211], a[0:3], 0
    buffer_load_dwordx4 v11, s[28:31], s91 offen offset:2048  lds
    v_mfma_f32_16x16x32_bf16 v[116:119], a[208:211], a[4:7], 0
    v_mfma_f32_16x16x32_bf16 v[120:123], a[208:211], a[8:11], 0
    v_mfma_f32_16x16x32_bf16 v[124:127], a[208:211], a[12:15], 0
    v_mfma_f32_16x16x32_bf16 v[112:115], a[212:215], a[16:19], v[112:115]
    s_mul_i32 s48, s3, 128
    buffer_load_dwordx4 v12, s[28:31], s91 offen offset:3072  lds
    v_mfma_f32_16x16x32_bf16 v[116:119], a[212:215], a[20:23], v[116:119]
    s_waitcnt vmcnt(16)
    ds_read_b128 a[224:227], v30 offset:12288
    v_mfma_f32_16x16x32_bf16 v[120:123], a[212:215], a[24:27], v[120:123]
    ds_read_b128 a[228:231], v31 offset:12288
    ds_read_b128 a[232:235], v30 offset:14336
    v_mfma_f32_16x16x32_bf16 v[124:127], a[212:215], a[28:31], v[124:127]
    ds_read_b128 a[236:239], v31 offset:14336
    v_mfma_f32_16x16x32_bf16 v[112:115], a[216:219], a[32:35], v[112:115]
    s_add_u32 m0, s98, 12288
    s_xor_b32 s91, s18, 204800
    v_mfma_f32_16x16x32_bf16 v[116:119], a[216:219], a[36:39], v[116:119]
    s_lshl_b32 s49, 1, s17
    v_mfma_f32_16x16x32_bf16 v[120:123], a[216:219], a[40:43], v[120:123]
    v_max3_f32 v46, v96, v97, v98
    v_max_f32 v46, v46, v99
    v_mfma_f32_16x16x32_bf16 v[124:127], a[216:219], a[44:47], v[124:127]
    s_waitcnt lgkmcnt(0)
    buffer_load_dwordx4 v9, s[28:31], s91 offen  lds
    v_mfma_f32_16x16x32_bf16 v[112:115], a[220:223], a[48:51], v[112:115]
    v_max3_f32 v47, v100, v101, v102
    v_mfma_f32_16x16x32_bf16 v[116:119], a[220:223], a[52:55], v[116:119]
    v_max_f32 v47, v47, v103
    v_mfma_f32_16x16x32_bf16 v[120:123], a[220:223], a[56:59], v[120:123]
    v_max3_f32 v48, v104, v105, v106
    v_mfma_f32_16x16x32_bf16 v[124:127], a[220:223], a[60:63], v[124:127]
    buffer_load_dwordx4 v10, s[28:31], s91 offen offset:1024  lds
    v_mfma_f32_16x16x32_bf16 v[112:115], a[192:195], a[64:67], v[112:115]
    v_mul_u32_u24 v2, 512, v0
    v_mfma_f32_16x16x32_bf16 v[116:119], a[192:195], a[68:71], v[116:119]
    v_add_u32 v2, s48, v2
    v_max_f32 v48, v48, v107
    v_mfma_f32_16x16x32_bf16 v[120:123], a[192:195], a[72:75], v[120:123]
    buffer_load_dwordx4 v11, s[28:31], s91 offen offset:2048  lds
    v_mfma_f32_16x16x32_bf16 v[124:127], a[192:195], a[76:79], v[124:127]
    v_mov_b32 v34, s49
    v_mfma_f32_16x16x32_bf16 v[112:115], a[196:199], a[80:83], v[112:115]
    v_mov_b32 v76, 0x3f803f80
    v_mfma_f32_16x16x32_bf16 v[116:119], a[196:199], a[84:87], v[116:119]
    v_max3_f32 v49, v108, v109, v110
    v_mfma_f32_16x16x32_bf16 v[120:123], a[196:199], a[88:91], v[120:123]
    s_waitcnt vmcnt(15)
    ds_read_b128 a[208:211], v30 offset:16384
    v_mfma_f32_16x16x32_bf16 v[124:127], a[196:199], a[92:95], v[124:127]
    ds_read_b128 a[212:215], v31 offset:16384
    buffer_load_dwordx4 v12, s[28:31], s91 offen offset:3072  lds
    v_mfma_f32_16x16x32_bf16 v[112:115], a[200:203], a[96:99], v[112:115]
    ds_read_b128 a[216:219], v30 offset:18432
    v_mfma_f32_16x16x32_bf16 v[116:119], a[200:203], a[100:103], v[116:119]
    ds_read_b128 a[220:223], v31 offset:18432
    v_max_f32 v49, v49, v111
    v_mfma_f32_16x16x32_bf16 v[120:123], a[200:203], a[104:107], v[120:123]
    s_add_u32 m0, s98, 16384
    s_xor_b32 s91, s18, 205056
    v_mfma_f32_16x16x32_bf16 v[124:127], a[200:203], a[108:111], v[124:127]
    v_mov_b32 v77, 0x3f803f80
    v_mfma_f32_16x16x32_bf16 v[112:115], a[204:207], a[112:115], v[112:115]
    s_cmp_eq_u32 s5, 1
    s_cbranch_scc1 L_ar4_1
L_ab4_1:
    v_mfma_f32_16x16x32_bf16 v[116:119], a[204:207], a[116:119], v[116:119]
    v_mov_b32 v78, 0x3f803f80
    v_mfma_f32_16x16x32_bf16 v[120:123], a[204:207], a[120:123], v[120:123]
    s_waitcnt lgkmcnt(0)
    buffer_load_dwordx4 v9, s[28:31], s91 offen  lds
    v_mfma_f32_16x16x32_bf16 v[124:127], a[204:207], a[124:127], v[124:127]
    v_mov_b32 v79, 0x3f803f80
    v_mfma_f32_16x16x32_bf16 v[128:131], a[176:179], a[0:3], 0
    v_mfma_f32_16x16x32_bf16 v[132:135], a[176:179], a[4:7], 0
    v_mfma_f32_16x16x32_bf16 v[136:139], a[176:179], a[8:11], 0
    buffer_load_dwordx4 v10, s[28:31], s91 offen offset:1024  lds
    v_mfma_f32_16x16x32_bf16 v[140:143], a[176:179], a[12:15], 0
    v_max3_f32 v46, v46, v112, v113
    v_max3_f32 v46, v46, v114, v115
    v_mfma_f32_16x16x32_bf16 v[128:131], a[180:183], a[16:19], v[128:131]
    v_max3_f32 v47, v47, v116, v117
    v_max3_f32 v47, v47, v118, v119
    v_mfma_f32_16x16x32_bf16 v[132:135], a[180:183], a[20:23], v[132:135]
    v_max3_f32 v48, v48, v120, v121
    v_max3_f32 v48, v48, v122, v123
    v_mfma_f32_16x16x32_bf16 v[136:139], a[180:183], a[24:27], v[136:139]
    v_max3_f32 v49, v49, v124, v125
    v_max3_f32 v49, v49, v126, v127
    v_mfma_f32_16x16x32_bf16 v[140:143], a[180:183], a[28:31], v[140:143]
    buffer_load_dwordx4 v11, s[28:31], s91 offen offset:2048  lds
    v_mfma_f32_16x16x32_bf16 v[128:131], a[184:187], a[32:35], v[128:131]
    v_permlane32_swap_b32 v46, v48
    v_permlane32_swap_b32 v47, v49
    v_mfma_f32_16x16x32_bf16 v[132:135], a[184:187], a[36:39], v[132:135]
    v_max_f32 v46, v46, v48
    v_max_f32 v47, v47, v49
    v_mfma_f32_16x16x32_bf16 v[136:139], a[184:187], a[40:43], v[136:139]
    s_waitcnt vmcnt(15)
    ds_read_b128 a[192:195], v30 offset:0
    v_mfma_f32_16x16x32_bf16 v[140:143], a[184:187], a[44:47], v[140:143]
    v_permlane16_swap_b32 v46, v47
    v_max_f32 v46, v46, v47
    v_mfma_f32_16x16x32_bf16 v[128:131], a[188:191], a[48:51], v[128:131]
    ds_max_f32 v44, v46 offset:0
    ds_read_b128 a[196:199], v31 offset:0
    v_mfma_f32_16x16x32_bf16 v[132:135], a[188:191], a[52:55], v[132:135]
    ds_read_b128 a[200:203], v30 offset:2048
    ds_read_b128 a[204:207], v31 offset:2048
    v_mfma_f32_16x16x32_bf16 v[136:139], a[188:191], a[56:59], v[136:139]
    buffer_load_dwordx4 v12, s[28:31], s91 offen offset:3072  lds
    v_mfma_f32_16x16x32_bf16 v[140:143], a[188:191], a[60:63], v[140:143]
    s_add_u32 m0, s98, 0
    s_xor_b32 s91, s90, 0
    v_mfma_f32_16x16x32_bf16 v[128:131], a[160:163], a[64:67], v[128:131]
    v_mfma_f32_16x16x32_bf16 v[132:135], a[160:163], a[68:71], v[132:135]
    s_waitcnt lgkmcnt(0)
    buffer_load_dwordx4 v13, s[32:35], s91 offen  lds
    v_mfma_f32_16x16x32_bf16 v[136:139], a[160:163], a[72:75], v[136:139]
    v_mfma_f32_16x16x32_bf16 v[140:143], a[160:163], a[76:79], v[140:143]
    v_mfma_f32_16x16x32_bf16 v[128:131], a[164:167], a[80:83], v[128:131]
    buffer_load_dwordx4 v14, s[32:35], s91 offen offset:1024  lds
    v_mfma_f32_16x16x32_bf16 v[132:135], a[164:167], a[84:87], v[132:135]
    v_mfma_f32_16x16x32_bf16 v[136:139], a[164:167], a[88:91], v[136:139]
    s_barrier
    ds_read_b128 v[192:195], v38 offset:0
    v_mfma_f32_16x16x32_bf16 v[140:143], a[164:167], a[92:95], v[140:143]
    v_mfma_f32_16x16x32_bf16 v[128:131], a[168:171], a[96:99], v[128:131]
    buffer_load_dwordx4 v15, s[32:35], s91 offen offset:2048  lds
    v_mfma_f32_16x16x32_bf16 v[132:135], a[168:171], a[100:103], v[132:135]
    v_mfma_f32_16x16x32_bf16 v[136:139], a[168:171], a[104:107], v[136:139]
    v_mfma_f32_16x16x32_bf16 v[140:143], a[168:171], a[108:111], v[140:143]
    s_waitcnt vmcnt(15)
    ds_read_b128 a[176:179], v30 offset:4096
    v_mfma_f32_16x16x32_bf16 v[128:131], a[172:175], a[112:115], v[128:131]
    s_cmp_eq_u32 s5, 2
    s_cbranch_scc1 L_ar4_2
L_ab4_2:
    v_mfma_f32_16x16x32_bf16 v[132:135], a[172:175], a[116:119], v[132:135]
    ds_read_b128 a[180:183], v31 offset:4096
    ds_read_b128 a[184:187], v30 offset:6144
    s_waitcnt lgkmcnt(3)
    v_mul_f32 v51, 0xbdb8aa3b, v192
    v_mfma_f32_16x16x32_bf16 v[136:139], a[172:175], a[120:123], v[136:139]
    ds_read_b128 a[188:191], v31 offset:6144
    buffer_load_dwordx4 v16, s[32:35], s91 offen offset:3072  lds
    v_mul_f32 v52, 0xbdb8aa3b, v193
    v_mfma_f32_16x16x32_bf16 v[140:143], a[172:175], a[124:127], v[140:143]
    s_add_u32 m0, s98, 4096
    s_xor_b32 s91, s90, 16384
    v_mul_f32 v53, 0xbdb8aa3b, v194
    v_mfma_f32_16x16x32_bf16 v[144:147], a[144:147], a[0:3], 0
    v_mul_f32 v54, 0xbdb8aa3b, v195
    v_fma_f32 v96, v96, s96, v51
    v_fma_f32 v97, v97, s96, v51
    v_mfma_f32_16x16x32_bf16 v[148:151], a[144:147], a[4:7], 0
    v_exp_f32 v96, v96
    v_exp_f32 v97, v97
    v_mfma_f32_16x16x32_bf16 v[152:155], a[144:147], a[8:11], 0
    s_waitcnt lgkmcnt(0)
    buffer_load_dwordx4 v13, s[32:35], s91 offen  lds
    v_fma_f32 v98, v98, s96, v51
    v_mfma_f32_16x16x32_bf16 v[156:159], a[144:147], a[12:15], 0
    v_fma_f32 v99, v99, s96, v51
    v_exp_f32 v98, v98
    v_mfma_f32_16x16x32_bf16 v[144:147], a[148:151], a[16:19], v[144:147]
    v_exp_f32 v99, v99
    v_fma_f32 v112, v112, s96, v51
    v_mfma_f32_16x16x32_bf16 v[148:151], a[148:151], a[20:23], v[148:151]
    v_fma_f32 v113, v113, s96, v51
    v_exp_f32 v112, v112
    v_mfma_f32_16x16x32_bf16 v[152:155], a[148:151], a[24:27], v[152:155]
    buffer_load_dwordx4 v14, s[32:35], s91 offen offset:1024  lds
    v_exp_f32 v113, v113
    v_fma_f32 v114, v114, s96, v51
    v_mfma_f32_16x16x32_bf16 v[156:159], a[148:151], a[28:31], v[156:159]
    v_fma_f32 v115, v115, s96, v51
    v_exp_f32 v114, v114
    v_mfma_f32_16x16x32_bf16 v[144:147], a[152:155], a[32:35], v[144:147]
    v_cvt_pk_bf16_f32 v200, v96, v97
    v_cvt_pk_bf16_f32 v201, v98, v99
    v_mfma_f32_16x16x32_bf16 v[148:151], a[152:155], a[36:39], v[148:151]
    buffer_load_dwordx4 v15, s[32:35], s91 offen offset:2048  lds
    v_exp_f32 v115, v115
    v_cvt_pk_bf16_f32 v202, v112, v113
    v_mfma_f32_16x16x32_bf16 v[152:155], a[152:155], a[40:43], v[152:155]
    v_cvt_pk_bf16_f32 v203, v114, v115
    v_max3_f32 v46, v128, v129, v130
    v_mfma_f32_16x16x32_bf16 v[156:159], a[152:155], a[44:47], v[156:159]
    v_max_f32 v46, v46, v131
    v_max3_f32 v47, v132, v133, v134
    v_mfma_f32_16x16x32_bf16 v[144:147], a[156:159], a[48:51], v[144:147]
    v_fma_f32 v100, v100, s96, v52
    v_max_f32 v47, v47, v135
    v_mfma_f32_16x16x32_bf16 v[148:151], a[156:159], a[52:55], v[148:151]
    s_waitcnt vmcnt(15)
    ds_read_b128 a[160:163], v30 offset:8192
    v_fma_f32 v101, v101, s96, v52
    v_mfma_f32_16x16x32_bf16 v[152:155], a[156:159], a[56:59], v[152:155]
    ds_read_b128 a[164:167], v31 offset:8192
    buffer_load_dwordx4 v16, s[32:35], s91 offen offset:3072  lds
    v_exp_f32 v100, v100
    v_mfma_f32_16x16x32_bf16 v[156:159], a[156:159], a[60:63], v[156:159]
    ds_read_b128 a[168:171], v30 offset:10240
    v_exp_f32 v101, v101
    v_mfma_f32_16x16x32_bf16 v[144:147], a[128:131], a[64:67], v[144:147]
    ds_read_b128 a[172:175], v31 offset:10240
    ds_write_b128 v35, v[200:203] offset:0
    v_mfma_f32_16x16x32_bf16 v[56:59], v[76:79], v[200:203], 0
    v_fma_f32 v102, v102, s96, v52
    v_fma_f32 v103, v103, s96, v52
    v_mfma_f32_16x16x32_bf16 v[148:151], a[128:131], a[68:71], v[148:151]
    s_add_u32 m0, s98, 8192
    s_xor_b32 s91, s90, 32768
    v_exp_f32 v102, v102
    v_mfma_f32_16x16x32_bf16 v[152:155], a[128:131], a[72:75], v[152:155]
    v_exp_f32 v103, v103
    v_mfma_f32_16x16x32_bf16 v[156:159], a[128:131], a[76:79], v[156:159]
    v_fma_f32 v116, v116, s96, v52
    v_fma_f32 v117, v117, s96, v52
    v_exp_f32 v116, v116
    v_mfma_f32_16x16x32_bf16 v[144:147], a[132:135], a[80:83], v[144:147]
    s_waitcnt lgkmcnt(1)
    buffer_load_dwordx4 v13, s[32:35], s91 offen  lds
    v_mfma_f32_16x16x32_bf16 v[148:151], a[132:135], a[84:87], v[148:151]
    v_exp_f32 v117, v117
    v_fma_f32 v118, v118, s96, v52
    v_fma_f32 v119, v119, s96, v52
    v_mfma_f32_16x16x32_bf16 v[152:155], a[132:135], a[88:91], v[152:155]
    v_exp_f32 v118, v118
    v_cvt_pk_bf16_f32 v204, v100, v101
    v_mfma_f32_16x16x32_bf16 v[156:159], a[132:135], a[92:95], v[156:159]
    v_cvt_pk_bf16_f32 v205, v102, v103
    v_exp_f32 v119, v119
    v_mfma_f32_16x16x32_bf16 v[144:147], a[136:139], a[96:99], v[144:147]
    buffer_load_dwordx4 v14, s[32:35], s91 offen offset:1024  lds
    v_cvt_pk_bf16_f32 v206, v116, v117
    v_cvt_pk_bf16_f32 v207, v118, v119
    v_mfma_f32_16x16x32_bf16 v[148:151], a[136:139], a[100:103], v[148:151]
    v_max3_f32 v48, v136, v137, v138
    v_max_f32 v48, v48, v139
    v_mfma_f32_16x16x32_bf16 v[152:155], a[136:139], a[104:107], v[152:155]
    v_max3_f32 v49, v140, v141, v142
    v_max_f32 v49, v49, v143
    v_mfma_f32_16x16x32_bf16 v[156:159], a[136:139], a[108:111], v[156:159]
    v_fma_f32 v104, v104, s96, v53
    v_fma_f32 v105, v105, s96, v53
    v_mfma_f32_16x16x32_bf16 v[144:147], a[140:143], a[112:115], v[144:147]
    s_cmp_eq_u32 s5, 3
    s_cbranch_scc1 L_ar4_3
L_ab4_3:
    v_exp_f32 v104, v104
    v_mfma_f32_16x16x32_bf16 v[148:151], a[140:143], a[116:119], v[148:151]
    buffer_load_dwordx4 v15, s[32:35], s91 offen offset:2048  lds
    v_exp_f32 v105, v105
    v_mfma_f32_16x16x32_bf16 v[152:155], a[140:143], a[120:123], v[152:155]
    v_fma_f32 v106, v106, s96, v53
    v_fma_f32 v107, v107, s96, v53
    v_exp_f32 v106, v106
    v_mfma_f32_16x16x32_bf16 v[156:159], a[140:143], a[124:127], v[156:159]
    v_exp_f32 v107, v107
    v_mfma_f32_16x16x32_bf16 v[160:163], a[240:243], a[0:3], 0
    s_waitcnt vmcnt(15)
    ds_read_b128 a[144:147], v30 offset:12288
    v_fma_f32 v120, v120, s96, v53
    v_fma_f32 v121, v121, s96, v53
    v_mfma_f32_16x16x32_bf16 v[164:167], a[240:243], a[4:7], 0
    ds_read_b128 a[148:151], v31 offset:12288
    buffer_load_dwordx4 v16, s[32:35], s91 offen offset:3072  lds
    v_mfma_f32_16x16x32_bf16 v[168:171], a[240:243], a[8:11], 0
    ds_read_b128 a[152:155], v30 offset:14336
    v_exp_f32 v120, v120
    v_mfma_f32_16x16x32_bf16 v[172:175], a[240:243], a[12:15], 0
    ds_read_b128 a[156:159], v31 offset:14336
    ds_write_b128 v35, v[204:207] offset:1024
    v_mfma_f32_16x16x32_bf16 v[60:63], v[76:79], v[204:207], 0
    v_max3_f32 v46, v46, v144, v145
    v_max3_f32 v46, v46, v146, v147
    v_mfma_f32_16x16x32_bf16 v[160:163], a[244:247], a[16:19], v[160:163]
    v_max3_f32 v47, v47, v148, v149
    v_max3_f32 v47, v47, v150, v151
    v_exp_f32 v121, v121
    v_mfma_f32_16x16x32_bf16 v[164:167], a[244:247], a[20:23], v[164:167]
    v_max3_f32 v48, v48, v152, v153
    v_max3_f32 v48, v48, v154, v155
    v_fma_f32 v122, v122, s96, v53
    v_mfma_f32_16x16x32_bf16 v[168:171], a[244:247], a[24:27], v[168:171]
    v_max3_f32 v49, v49, v156, v157
    v_max3_f32 v49, v49, v158, v159
    v_fma_f32 v123, v123, s96, v53
    v_mfma_f32_16x16x32_bf16 v[172:175], a[244:247], a[28:31], v[172:175]
    s_add_u32 m0, s98, 12288
    s_xor_b32 s91, s90, 49152
    v_exp_f32 v122, v122
    v_mfma_f32_16x16x32_bf16 v[160:163], a[248:251], a[32:35], v[160:163]
    v_permlane32_swap_b32 v46, v48
    v_permlane32_swap_b32 v47, v49
    v_cvt_pk_bf16_f32 v200, v104, v105
    v_mfma_f32_16x16x32_bf16 v[164:167], a[248:251], a[36:39], v[164:167]
    v_max_f32 v46, v46, v48
    v_max_f32 v47, v47, v49
    v_cvt_pk_bf16_f32 v201, v106, v107
    v_mfma_f32_16x16x32_bf16 v[168:171], a[248:251], a[40:43], v[168:171]
    s_waitcnt lgkmcnt(1)
    buffer_load_dwordx4 v13, s[32:35], s91 offen  lds
    v_exp_f32 v123, v123
    v_mfma_f32_16x16x32_bf16 v[172:175], a[248:251], a[44:47], v[172:175]
    v_permlane16_swap_b32 v46, v47
    v_max_f32 v46, v46, v47
    v_mfma_f32_16x16x32_bf16 v[160:163], a[252:255], a[48:51], v[160:163]
    ds_max_f32 v44, v46 offset:512
    buffer_load_dwordx4 v14, s[32:35], s91 offen offset:1024  lds
    v_cvt_pk_bf16_f32 v202, v120, v121
    v_mfma_f32_16x16x32_bf16 v[164:167], a[252:255], a[52:55], v[164:167]
    v_cvt_pk_bf16_f32 v203, v122, v123
    v_mfma_f32_16x16x32_bf16 v[168:171], a[252:255], a[56:59], v[168:171]
    buffer_load_dwordx4 v15, s[32:35], s91 offen offset:2048  lds
    v_mfma_f32_16x16x32_bf16 v[172:175], a[252:255], a[60:63], v[172:175]
    v_fma_f32 v108, v108, s96, v54
    v_mfma_f32_16x16x32_bf16 v[160:163], a[224:227], a[64:67], v[160:163]
    v_fma_f32 v109, v109, s96, v54
    v_exp_f32 v108, v108
    v_mfma_f32_16x16x32_bf16 v[164:167], a[224:227], a[68:71], v[164:167]
    v_exp_f32 v109, v109
    v_fma_f32 v110, v110, s96, v54
    v_mfma_f32_16x16x32_bf16 v[168:171], a[224:227], a[72:75], v[168:171]
    s_waitcnt vmcnt(15)
    ds_read_b128 a[240:243], v30 offset:16384
    v_fma_f32 v111, v111, s96, v54
    v_mfma_f32_16x16x32_bf16 v[172:175], a[224:227], a[76:79], v[172:175]
    ds_read_b128 a[244:247], v31 offset:16384
    buffer_load_dwordx4 v16, s[32:35], s91 offen offset:3072  lds
    v_exp_f32 v110, v110
    v_mfma_f32_16x16x32_bf16 v[160:163], a[228:231], a[80:83], v[160:163]
    ds_read_b128 a[248:251], v30 offset:18432
    v_exp_f32 v111, v111
    v_mfma_f32_16x16x32_bf16 v[164:167], a[228:231], a[84:87], v[164:167]
    ds_read_b128 a[252:255], v31 offset:18432
    ds_write_b128 v35, v[200:203] offset:2048
    v_mfma_f32_16x16x32_bf16 v[64:67], v[76:79], v[200:203], 0
    v_fma_f32 v124, v124, s96, v54
    v_fma_f32 v125, v125, s96, v54
    v_mfma_f32_16x16x32_bf16 v[168:171], a[228:231], a[88:91], v[168:171]
    s_add_u32 m0, s98, 16384
    s_xor_b32 s91, s90, 65536
    v_mfma_f32_16x16x32_bf16 v[172:175], a[228:231], a[92:95], v[172:175]
    v_exp_f32 v124, v124
    v_exp_f32 v125, v125
    v_mfma_f32_16x16x32_bf16 v[160:163], a[232:235], a[96:99], v[160:163]
    v_fma_f32 v126, v126, s96, v54
    v_fma_f32 v127, v127, s96, v54
    v_exp_f32 v126, v126
    v_mfma_f32_16x16x32_bf16 v[164:167], a[232:235], a[100:103], v[164:167]
    v_cvt_pk_bf16_f32 v204, v108, v109
    v_cvt_pk_bf16_f32 v205, v110, v111
    v_mfma_f32_16x16x32_bf16 v[168:171], a[232:235], a[104:107], v[168:171]
    s_waitcnt lgkmcnt(1)
    buffer_load_dwordx4 v13, s[32:35], s91 offen  lds
    v_exp_f32 v127, v127
    v_mfma_f32_16x16x32_bf16 v[172:175], a[232:235], a[108:111], v[172:175]
    v_cvt_pk_bf16_f32 v206, v124, v125
    v_cvt_pk_bf16_f32 v207, v126, v127
    v_mfma_f32_16x16x32_bf16 v[160:163], a[236:239], a[112:115], v[160:163]
    s_cmp_eq_u32 s5, 4
    s_cbranch_scc1 L_ar4_4
L_ab4_4:
    v_mfma_f32_16x16x32_bf16 v[164:167], a[236:239], a[116:119], v[164:167]
    ds_write_b128 v35, v[204:207] offset:3072
    v_mfma_f32_16x16x32_bf16 v[68:71], v[76:79], v[204:207], 0
    v_mfma_f32_16x16x32_bf16 v[168:171], a[236:239], a[120:123], v[168:171]
    buffer_load_dwordx4 v14, s[32:35], s91 offen offset:1024  lds
    v_mfma_f32_16x16x32_bf16 v[172:175], a[236:239], a[124:127], v[172:175]
    v_mfma_f32_16x16x32_bf16 v[176:179], a[208:211], a[0:3], 0
    v_mfma_f32_16x16x32_bf16 v[180:183], a[208:211], a[4:7], 0
    v_mfma_f32_16x16x32_bf16 v[184:187], a[208:211], a[8:11], 0
    v_mfma_f32_16x16x32_bf16 v[188:191], a[208:211], a[12:15], 0
    s_waitcnt lgkmcnt(0)
    s_barrier
    ds_read_b128 v[96:99], v38 offset:512
    v_mfma_f32_16x16x32_bf16 v[176:179], a[212:215], a[16:19], v[176:179]
    s_waitcnt vmcnt(14)
    ds_read_b64_tr_b16 a[224:225], v21 offset:0
    v_mfma_f32_16x16x32_bf16 v[180:183], a[212:215], a[20:23], v[180:183]
    ds_read_b64_tr_b16 a[226:227], v21 offset:2048
    buffer_load_dwordx4 v15, s[32:35], s91 offen offset:2048  lds
    v_mfma_f32_16x16x32_bf16 v[184:187], a[212:215], a[24:27], v[184:187]
    ds_read_b64_tr_b16 a[228:229], v22 offset:0
    v_max3_f32 v46, v160, v161, v162
    v_mfma_f32_16x16x32_bf16 v[188:191], a[212:215], a[28:31], v[188:191]
    ds_read_b64_tr_b16 a[230:231], v22 offset:2048
    buffer_load_dwordx4 v16, s[32:35], s91 offen offset:3072  lds
    v_max_f32 v46, v46, v163
    v_mfma_f32_16x16x32_bf16 v[176:179], a[216:219], a[32:35], v[176:179]
    ds_read_b64_tr_b16 a[232:233], v23 offset:0
    v_max3_f32 v47, v164, v165, v166
    v_mfma_f32_16x16x32_bf16 v[180:183], a[216:219], a[36:39], v[180:183]
    ds_read_b64_tr_b16 a[234:235], v23 offset:2048
    v_max_f32 v47, v47, v167
    v_mfma_f32_16x16x32_bf16 v[184:187], a[216:219], a[40:43], v[184:187]
    ds_read_b64_tr_b16 a[236:237], v24 offset:0
    s_waitcnt lgkmcnt(7)
    v_fma_f32 v80, v96, s96, v51
    v_fma_f32 v81, v97, s96, v52
    v_mfma_f32_16x16x32_bf16 v[188:191], a[216:219], a[44:47], v[188:191]
    ds_read_b64_tr_b16 a[238:239], v24 offset:2048
    v_fma_f32 v82, v98, s96, v53
    v_fma_f32 v83, v99, s96, v54
    v_mfma_f32_16x16x32_bf16 v[176:179], a[220:223], a[48:51], v[176:179]
    s_add_u32 m0, s98, 0
    s_xor_b32 s91, s90, 81920
    v_max3_f32 v101, v80, v81, v82
    v_mfma_f32_16x16x32_bf16 v[180:183], a[220:223], a[52:55], v[180:183]
    v_max3_f32 v101, v101, v83, v83
    v_cmp_lt_f32 vcc, 0x41200000, v101
    s_cbranch_vccnz L_mv4_1
L_mb4_1:
    v_mfma_f32_16x16x32_bf16 v[184:187], a[220:223], a[56:59], v[184:187]
    v_fma_f32 v128, v128, s96, v51
    v_fma_f32 v129, v129, s96, v51
    v_exp_f32 v128, v128
    v_mfma_f32_16x16x32_bf16 v[188:191], a[220:223], a[60:63], v[188:191]
    s_waitcnt lgkmcnt(0)
    buffer_load_dwordx4 v13, s[32:35], s91 offen  lds
    v_max3_f32 v48, v168, v169, v170
    v_mfma_f32_16x16x32_bf16 v[176:179], a[192:195], a[64:67], v[176:179]
    v_exp_f32 v129, v129
    v_fma_f32 v130, v130, s96, v51
    v_fma_f32 v131, v131, s96, v51
    v_mfma_f32_16x16x32_bf16 v[180:183], a[192:195], a[68:71], v[180:183]
    v_exp_f32 v130, v130
    v_exp_f32 v131, v131
    v_mfma_f32_16x16x32_bf16 v[184:187], a[192:195], a[72:75], v[184:187]
    v_fma_f32 v144, v144, s96, v51
    v_fma_f32 v145, v145, s96, v51
    v_mfma_f32_16x16x32_bf16 v[188:191], a[192:195], a[76:79], v[188:191]
    buffer_load_dwordx4 v14, s[32:35], s91 offen offset:1024  lds
    v_exp_f32 v144, v144
    v_mfma_f32_16x16x32_bf16 v[176:179], a[196:199], a[80:83], v[176:179]
    v_exp_f32 v145, v145
    v_fma_f32 v146, v146, s96, v51
    v_fma_f32 v147, v147, s96, v51
    v_mfma_f32_16x16x32_bf16 v[180:183], a[196:199], a[84:87], v[180:183]
    v_exp_f32 v146, v146
    v_cvt_pk_bf16_f32 v104, v128, v129
    v_mfma_f32_16x16x32_bf16 v[184:187], a[196:199], a[88:91], v[184:187]
    s_waitcnt vmcnt(14)
    ds_read_b64_tr_b16 a[208:209], v21 offset:4096
    v_cvt_pk_bf16_f32 v105, v130, v131
    v_mfma_f32_16x16x32_bf16 v[188:191], a[196:199], a[92:95], v[188:191]
    ds_read_b64_tr_b16 a[210:211], v21 offset:6144
    buffer_load_dwordx4 v15, s[32:35], s91 offen offset:2048  lds
    v_exp_f32 v147, v147
    v_mfma_f32_16x16x32_bf16 v[176:179], a[200:203], a[96:99], v[176:179]
    ds_read_b64_tr_b16 a[212:213], v22 offset:4096
    v_cvt_pk_bf16_f32 v106, v144, v145
    v_max_f32 v48, v48, v171
    v_mfma_f32_16x16x32_bf16 v[180:183], a[200:203], a[100:103], v[180:183]
    ds_read_b64_tr_b16 a[214:215], v22 offset:6144
    v_cvt_pk_bf16_f32 v107, v146, v147
    v_mfma_f32_16x16x32_bf16 v[184:187], a[200:203], a[104:107], v[184:187]
    ds_read_b64_tr_b16 a[216:217], v23 offset:4096
    buffer_load_dwordx4 v16, s[32:35], s91 offen offset:3072  lds
    v_mfma_f32_16x16x32_bf16 v[188:191], a[200:203], a[108:111], v[188:191]
    ds_read_b64_tr_b16 a[218:219], v23 offset:6144
    v_max3_f32 v49, v172, v173, v174
    v_max_f32 v49, v49, v175
    v_mfma_f32_16x16x32_bf16 v[176:179], a[204:207], a[112:115], v[176:179]
    s_cmp_eq_u32 s5, 5
    s_cbranch_scc1 L_ar4_5
L_ab4_5:
    v_mfma_f32_16x16x32_bf16 v[180:183], a[204:207], a[116:119], v[180:183]
    ds_read_b64_tr_b16 a[220:221], v24 offset:4096
    ds_read_b64_tr_b16 a[222:223], v24 offset:6144
    ds_write_b128 v35, v[104:107] offset:16384
    v_mfma_f32_16x16x32_bf16 v[56:59], v[76:79], v[104:107], v[56:59]
    v_mfma_f32_16x16x32_bf16 v[184:187], a[204:207], a[120:123], v[184:187]
    s_add_u32 m0, s98, 4096
    s_xor_b32 s91, s90, 98304
    v_fma_f32 v132, v132, s96, v52
    v_mfma_f32_16x16x32_bf16 v[188:191], a[204:207], a[124:127], v[188:191]
    v_fma_f32 v133, v133, s96, v52
    v_exp_f32 v132, v132
    v_mfma_f32_16x16x32_bf16 v[192:195], a[176:179], a[0:3], 0
    v_exp_f32 v133, v133
    v_fma_f32 v134, v134, s96, v52
    v_mfma_f32_16x16x32_bf16 v[196:199], a[176:179], a[4:7], 0
    s_waitcnt lgkmcnt(1)
    buffer_load_dwordx4 v13, s[32:35], s91 offen  lds
    v_fma_f32 v135, v135, s96, v52
    v_mfma_f32_16x16x32_bf16 v[200:203], a[176:179], a[8:11], 0
    v_exp_f32 v134, v134
    v_exp_f32 v135, v135
    v_mfma_f32_16x16x32_bf16 v[204:207], a[176:179], a[12:15], 0
    v_max3_f32 v46, v46, v176, v177
    v_max3_f32 v46, v46, v178, v179
    v_fma_f32 v148, v148, s96, v52
    v_mfma_f32_16x16x32_bf16 v[192:195], a[180:183], a[16:19], v[192:195]
    v_max3_f32 v47, v47, v180, v181
    v_max3_f32 v47, v47, v182, v183
    v_fma_f32 v149, v149, s96, v52
    v_mfma_f32_16x16x32_bf16 v[196:199], a[180:183], a[20:23], v[196:199]
    v_max3_f32 v48, v48, v184, v185
    v_max3_f32 v48, v48, v186, v187
    v_exp_f32 v148, v148
    v_mfma_f32_16x16x32_bf16 v[200:203], a[180:183], a[24:27], v[200:203]
    v_max3_f32 v49, v49, v188, v189
    v_max3_f32 v49, v49, v190, v191
    v_mfma_f32_16x16x32_bf16 v[204:207], a[180:183], a[28:31], v[204:207]
    buffer_load_dwordx4 v14, s[32:35], s91 offen offset:1024  lds
    v_exp_f32 v149, v149
    v_mfma_f32_16x16x32_bf16 v[192:195], a[184:187], a[32:35], v[192:195]
    v_permlane32_swap_b32 v46, v48
    v_permlane32_swap_b32 v47, v49
    v_fma_f32 v150, v150, s96, v52
    v_mfma_f32_16x16x32_bf16 v[196:199], a[184:187], a[36:39], v[196:199]
    v_max_f32 v46, v46, v48
    v_max_f32 v47, v47, v49
    v_fma_f32 v151, v151, s96, v52
    v_mfma_f32_16x16x32_bf16 v[200:203], a[184:187], a[40:43], v[200:203]
    s_waitcnt vmcnt(14)
    ds_read_b64_tr_b16 a[192:193], v21 offset:8192
    buffer_load_dwordx4 v15, s[32:35], s91 offen offset:2048  lds
    v_mfma_f32_16x16x32_bf16 v[204:207], a[184:187], a[44:47], v[204:207]
    v_permlane16_swap_b32 v46, v47
    v_max_f32 v46, v46, v47
    v_exp_f32 v150, v150
    v_mfma_f32_16x16x32_bf16 v[192:195], a[188:191], a[48:51], v[192:195]
    ds_max_f32 v44, v46 offset:1024
    ds_read_b64_tr_b16 a[194:195], v21 offset:10240
    v_cvt_pk_bf16_f32 v108, v132, v133
    v_mfma_f32_16x16x32_bf16 v[196:199], a[188:191], a[52:55], v[196:199]
    ds_read_b64_tr_b16 a[196:197], v22 offset:8192
    ds_read_b64_tr_b16 a[198:199], v22 offset:10240
    v_cvt_pk_bf16_f32 v109, v134, v135
    v_mfma_f32_16x16x32_bf16 v[200:203], a[188:191], a[56:59], v[200:203]
    ds_read_b64_tr_b16 a[200:201], v23 offset:8192
    ds_read_b64_tr_b16 a[202:203], v23 offset:10240
    v_exp_f32 v151, v151
    v_mfma_f32_16x16x32_bf16 v[204:207], a[188:191], a[60:63], v[204:207]
    ds_read_b64_tr_b16 a[204:205], v24 offset:8192
    buffer_load_dwordx4 v16, s[32:35], s91 offen offset:3072  lds
    v_cvt_pk_bf16_f32 v110, v148, v149
    v_mfma_f32_16x16x32_bf16 v[192:195], a[160:163], a[64:67], v[192:195]
    ds_read_b64_tr_b16 a[206:207], v24 offset:10240
    v_cvt_pk_bf16_f32 v111, v150, v151
    v_mfma_f32_16x16x32_bf16 v[196:199], a[160:163], a[68:71], v[196:199]
    s_add_u32 m0, s98, 8192
    s_xor_b32 s91, s90, 114688
    v_mfma_f32_16x16x32_bf16 v[200:203], a[160:163], a[72:75], v[200:203]
    ds_write_b128 v35, v[108:111] offset:17408
    v_mfma_f32_16x16x32_bf16 v[60:63], v[76:79], v[108:111], v[60:63]
    v_mfma_f32_16x16x32_bf16 v[204:207], a[160:163], a[76:79], v[204:207]
    v_fma_f32 v136, v136, s96, v53
    v_mfma_f32_16x16x32_bf16 v[192:195], a[164:167], a[80:83], v[192:195]
    s_waitcnt lgkmcnt(1)
    buffer_load_dwordx4 v13, s[32:35], s91 offen  lds
    v_fma_f32 v137, v137, s96, v53
    v_mfma_f32_16x16x32_bf16 v[196:199], a[164:167], a[84:87], v[196:199]
    v_exp_f32 v136, v136
    v_exp_f32 v137, v137
    v_mfma_f32_16x16x32_bf16 v[200:203], a[164:167], a[88:91], v[200:203]
    v_fma_f32 v138, v138, s96, v53
    v_fma_f32 v139, v139, s96, v53
    v_mfma_f32_16x16x32_bf16 v[204:207], a[164:167], a[92:95], v[204:207]
    v_exp_f32 v138, v138
    v_exp_f32 v139, v139
    v_mfma_f32_16x16x32_bf16 v[192:195], a[168:171], a[96:99], v[192:195]
    buffer_load_dwordx4 v14, s[32:35], s91 offen offset:1024  lds
    v_fma_f32 v152, v152, s96, v53
    v_fma_f32 v153, v153, s96, v53
    v_mfma_f32_16x16x32_bf16 v[196:199], a[168:171], a[100:103], v[196:199]
    v_exp_f32 v152, v152
    v_exp_f32 v153, v153
    v_mfma_f32_16x16x32_bf16 v[200:203], a[168:171], a[104:107], v[200:203]
    v_fma_f32 v154, v154, s96, v53
    v_fma_f32 v155, v155, s96, v53
    v_mfma_f32_16x16x32_bf16 v[204:207], a[168:171], a[108:111], v[204:207]
    s_waitcnt vmcnt(14)
    ds_read_b64_tr_b16 a[176:177], v21 offset:12288
    v_exp_f32 v154, v154
    v_mfma_f32_16x16x32_bf16 v[192:195], a[172:175], a[112:115], v[192:195]
    s_cmp_eq_u32 s5, 6
    s_cbranch_scc1 L_ar4_6
L_ab4_6:
    v_cvt_pk_bf16_f32 v104, v136, v137
    v_mfma_f32_16x16x32_bf16 v[196:199], a[172:175], a[116:119], v[196:199]
    ds_read_b64_tr_b16 a[178:179], v21 offset:14336
    ds_read_b64_tr_b16 a[180:181], v22 offset:12288
    v_cvt_pk_bf16_f32 v105, v138, v139
    v_mfma_f32_16x16x32_bf16 v[200:203], a[172:175], a[120:123], v[200:203]
    ds_read_b64_tr_b16 a[182:183], v22 offset:14336
    buffer_load_dwordx4 v15, s[32:35], s91 offen offset:2048  lds
    v_mfma_f32_16x16x32_bf16 v[204:207], a[172:175], a[124:127], v[204:207]
    ds_read_b64_tr_b16 a[184:185], v23 offset:12288
    buffer_load_dwordx4 v16, s[32:35], s91 offen offset:3072  lds
    v_exp_f32 v155, v155
    v_mfma_f32_16x16x32_bf16 v[208:211], a[144:147], a[0:3], 0
    ds_read_b64_tr_b16 a[186:187], v23 offset:14336
    v_cvt_pk_bf16_f32 v106, v152, v153
    v_cvt_pk_bf16_f32 v107, v154, v155
    v_mfma_f32_16x16x32_bf16 v[212:215], a[144:147], a[4:7], 0
    ds_read_b64_tr_b16 a[188:189], v24 offset:12288
    v_mfma_f32_16x16x32_bf16 v[216:219], a[144:147], a[8:11], 0
    ds_read_b64_tr_b16 a[190:191], v24 offset:14336
    ds_write_b128 v35, v[104:107] offset:18432
    v_mfma_f32_16x16x32_bf16 v[64:67], v[76:79], v[104:107], v[64:67]
    v_mfma_f32_16x16x32_bf16 v[220:223], a[144:147], a[12:15], 0
    s_add_u32 m0, s98, 12288
    s_xor_b32 s91, s90, 131072
    v_mfma_f32_16x16x32_bf16 v[208:211], a[148:151], a[16:19], v[208:211]
    v_fma_f32 v140, v140, s96, v54
    v_fma_f32 v141, v141, s96, v54
    v_mfma_f32_16x16x32_bf16 v[212:215], a[148:151], a[20:23], v[212:215]
    v_exp_f32 v140, v140
    v_mfma_f32_16x16x32_bf16 v[216:219], a[148:151], a[24:27], v[216:219]
    s_waitcnt lgkmcnt(1)
    buffer_load_dwordx4 v13, s[32:35], s91 offen  lds
    v_exp_f32 v141, v141
    v_mfma_f32_16x16x32_bf16 v[220:223], a[148:151], a[28:31], v[220:223]
    v_fma_f32 v142, v142, s96, v54
    v_fma_f32 v143, v143, s96, v54
    v_exp_f32 v142, v142
    v_mfma_f32_16x16x32_bf16 v[208:211], a[152:155], a[32:35], v[208:211]
    v_exp_f32 v143, v143
    v_mfma_f32_16x16x32_bf16 v[212:215], a[152:155], a[36:39], v[212:215]
    v_fma_f32 v156, v156, s96, v54
    v_fma_f32 v157, v157, s96, v54
    v_exp_f32 v156, v156
    v_mfma_f32_16x16x32_bf16 v[216:219], a[152:155], a[40:43], v[216:219]
    buffer_load_dwordx4 v14, s[32:35], s91 offen offset:1024  lds
    v_exp_f32 v157, v157
    v_mfma_f32_16x16x32_bf16 v[220:223], a[152:155], a[44:47], v[220:223]
    v_fma_f32 v158, v158, s96, v54
    v_fma_f32 v159, v159, s96, v54
    v_mfma_f32_16x16x32_bf16 v[208:211], a[156:159], a[48:51], v[208:211]
    v_exp_f32 v158, v158
    v_cvt_pk_bf16_f32 v108, v140, v141
    v_cvt_pk_bf16_f32 v109, v142, v143
    v_mfma_f32_16x16x32_bf16 v[212:215], a[156:159], a[52:55], v[212:215]
    s_waitcnt vmcnt(14)
    ds_read_b64_tr_b16 a[160:161], v21 offset:16384
    v_exp_f32 v159, v159
    v_mfma_f32_16x16x32_bf16 v[216:219], a[156:159], a[56:59], v[216:219]
    ds_read_b64_tr_b16 a[162:163], v21 offset:18432
    buffer_load_dwordx4 v15, s[32:35], s91 offen offset:2048  lds
    v_mfma_f32_16x16x32_bf16 v[220:223], a[156:159], a[60:63], v[220:223]
    ds_read_b64_tr_b16 a[164:165], v22 offset:16384
    v_cvt_pk_bf16_f32 v110, v156, v157
    v_cvt_pk_bf16_f32 v111, v158, v159
    v_mfma_f32_16x16x32_bf16 v[208:211], a[240:243], a[64:67], v[208:211]
    ds_read_b128 a[0:3], v32 offset:0
    ds_read_b64_tr_b16 a[166:167], v22 offset:18432
    v_mfma_f32_16x16x32_bf16 v[212:215], a[240:243], a[68:71], v[212:215]
    ds_read_b64_tr_b16 a[168:169], v23 offset:16384
    buffer_load_dwordx4 v16, s[32:35], s91 offen offset:3072  lds
    v_mfma_f32_16x16x32_bf16 v[216:219], a[240:243], a[72:75], v[216:219]
    ds_read_b128 a[4:7], v32 offset:1024
    ds_read_b64_tr_b16 a[170:171], v23 offset:18432
    v_mfma_f32_16x16x32_bf16 v[220:223], a[240:243], a[76:79], v[220:223]
    ds_read_b64_tr_b16 a[172:173], v24 offset:16384
    v_max3_f32 v46, v192, v193, v194
    v_mfma_f32_16x16x32_bf16 v[208:211], a[244:247], a[80:83], v[208:211]
    ds_read_b128 a[8:11], v32 offset:2048
    ds_read_b64_tr_b16 a[174:175], v24 offset:18432
    v_mfma_f32_16x16x32_bf16 v[212:215], a[244:247], a[84:87], v[212:215]
    s_add_u32 m0, s98, 16384
    s_xor_b32 s91, s90, 147456
    v_mfma_f32_16x16x32_bf16 v[216:219], a[244:247], a[88:91], v[216:219]
    ds_read_b128 a[12:15], v32 offset:3072
    ds_write_b128 v35, v[108:111] offset:19456
    v_mfma_f32_16x16x32_bf16 v[68:71], v[76:79], v[108:111], v[68:71]
    v_mfma_f32_16x16x32_bf16 v[220:223], a[244:247], a[92:95], v[220:223]
    v_max_f32 v46, v46, v195
    v_max3_f32 v47, v196, v197, v198
    v_mfma_f32_16x16x32_bf16 v[208:211], a[248:251], a[96:99], v[208:211]
    s_waitcnt lgkmcnt(2)
    buffer_load_dwordx4 v13, s[32:35], s91 offen  lds
    v_mfma_f32_16x16x32_bf16 v[212:215], a[248:251], a[100:103], v[212:215]
    s_waitcnt lgkmcnt(0)
    s_barrier
    ds_read_b128 v[4:7], v38 offset:1024
    v_mfma_f32_16x16x32_bf16 v[216:219], a[248:251], a[104:107], v[216:219]
    v_max_f32 v47, v47, v199
    v_max3_f32 v48, v200, v201, v202
    v_mfma_f32_16x16x32_bf16 v[220:223], a[248:251], a[108:111], v[220:223]
    v_max_f32 v48, v48, v203
    v_max3_f32 v49, v204, v205, v206
    v_mfma_f32_16x16x32_bf16 v[208:211], a[252:255], a[112:115], v[208:211]
    s_cmp_eq_u32 s5, 7
    s_cbranch_scc1 L_ar4_7
L_ab4_7:
    v_mfma_f32_16x16x32_bf16 v[212:215], a[252:255], a[116:119], v[212:215]
    buffer_load_dwordx4 v14, s[32:35], s91 offen offset:1024  lds
    v_max_f32 v49, v49, v207
    v_mfma_f32_16x16x32_bf16 v[216:219], a[252:255], a[120:123], v[216:219]
    v_mfma_f32_16x16x32_bf16 v[220:223], a[252:255], a[124:127], v[220:223]
    v_mfma_f32_16x16x32_bf16 v[96:99], a[224:227], a[0:3], 0
    ds_read_b128 a[20:23], v32 offset:4096
    buffer_load_dwordx4 v15, s[32:35], s91 offen offset:2048  lds
    s_waitcnt lgkmcnt(1)
    v_fma_f32 v84, v4, s96, v51
    v_mfma_f32_16x16x32_bf16 v[100:103], a[224:227], a[4:7], 0
    s_waitcnt vmcnt(15)
    ds_read_b64_tr_b16 a[240:241], v21 offset:0
    v_fma_f32 v85, v5, s96, v52
    v_mfma_f32_16x16x32_bf16 v[104:107], a[224:227], a[8:11], 0
    ds_read_b128 a[24:27], v32 offset:5120
    ds_read_b64_tr_b16 a[242:243], v21 offset:2048
    ds_read_b64_tr_b16 a[244:245], v22 offset:0
    v_mfma_f32_16x16x32_bf16 v[108:111], a[224:227], a[12:15], 0
    ds_read_b64_tr_b16 a[246:247], v22 offset:2048
    v_max3_f32 v46, v46, v208, v209
    v_max3_f32 v46, v46, v210, v211
    v_mfma_f32_16x16x32_bf16 v[112:115], a[228:231], a[0:3], 0
    ds_read_b128 a[28:31], v32 offset:6144
    v_max3_f32 v47, v47, v212, v213
    v_max3_f32 v47, v47, v214, v215
    v_mfma_f32_16x16x32_bf16 v[116:119], a[228:231], a[4:7], 0
    ds_read_b64_tr_b16 a[248:249], v23 offset:0
    v_max3_f32 v48, v48, v216, v217
    v_max3_f32 v48, v48, v218, v219
    v_mfma_f32_16x16x32_bf16 v[120:123], a[228:231], a[8:11], 0
    ds_read_b128 a[32:35], v32 offset:7168
    v_max3_f32 v49, v49, v220, v221
    v_max3_f32 v49, v49, v222, v223
    v_mfma_f32_16x16x32_bf16 v[124:127], a[228:231], a[12:15], 0
    ds_read_b64_tr_b16 a[250:251], v23 offset:2048
    ds_read_b64_tr_b16 a[252:253], v24 offset:0
    ds_read_b64_tr_b16 a[254:255], v24 offset:2048
    v_mfma_f32_16x16x32_bf16 v[128:131], a[232:235], a[0:3], 0
    buffer_load_dwordx4 v16, s[32:35], s91 offen offset:3072  lds
    v_permlane32_swap_b32 v46, v48
    v_permlane32_swap_b32 v47, v49
    v_mfma_f32_16x16x32_bf16 v[132:135], a[232:235], a[4:7], 0
    v_max_f32 v46, v46, v48
    v_max_f32 v47, v47, v49
    v_mfma_f32_16x16x32_bf16 v[136:139], a[232:235], a[8:11], 0
    s_add_u32 m0, s98, 0
    s_xor_b32 s91, s90, 163840
    v_fma_f32 v86, v6, s96, v53
    v_mfma_f32_16x16x32_bf16 v[140:143], a[232:235], a[12:15], 0
    v_permlane16_swap_b32 v46, v47
    v_max_f32 v46, v46, v47
    v_fma_f32 v87, v7, s96, v54
    v_mfma_f32_16x16x32_bf16 v[144:147], a[236:239], a[0:3], 0
    ds_max_f32 v44, v46 offset:1536
    v_max3_f32 v9, v84, v85, v86
    v_max3_f32 v9, v9, v87, v87
    v_mfma_f32_16x16x32_bf16 v[148:151], a[236:239], a[4:7], 0
    v_cmp_lt_f32 vcc, 0x41200000, v9
    s_cbranch_vccnz L_mv4_2
L_mb4_2:
    v_mfma_f32_16x16x32_bf16 v[152:155], a[236:239], a[8:11], 0
    s_waitcnt lgkmcnt(1)
    buffer_load_dwordx4 v13, s[32:35], s91 offen  lds
    v_fma_f32 v160, v160, s96, v51
    v_mfma_f32_16x16x32_bf16 v[156:159], a[236:239], a[12:15], 0
    v_fma_f32 v161, v161, s96, v51
    v_exp_f32 v160, v160
    v_mfma_f32_16x16x32_bf16 v[96:99], a[208:211], a[20:23], v[96:99]
    ds_read_b128 a[0:3], v32 offset:8192
    v_exp_f32 v161, v161
    v_mfma_f32_16x16x32_bf16 v[100:103], a[208:211], a[24:27], v[100:103]
    v_fma_f32 v162, v162, s96, v51
    v_fma_f32 v163, v163, s96, v51
    v_mfma_f32_16x16x32_bf16 v[104:107], a[208:211], a[28:31], v[104:107]
    ds_read_b128 a[4:7], v32 offset:9216
    v_exp_f32 v162, v162
    v_mfma_f32_16x16x32_bf16 v[108:111], a[208:211], a[32:35], v[108:111]
    v_exp_f32 v163, v163
    v_fma_f32 v176, v176, s96, v51
    v_mfma_f32_16x16x32_bf16 v[112:115], a[212:215], a[20:23], v[112:115]
    ds_read_b128 a[8:11], v32 offset:10240
    buffer_load_dwordx4 v14, s[32:35], s91 offen offset:1024  lds
    v_fma_f32 v177, v177, s96, v51
    v_mfma_f32_16x16x32_bf16 v[116:119], a[212:215], a[24:27], v[116:119]
    v_exp_f32 v176, v176
    v_mfma_f32_16x16x32_bf16 v[120:123], a[212:215], a[28:31], v[120:123]
    ds_read_b128 a[12:15], v32 offset:11264
    v_exp_f32 v177, v177
    v_mfma_f32_16x16x32_bf16 v[124:127], a[212:215], a[32:35], v[124:127]
    v_fma_f32 v178, v178, s96, v51
    v_fma_f32 v179, v179, s96, v51
    v_mfma_f32_16x16x32_bf16 v[128:131], a[216:219], a[20:23], v[128:131]
    v_exp_f32 v178, v178
    v_cvt_pk_bf16_f32 v4, v160, v161
    v_cvt_pk_bf16_f32 v5, v162, v163
    v_mfma_f32_16x16x32_bf16 v[132:135], a[216:219], a[24:27], v[132:135]
    v_exp_f32 v179, v179
    v_mfma_f32_16x16x32_bf16 v[136:139], a[216:219], a[28:31], v[136:139]
    v_cvt_pk_bf16_f32 v6, v176, v177
    v_cvt_pk_bf16_f32 v7, v178, v179
    v_mfma_f32_16x16x32_bf16 v[140:143], a[216:219], a[32:35], v[140:143]
    buffer_load_dwordx4 v15, s[32:35], s91 offen offset:2048  lds
    v_mfma_f32_16x16x32_bf16 v[144:147], a[220:223], a[20:23], v[144:147]
    v_mfma_f32_16x16x32_bf16 v[148:151], a[220:223], a[24:27], v[148:151]
    v_fma_f32 v164, v164, s96, v52
    v_mfma_f32_16x16x32_bf16 v[152:155], a[220:223], a[28:31], v[152:155]
    v_fma_f32 v165, v165, s96, v52
    v_exp_f32 v164, v164
    v_mfma_f32_16x16x32_bf16 v[156:159], a[220:223], a[32:35], v[156:159]
    v_exp_f32 v165, v165
    v_fma_f32 v166, v166, s96, v52
    s_waitcnt lgkmcnt(0)
    v_mfma_f32_16x16x32_bf16 v[96:99], a[192:195], a[0:3], v[96:99]
    ds_read_b128 a[20:23], v32 offset:12288
    v_fma_f32 v167, v167, s96, v52
    v_mfma_f32_16x16x32_bf16 v[100:103], a[192:195], a[4:7], v[100:103]
    s_waitcnt vmcnt(15)
    ds_read_b64_tr_b16 a[224:225], v21 offset:4096
    v_exp_f32 v166, v166
    v_mfma_f32_16x16x32_bf16 v[104:107], a[192:195], a[8:11], v[104:107]
    ds_read_b128 a[24:27], v32 offset:13312
    ds_read_b64_tr_b16 a[226:227], v21 offset:6144
    v_mfma_f32_16x16x32_bf16 v[108:111], a[192:195], a[12:15], v[108:111]
    ds_read_b64_tr_b16 a[228:229], v22 offset:4096
    ds_read_b64_tr_b16 a[230:231], v22 offset:6144
    v_exp_f32 v167, v167
    v_mfma_f32_16x16x32_bf16 v[112:115], a[196:199], a[0:3], v[112:115]
    ds_read_b128 a[28:31], v32 offset:14336
    ds_read_b64_tr_b16 a[232:233], v23 offset:4096
    v_mfma_f32_16x16x32_bf16 v[116:119], a[196:199], a[4:7], v[116:119]
    ds_read_b64_tr_b16 a[234:235], v23 offset:6144
    buffer_load_dwordx4 v16, s[32:35], s91 offen offset:3072  lds
    v_fma_f32 v180, v180, s96, v52
    v_mfma_f32_16x16x32_bf16 v[120:123], a[196:199], a[8:11], v[120:123]
    ds_read_b128 a[32:35], v32 offset:15360
    ds_read_b64_tr_b16 a[236:237], v24 offset:4096
    v_mfma_f32_16x16x32_bf16 v[124:127], a[196:199], a[12:15], v[124:127]
    ds_read_b64_tr_b16 a[238:239], v24 offset:6144
    ds_write_b128 v35, v[4:7] offset:32768
    v_mfma_f32_16x16x32_bf16 v[56:59], v[76:79], v[4:7], v[56:59]
    v_fma_f32 v181, v181, s96, v52
    v_mfma_f32_16x16x32_bf16 v[128:131], a[200:203], a[0:3], v[128:131]
    s_add_u32 m0, s98, 4096
    s_xor_b32 s91, s90, 180224
    v_exp_f32 v180, v180
    v_mfma_f32_16x16x32_bf16 v[132:135], a[200:203], a[4:7], v[132:135]
    v_exp_f32 v181, v181
    v_mfma_f32_16x16x32_bf16 v[136:139], a[200:203], a[8:11], v[136:139]
    v_fma_f32 v182, v182, s96, v52
    v_fma_f32 v183, v183, s96, v52
    v_exp_f32 v182, v182
    v_mfma_f32_16x16x32_bf16 v[140:143], a[200:203], a[12:15], v[140:143]
    v_cvt_pk_bf16_f32 v8, v164, v165
    v_cvt_pk_bf16_f32 v9, v166, v167
    v_mfma_f32_16x16x32_bf16 v[144:147], a[204:207], a[0:3], v[144:147]
    v_exp_f32 v183, v183
    v_cvt_pk_bf16_f32 v10, v180, v181
    v_mfma_f32_16x16x32_bf16 v[148:151], a[204:207], a[4:7], v[148:151]
    v_cvt_pk_bf16_f32 v11, v182, v183
    v_mfma_f32_16x16x32_bf16 v[152:155], a[204:207], a[8:11], v[152:155]
    s_waitcnt lgkmcnt(1)
    buffer_load_dwordx4 v13, s[32:35], s91 offen  lds
    v_mfma_f32_16x16x32_bf16 v[156:159], a[204:207], a[12:15], v[156:159]
    v_mfma_f32_16x16x32_bf16 v[96:99], a[176:179], a[20:23], v[96:99]
    ds_read_b128 a[0:3], v32 offset:16384
    v_mfma_f32_16x16x32_bf16 v[100:103], a[176:179], a[24:27], v[100:103]
    v_fma_f32 v168, v168, s96, v53
    v_fma_f32 v169, v169, s96, v53
    v_mfma_f32_16x16x32_bf16 v[104:107], a[176:179], a[28:31], v[104:107]
    ds_read_b128 a[4:7], v32 offset:17408
    v_exp_f32 v168, v168
    v_mfma_f32_16x16x32_bf16 v[108:111], a[176:179], a[32:35], v[108:111]
    v_exp_f32 v169, v169
    v_fma_f32 v170, v170, s96, v53
    v_mfma_f32_16x16x32_bf16 v[112:115], a[180:183], a[20:23], v[112:115]
    ds_read_b128 a[8:11], v32 offset:18432
    buffer_load_dwordx4 v14, s[32:35], s91 offen offset:1024  lds
    v_fma_f32 v171, v171, s96, v53
    v_mfma_f32_16x16x32_bf16 v[116:119], a[180:183], a[24:27], v[116:119]
    v_exp_f32 v170, v170
    v_mfma_f32_16x16x32_bf16 v[120:123], a[180:183], a[28:31], v[120:123]
    ds_read_b128 a[12:15], v32 offset:19456
    ds_write_b128 v35, v[8:11] offset:33792
    v_mfma_f32_16x16x32_bf16 v[60:63], v[76:79], v[8:11], v[60:63]
    v_exp_f32 v171, v171
    v_mfma_f32_16x16x32_bf16 v[124:127], a[180:183], a[32:35], v[124:127]
    v_fma_f32 v184, v184, s96, v53
    v_fma_f32 v185, v185, s96, v53
    v_mfma_f32_16x16x32_bf16 v[128:131], a[184:187], a[20:23], v[128:131]
    v_exp_f32 v184, v184
    v_exp_f32 v185, v185
    v_mfma_f32_16x16x32_bf16 v[132:135], a[184:187], a[24:27], v[132:135]
    v_fma_f32 v186, v186, s96, v53
    v_fma_f32 v187, v187, s96, v53
    v_mfma_f32_16x16x32_bf16 v[136:139], a[184:187], a[28:31], v[136:139]
    v_exp_f32 v186, v186
    v_cvt_pk_bf16_f32 v4, v168, v169
    v_mfma_f32_16x16x32_bf16 v[140:143], a[184:187], a[32:35], v[140:143]
    buffer_load_dwordx4 v15, s[32:35], s91 offen offset:2048  lds
    v_cvt_pk_bf16_f32 v5, v170, v171
    v_mfma_f32_16x16x32_bf16 v[144:147], a[188:191], a[20:23], v[144:147]
    v_exp_f32 v187, v187
    v_cvt_pk_bf16_f32 v6, v184, v185
    v_cvt_pk_bf16_f32 v7, v186, v187
    v_mfma_f32_16x16x32_bf16 v[148:151], a[188:191], a[24:27], v[148:151]
    v_mfma_f32_16x16x32_bf16 v[152:155], a[188:191], a[28:31], v[152:155]
    v_mfma_f32_16x16x32_bf16 v[156:159], a[188:191], a[32:35], v[156:159]
    v_fma_f32 v172, v172, s96, v54
    s_bitcmp1_b32 s4, 1
    s_cbranch_scc1 L_rs4_1
L_rb4_1:
    s_waitcnt lgkmcnt(1)
    v_mfma_f32_16x16x32_bf16 v[96:99], a[160:163], a[0:3], v[96:99]
    ds_read_b128 a[20:23], v32 offset:20480
    v_fma_f32 v173, v173, s96, v54
    v_mfma_f32_16x16x32_bf16 v[100:103], a[160:163], a[4:7], v[100:103]
    s_waitcnt vmcnt(15)
    ds_read_b64_tr_b16 a[208:209], v21 offset:8192
    v_exp_f32 v172, v172
    v_mfma_f32_16x16x32_bf16 v[104:107], a[160:163], a[8:11], v[104:107]
    ds_read_b128 a[24:27], v32 offset:21504
    ds_read_b64_tr_b16 a[210:211], v21 offset:10240
    v_mfma_f32_16x16x32_bf16 v[108:111], a[160:163], a[12:15], v[108:111]
    ds_read_b64_tr_b16 a[212:213], v22 offset:8192
    ds_read_b64_tr_b16 a[214:215], v22 offset:10240
    v_exp_f32 v173, v173
    v_mfma_f32_16x16x32_bf16 v[112:115], a[164:167], a[0:3], v[112:115]
    ds_read_b128 a[28:31], v32 offset:22528
    ds_read_b64_tr_b16 a[216:217], v23 offset:8192
    v_mfma_f32_16x16x32_bf16 v[116:119], a[164:167], a[4:7], v[116:119]
    ds_read_b64_tr_b16 a[218:219], v23 offset:10240
    buffer_load_dwordx4 v16, s[32:35], s91 offen offset:3072  lds
    v_fma_f32 v174, v174, s96, v54
    v_mfma_f32_16x16x32_bf16 v[120:123], a[164:167], a[8:11], v[120:123]
    ds_read_b128 a[32:35], v32 offset:23552
    ds_read_b64_tr_b16 a[220:221], v24 offset:8192
    v_mfma_f32_16x16x32_bf16 v[124:127], a[164:167], a[12:15], v[124:127]
    ds_read_b64_tr_b16 a[222:223], v24 offset:10240
    ds_write_b128 v35, v[4:7] offset:34816
    v_mfma_f32_16x16x32_bf16 v[64:67], v[76:79], v[4:7], v[64:67]
    v_fma_f32 v175, v175, s96, v54
    v_mfma_f32_16x16x32_bf16 v[128:131], a[168:171], a[0:3], v[128:131]
    s_add_u32 m0, s98, 8192
    s_xor_b32 s91, s90, 196608
    v_exp_f32 v174, v174
    v_mfma_f32_16x16x32_bf16 v[132:135], a[168:171], a[4:7], v[132:135]
    v_exp_f32 v175, v175
    v_mfma_f32_16x16x32_bf16 v[136:139], a[168:171], a[8:11], v[136:139]
    v_fma_f32 v188, v188, s96, v54
    v_fma_f32 v189, v189, s96, v54
    v_exp_f32 v188, v188
    v_mfma_f32_16x16x32_bf16 v[140:143], a[168:171], a[12:15], v[140:143]
    v_exp_f32 v189, v189
    v_mfma_f32_16x16x32_bf16 v[144:147], a[172:175], a[0:3], v[144:147]
    s_waitcnt lgkmcnt(1)
    buffer_load_dwordx4 v13, s[32:35], s91 offen  lds
    v_fma_f32 v190, v190, s96, v54
    v_mfma_f32_16x16x32_bf16 v[148:151], a[172:175], a[4:7], v[148:151]
    v_fma_f32 v191, v191, s96, v54
    v_exp_f32 v190, v190
    v_mfma_f32_16x16x32_bf16 v[152:155], a[172:175], a[8:11], v[152:155]
    v_cvt_pk_bf16_f32 v8, v172, v173
    v_cvt_pk_bf16_f32 v9, v174, v175
    v_mfma_f32_16x16x32_bf16 v[156:159], a[172:175], a[12:15], v[156:159]
    v_exp_f32 v191, v191
    v_cvt_pk_bf16_f32 v10, v188, v189
    v_mfma_f32_16x16x32_bf16 v[96:99], a[240:243], a[20:23], v[96:99]
    ds_read_b128 a[0:3], v32 offset:24576
    buffer_load_dwordx4 v14, s[32:35], s91 offen offset:1024  lds
    v_cvt_pk_bf16_f32 v11, v190, v191
    v_mfma_f32_16x16x32_bf16 v[100:103], a[240:243], a[24:27], v[100:103]
    v_mfma_f32_16x16x32_bf16 v[104:107], a[240:243], a[28:31], v[104:107]
    ds_read_b128 a[4:7], v32 offset:25600
    ds_write_b128 v35, v[8:11] offset:35840
    v_mfma_f32_16x16x32_bf16 v[68:71], v[76:79], v[8:11], v[68:71]
    v_mfma_f32_16x16x32_bf16 v[108:111], a[240:243], a[32:35], v[108:111]
    v_mfma_f32_16x16x32_bf16 v[112:115], a[244:247], a[20:23], v[112:115]
    ds_read_b128 a[8:11], v32 offset:26624
    buffer_load_dwordx4 v15, s[32:35], s91 offen offset:2048  lds
    v_mfma_f32_16x16x32_bf16 v[116:119], a[244:247], a[24:27], v[116:119]
    s_waitcnt vmcnt(15)
    ds_read_b64_tr_b16 a[192:193], v21 offset:12288
    v_mfma_f32_16x16x32_bf16 v[120:123], a[244:247], a[28:31], v[120:123]
    ds_read_b128 a[12:15], v32 offset:27648
    ds_read_b64_tr_b16 a[194:195], v21 offset:14336
    v_mfma_f32_16x16x32_bf16 v[124:127], a[244:247], a[32:35], v[124:127]
    ds_read_b64_tr_b16 a[196:197], v22 offset:12288
    v_mfma_f32_16x16x32_bf16 v[128:131], a[248:251], a[20:23], v[128:131]
    s_waitcnt lgkmcnt(5)
    s_barrier
    ds_read_b128 v[4:7], v38 offset:1536
    v_mfma_f32_16x16x32_bf16 v[132:135], a[248:251], a[24:27], v[132:135]
    ds_read_b64_tr_b16 a[198:199], v22 offset:14336
    ds_read_b64_tr_b16 a[200:201], v23 offset:12288
    v_mfma_f32_16x16x32_bf16 v[136:139], a[248:251], a[28:31], v[136:139]
    ds_read_b64_tr_b16 a[202:203], v23 offset:14336
    buffer_load_dwordx4 v16, s[32:35], s91 offen offset:3072  lds
    v_mfma_f32_16x16x32_bf16 v[140:143], a[248:251], a[32:35], v[140:143]
    ds_read_b64_tr_b16 a[204:205], v24 offset:12288
    v_mfma_f32_16x16x32_bf16 v[144:147], a[252:255], a[20:23], v[144:147]
    ds_read_b64_tr_b16 a[206:207], v24 offset:14336
    v_mfma_f32_16x16x32_bf16 v[148:151], a[252:255], a[24:27], v[148:151]
    s_add_u32 m0, s98, 12288
    s_xor_b32 s91, s90, 212992
    v_mfma_f32_16x16x32_bf16 v[152:155], a[252:255], a[28:31], v[152:155]
    v_mfma_f32_16x16x32_bf16 v[156:159], a[252:255], a[32:35], v[156:159]
    s_waitcnt lgkmcnt(5)
    v_fma_f32 v88, v4, s96, v51
    v_fma_f32 v89, v5, s96, v52
    v_fma_f32 v90, v6, s96, v53
    v_mfma_f32_16x16x32_bf16 v[96:99], a[224:227], a[0:3], v[96:99]
    ds_read_b128 a[20:23], v32 offset:28672
    v_fma_f32 v91, v7, s96, v54
    v_max3_f32 v9, v88, v89, v90
    v_mfma_f32_16x16x32_bf16 v[100:103], a[224:227], a[4:7], v[100:103]
    s_waitcnt lgkmcnt(1)
    buffer_load_dwordx4 v13, s[32:35], s91 offen  lds
    v_max3_f32 v9, v9, v91, v91
    v_mfma_f32_16x16x32_bf16 v[104:107], a[224:227], a[8:11], v[104:107]
    ds_read_b128 a[24:27], v32 offset:29696
    v_cmp_lt_f32 vcc, 0x41200000, v9
    s_cbranch_vccnz L_mv4_3
L_mb4_3:
    v_mfma_f32_16x16x32_bf16 v[108:111], a[224:227], a[12:15], v[108:111]
    v_fma_f32 v192, v192, s96, v51
    v_fma_f32 v193, v193, s96, v51
    v_mfma_f32_16x16x32_bf16 v[112:115], a[228:231], a[0:3], v[112:115]
    ds_read_b128 a[28:31], v32 offset:30720
    v_exp_f32 v192, v192
    v_mfma_f32_16x16x32_bf16 v[116:119], a[228:231], a[4:7], v[116:119]
    buffer_load_dwordx4 v14, s[32:35], s91 offen offset:1024  lds
    v_exp_f32 v193, v193
    v_mfma_f32_16x16x32_bf16 v[120:123], a[228:231], a[8:11], v[120:123]
    ds_read_b128 a[32:35], v32 offset:31744
    v_fma_f32 v194, v194, s96, v51
    v_fma_f32 v195, v195, s96, v51
    v_mfma_f32_16x16x32_bf16 v[124:127], a[228:231], a[12:15], v[124:127]
    v_exp_f32 v194, v194
    v_mfma_f32_16x16x32_bf16 v[128:131], a[232:235], a[0:3], v[128:131]
    v_exp_f32 v195, v195
    v_fma_f32 v208, v208, s96, v51
    v_fma_f32 v209, v209, s96, v51
    v_mfma_f32_16x16x32_bf16 v[132:135], a[232:235], a[4:7], v[132:135]
    buffer_load_dwordx4 v15, s[32:35], s91 offen offset:2048  lds
    v_exp_f32 v208, v208
    v_mfma_f32_16x16x32_bf16 v[136:139], a[232:235], a[8:11], v[136:139]
    s_waitcnt vmcnt(15)
    ds_read_b64_tr_b16 a[240:241], v21 offset:16384
    v_mfma_f32_16x16x32_bf16 v[140:143], a[232:235], a[12:15], v[140:143]
    ds_read_b64_tr_b16 a[242:243], v21 offset:18432
    v_exp_f32 v209, v209
    v_mfma_f32_16x16x32_bf16 v[144:147], a[236:239], a[0:3], v[144:147]
    ds_read_b64_tr_b16 a[244:245], v22 offset:16384
    v_fma_f32 v210, v210, s96, v51
    v_fma_f32 v211, v211, s96, v51
    v_mfma_f32_16x16x32_bf16 v[148:151], a[236:239], a[4:7], v[148:151]
    ds_read_b64_tr_b16 a[246:247], v22 offset:18432
    buffer_load_dwordx4 v16, s[32:35], s91 offen offset:3072  lds
    v_mfma_f32_16x16x32_bf16 v[152:155], a[236:239], a[8:11], v[152:155]
    ds_read_b64_tr_b16 a[248:249], v23 offset:16384
    v_exp_f32 v210, v210
    v_cvt_pk_bf16_f32 v4, v192, v193
    v_mfma_f32_16x16x32_bf16 v[156:159], a[236:239], a[12:15], v[156:159]
    ds_read_b64_tr_b16 a[250:251], v23 offset:18432
    v_cvt_pk_bf16_f32 v5, v194, v195
    s_waitcnt lgkmcnt(6)
    v_mfma_f32_16x16x32_bf16 v[96:99], a[208:211], a[20:23], v[96:99]
    ds_read_b128 a[0:3], v32 offset:32768
    ds_read_b64_tr_b16 a[252:253], v24 offset:16384
    v_exp_f32 v211, v211
    v_mfma_f32_16x16x32_bf16 v[100:103], a[208:211], a[24:27], v[100:103]
    ds_read_b64_tr_b16 a[254:255], v24 offset:18432
    v_cvt_pk_bf16_f32 v6, v208, v209
    v_mfma_f32_16x16x32_bf16 v[104:107], a[208:211], a[28:31], v[104:107]
    ds_read_b128 a[4:7], v32 offset:33792
    v_cvt_pk_bf16_f32 v7, v210, v211
    v_mfma_f32_16x16x32_bf16 v[108:111], a[208:211], a[32:35], v[108:111]
    s_add_u32 m0, s98, 16384
    s_xor_b32 s91, s90, 229376
    v_mfma_f32_16x16x32_bf16 v[112:115], a[212:215], a[20:23], v[112:115]
    ds_read_b128 a[8:11], v32 offset:34816
    v_mfma_f32_16x16x32_bf16 v[116:119], a[212:215], a[24:27], v[116:119]
    v_mfma_f32_16x16x32_bf16 v[120:123], a[212:215], a[28:31], v[120:123]
    ds_read_b128 a[12:15], v32 offset:35840
    ds_write_b128 v35, v[4:7] offset:49152
    v_mfma_f32_16x16x32_bf16 v[56:59], v[76:79], v[4:7], v[56:59]
    v_fma_f32 v196, v196, s96, v52
    v_mfma_f32_16x16x32_bf16 v[124:127], a[212:215], a[32:35], v[124:127]
    s_waitcnt lgkmcnt(4)
    buffer_load_dwordx4 v13, s[32:35], s91 offen  lds
    v_fma_f32 v197, v197, s96, v52
    v_mfma_f32_16x16x32_bf16 v[128:131], a[216:219], a[20:23], v[128:131]
    v_exp_f32 v196, v196
    v_exp_f32 v197, v197
    v_mfma_f32_16x16x32_bf16 v[132:135], a[216:219], a[24:27], v[132:135]
    v_fma_f32 v198, v198, s96, v52
    v_fma_f32 v199, v199, s96, v52
    v_mfma_f32_16x16x32_bf16 v[136:139], a[216:219], a[28:31], v[136:139]
    buffer_load_dwordx4 v14, s[32:35], s91 offen offset:1024  lds
    v_exp_f32 v198, v198
    v_mfma_f32_16x16x32_bf16 v[140:143], a[216:219], a[32:35], v[140:143]
    v_exp_f32 v199, v199
    v_fma_f32 v212, v212, s96, v52
    v_mfma_f32_16x16x32_bf16 v[144:147], a[220:223], a[20:23], v[144:147]
    v_fma_f32 v213, v213, s96, v52
    v_exp_f32 v212, v212
    v_mfma_f32_16x16x32_bf16 v[148:151], a[220:223], a[24:27], v[148:151]
    v_exp_f32 v213, v213
    v_mfma_f32_16x16x32_bf16 v[152:155], a[220:223], a[28:31], v[152:155]
    v_fma_f32 v214, v214, s96, v52
    v_fma_f32 v215, v215, s96, v52
    v_exp_f32 v214, v214
    v_mfma_f32_16x16x32_bf16 v[156:159], a[220:223], a[32:35], v[156:159]
    buffer_load_dwordx4 v15, s[32:35], s91 offen offset:2048  lds
    v_cvt_pk_bf16_f32 v8, v196, v197
    s_bitcmp1_b32 s4, 2
    s_cbranch_scc1 L_rs4_2
L_rb4_2:
    v_mfma_f32_16x16x32_bf16 v[96:99], a[192:195], a[0:3], v[96:99]
    ds_read_b128 a[20:23], v32 offset:36864
    v_cvt_pk_bf16_f32 v9, v198, v199
    s_waitcnt lgkmcnt(2)
    v_mfma_f32_16x16x32_bf16 v[100:103], a[192:195], a[4:7], v[100:103]
    s_waitcnt vmcnt(15)
    ds_read_b64_tr_b16 a[224:225], v21 offset:0
    v_exp_f32 v215, v215
    v_mfma_f32_16x16x32_bf16 v[104:107], a[192:195], a[8:11], v[104:107]
    ds_read_b128 a[24:27], v32 offset:37888
    ds_read_b64_tr_b16 a[226:227], v21 offset:2048
    v_cvt_pk_bf16_f32 v10, v212, v213
    v_mfma_f32_16x16x32_bf16 v[108:111], a[192:195], a[12:15], v[108:111]
    ds_read_b64_tr_b16 a[228:229], v22 offset:0
    ds_read_b64_tr_b16 a[230:231], v22 offset:2048
    v_cvt_pk_bf16_f32 v11, v214, v215
    v_mfma_f32_16x16x32_bf16 v[112:115], a[196:199], a[0:3], v[112:115]
    ds_read_b128 a[28:31], v32 offset:38912
    ds_read_b64_tr_b16 a[232:233], v23 offset:0
    v_mfma_f32_16x16x32_bf16 v[116:119], a[196:199], a[4:7], v[116:119]
    ds_read_b64_tr_b16 a[234:235], v23 offset:2048
    buffer_load_dwordx4 v16, s[32:35], s91 offen offset:3072  lds
    v_mfma_f32_16x16x32_bf16 v[120:123], a[196:199], a[8:11], v[120:123]
    ds_read_b128 a[32:35], v32 offset:39936
    ds_read_b64_tr_b16 a[236:237], v24 offset:0
    v_mfma_f32_16x16x32_bf16 v[124:127], a[196:199], a[12:15], v[124:127]
    ds_read_b64_tr_b16 a[238:239], v24 offset:2048
    ds_write_b128 v35, v[8:11] offset:50176
    v_mfma_f32_16x16x32_bf16 v[60:63], v[76:79], v[8:11], v[60:63]
    v_mfma_f32_16x16x32_bf16 v[128:131], a[200:203], a[0:3], v[128:131]
    s_add_u32 m0, s98, 0
    s_xor_b32 s91, s90, 245760
    v_mfma_f32_16x16x32_bf16 v[132:135], a[200:203], a[4:7], v[132:135]
    v_fma_f32 v200, v200, s96, v53
    v_mfma_f32_16x16x32_bf16 v[136:139], a[200:203], a[8:11], v[136:139]
    v_fma_f32 v201, v201, s96, v53
    v_exp_f32 v200, v200
    v_mfma_f32_16x16x32_bf16 v[140:143], a[200:203], a[12:15], v[140:143]
    v_exp_f32 v201, v201
    v_mfma_f32_16x16x32_bf16 v[144:147], a[204:207], a[0:3], v[144:147]
    s_waitcnt lgkmcnt(1)
    buffer_load_dwordx4 v13, s[32:35], s91 offen  lds
    v_fma_f32 v202, v202, s96, v53
    v_mfma_f32_16x16x32_bf16 v[148:151], a[204:207], a[4:7], v[148:151]
    v_fma_f32 v203, v203, s96, v53
    v_exp_f32 v202, v202
    v_mfma_f32_16x16x32_bf16 v[152:155], a[204:207], a[8:11], v[152:155]
    v_exp_f32 v203, v203
    v_fma_f32 v216, v216, s96, v53
    v_mfma_f32_16x16x32_bf16 v[156:159], a[204:207], a[12:15], v[156:159]
    v_fma_f32 v217, v217, s96, v53
    v_exp_f32 v216, v216
    v_mfma_f32_16x16x32_bf16 v[96:99], a[240:243], a[20:23], v[96:99]
    ds_read_b128 a[0:3], v33 offset:0
    buffer_load_dwordx4 v14, s[32:35], s91 offen offset:1024  lds
    v_mfma_f32_16x16x32_bf16 v[100:103], a[240:243], a[24:27], v[100:103]
    v_exp_f32 v217, v217
    v_fma_f32 v218, v218, s96, v53
    v_mfma_f32_16x16x32_bf16 v[104:107], a[240:243], a[28:31], v[104:107]
    ds_read_b128 a[4:7], v33 offset:1024
    v_fma_f32 v219, v219, s96, v53
    v_exp_f32 v218, v218
    v_mfma_f32_16x16x32_bf16 v[108:111], a[240:243], a[32:35], v[108:111]
    v_cvt_pk_bf16_f32 v4, v200, v201
    v_cvt_pk_bf16_f32 v5, v202, v203
    v_mfma_f32_16x16x32_bf16 v[112:115], a[244:247], a[20:23], v[112:115]
    ds_read_b128 a[8:11], v33 offset:2048
    buffer_load_dwordx4 v15, s[32:35], s91 offen offset:2048  lds
    v_mfma_f32_16x16x32_bf16 v[116:119], a[244:247], a[24:27], v[116:119]
    s_waitcnt vmcnt(15)
    ds_read_b64_tr_b16 a[208:209], v21 offset:4096
    v_exp_f32 v219, v219
    v_mfma_f32_16x16x32_bf16 v[120:123], a[244:247], a[28:31], v[120:123]
    ds_read_b128 a[12:15], v33 offset:3072
    ds_read_b64_tr_b16 a[210:211], v21 offset:6144
    v_cvt_pk_bf16_f32 v6, v216, v217
    v_mfma_f32_16x16x32_bf16 v[124:127], a[244:247], a[32:35], v[124:127]
    ds_read_b64_tr_b16 a[212:213], v22 offset:4096
    v_cvt_pk_bf16_f32 v7, v218, v219
    v_mfma_f32_16x16x32_bf16 v[128:131], a[248:251], a[20:23], v[128:131]
    ds_read_b64_tr_b16 a[214:215], v22 offset:6144
    buffer_load_dwordx4 v16, s[32:35], s91 offen offset:3072  lds
    v_mfma_f32_16x16x32_bf16 v[132:135], a[248:251], a[24:27], v[132:135]
    ds_read_b64_tr_b16 a[216:217], v23 offset:4096
    v_mfma_f32_16x16x32_bf16 v[136:139], a[248:251], a[28:31], v[136:139]
    ds_read_b64_tr_b16 a[218:219], v23 offset:6144
    v_mfma_f32_16x16x32_bf16 v[140:143], a[248:251], a[32:35], v[140:143]
    ds_read_b64_tr_b16 a[220:221], v24 offset:4096
    v_mfma_f32_16x16x32_bf16 v[144:147], a[252:255], a[20:23], v[144:147]
    ds_read_b64_tr_b16 a[222:223], v24 offset:6144
    ds_write_b128 v35, v[4:7] offset:51200
    v_mfma_f32_16x16x32_bf16 v[64:67], v[76:79], v[4:7], v[64:67]
    v_fma_f32 v204, v204, s96, v54
    v_fma_f32 v205, v205, s96, v54
    v_mfma_f32_16x16x32_bf16 v[148:151], a[252:255], a[24:27], v[148:151]
    s_add_u32 m0, s98, 4096
    v_exp_f32 v204, v204
    v_mfma_f32_16x16x32_bf16 v[152:155], a[252:255], a[28:31], v[152:155]
    v_exp_f32 v205, v205
    v_mfma_f32_16x16x32_bf16 v[156:159], a[252:255], a[32:35], v[156:159]
    v_fma_f32 v206, v206, s96, v54
    v_fma_f32 v207, v207, s96, v54
    v_exp_f32 v206, v206
    s_waitcnt lgkmcnt(5)
    v_mfma_f32_16x16x32_bf16 v[96:99], a[224:227], a[0:3], v[96:99]
    ds_read_b128 a[20:23], v33 offset:4096
    v_exp_f32 v207, v207
    v_mfma_f32_16x16x32_bf16 v[100:103], a[224:227], a[4:7], v[100:103]
    s_waitcnt lgkmcnt(2)
    buffer_load_dwordx4 v17, s[40:43], s70 offen  lds
    v_mfma_f32_16x16x32_bf16 v[104:107], a[224:227], a[8:11], v[104:107]
    ds_read_b128 a[24:27], v33 offset:5120
    v_fma_f32 v220, v220, s96, v54
    v_fma_f32 v221, v221, s96, v54
    v_mfma_f32_16x16x32_bf16 v[108:111], a[224:227], a[12:15], v[108:111]
    v_exp_f32 v220, v220
    v_mfma_f32_16x16x32_bf16 v[112:115], a[228:231], a[0:3], v[112:115]
    ds_read_b128 a[28:31], v33 offset:6144
    v_exp_f32 v221, v221
    v_fma_f32 v222, v222, s96, v54
    v_mfma_f32_16x16x32_bf16 v[116:119], a[228:231], a[4:7], v[116:119]
    buffer_load_dwordx4 v18, s[40:43], s70 offen offset:1024  lds
    v_fma_f32 v223, v223, s96, v54
    v_mfma_f32_16x16x32_bf16 v[120:123], a[228:231], a[8:11], v[120:123]
    ds_read_b128 a[32:35], v33 offset:7168
    v_exp_f32 v222, v222
    v_mfma_f32_16x16x32_bf16 v[124:127], a[228:231], a[12:15], v[124:127]
    v_cvt_pk_bf16_f32 v8, v204, v205
    v_cvt_pk_bf16_f32 v9, v206, v207
    v_exp_f32 v223, v223
    v_mfma_f32_16x16x32_bf16 v[128:131], a[232:235], a[0:3], v[128:131]
    v_cvt_pk_bf16_f32 v10, v220, v221
    v_cvt_pk_bf16_f32 v11, v222, v223
    v_mfma_f32_16x16x32_bf16 v[132:135], a[232:235], a[4:7], v[132:135]
    buffer_load_dwordx4 v19, s[40:43], s70 offen offset:2048  lds
    v_mfma_f32_16x16x32_bf16 v[136:139], a[232:235], a[8:11], v[136:139]
    s_waitcnt vmcnt(15)
    ds_read_b64_tr_b16 a[240:241], v21 offset:8192
    v_mfma_f32_16x16x32_bf16 v[140:143], a[232:235], a[12:15], v[140:143]
    ds_read_b64_tr_b16 a[242:243], v21 offset:10240
    v_mfma_f32_16x16x32_bf16 v[144:147], a[236:239], a[0:3], v[144:147]
    ds_read_b64_tr_b16 a[244:245], v22 offset:8192
    v_mfma_f32_16x16x32_bf16 v[148:151], a[236:239], a[4:7], v[148:151]
    ds_read_b64_tr_b16 a[246:247], v22 offset:10240
    buffer_load_dwordx4 v20, s[40:43], s70 offen offset:3072  lds
    v_mfma_f32_16x16x32_bf16 v[152:155], a[236:239], a[8:11], v[152:155]
    ds_read_b64_tr_b16 a[248:249], v23 offset:8192
    v_mfma_f32_16x16x32_bf16 v[156:159], a[236:239], a[12:15], v[156:159]
    ds_read_b64_tr_b16 a[250:251], v23 offset:10240
    s_waitcnt lgkmcnt(6)
    v_mfma_f32_16x16x32_bf16 v[96:99], a[208:211], a[20:23], v[96:99]
    ds_read_b64_tr_b16 a[252:253], v24 offset:8192
    v_mfma_f32_16x16x32_bf16 v[100:103], a[208:211], a[24:27], v[100:103]
    ds_read_b64_tr_b16 a[254:255], v24 offset:10240
    ds_write_b128 v35, v[8:11] offset:52224
    v_mfma_f32_16x16x32_bf16 v[68:71], v[76:79], v[8:11], v[68:71]
    ds_write_b32 v37, v56 offset:2048
    ds_write_b32 v37, v60 offset:2304
    ds_write_b32 v37, v64 offset:2560
    s_nop 4
    ds_write_b32 v37, v68 offset:2816
    v_mfma_f32_16x16x32_bf16 v[104:107], a[208:211], a[28:31], v[104:107]
    s_add_u32 m0, s98, 8192
    s_add_u32 s91, s70, 28672
    v_mfma_f32_16x16x32_bf16 v[108:111], a[208:211], a[32:35], v[108:111]
    v_mfma_f32_16x16x32_bf16 v[112:115], a[212:215], a[20:23], v[112:115]
    s_waitcnt lgkmcnt(0)
    s_barrier
    v_mfma_f32_16x16x32_bf16 v[116:119], a[212:215], a[24:27], v[116:119]
    ds_read_b128 a[0:3], v33 offset:8192
    ds_read_b128 a[4:7], v33 offset:9216
    v_mfma_f32_16x16x32_bf16 v[120:123], a[212:215], a[28:31], v[120:123]
    ds_read_b128 a[8:11], v33 offset:10240
    v_mfma_f32_16x16x32_bf16 v[124:127], a[212:215], a[32:35], v[124:127]
    ds_read_b128 a[12:15], v33 offset:11264
    v_mfma_f32_16x16x32_bf16 v[128:131], a[216:219], a[20:23], v[128:131]
    buffer_load_dwordx4 v17, s[40:43], s91 offen  lds
    v_mfma_f32_16x16x32_bf16 v[132:135], a[216:219], a[24:27], v[132:135]
    v_mfma_f32_16x16x32_bf16 v[136:139], a[216:219], a[28:31], v[136:139]
    buffer_load_dwordx4 v18, s[40:43], s91 offen offset:1024  lds
    v_mfma_f32_16x16x32_bf16 v[140:143], a[216:219], a[32:35], v[140:143]
    v_mfma_f32_16x16x32_bf16 v[144:147], a[220:223], a[20:23], v[144:147]
    v_mfma_f32_16x16x32_bf16 v[148:151], a[220:223], a[24:27], v[148:151]
    v_mfma_f32_16x16x32_bf16 v[152:155], a[220:223], a[28:31], v[152:155]
    v_mfma_f32_16x16x32_bf16 v[156:159], a[220:223], a[32:35], v[156:159]
    buffer_load_dwordx4 v19, s[40:43], s91 offen offset:2048  lds
    s_bitcmp1_b32 s4, 3
    s_cbranch_scc1 L_rs4_3
L_rb4_3:
    s_waitcnt lgkmcnt(2)
    v_mfma_f32_16x16x32_bf16 v[96:99], a[240:243], a[0:3], v[96:99]
    ds_read_b128 a[20:23], v33 offset:12288
    v_mfma_f32_16x16x32_bf16 v[100:103], a[240:243], a[4:7], v[100:103]
    s_waitcnt vmcnt(15)
    ds_read_b64_tr_b16 a[224:225], v21 offset:12288
    s_waitcnt lgkmcnt(2)
    v_mfma_f32_16x16x32_bf16 v[104:107], a[240:243], a[8:11], v[104:107]
    ds_read_b128 a[24:27], v33 offset:13312
    ds_read_b64_tr_b16 a[226:227], v21 offset:14336
    v_mfma_f32_16x16x32_bf16 v[108:111], a[240:243], a[12:15], v[108:111]
    ds_read_b64_tr_b16 a[228:229], v22 offset:12288
    ds_read_b64_tr_b16 a[230:231], v22 offset:14336
    v_mfma_f32_16x16x32_bf16 v[112:115], a[244:247], a[0:3], v[112:115]
    ds_read_b128 a[28:31], v33 offset:14336
    ds_read_b64_tr_b16 a[232:233], v23 offset:12288
    v_mfma_f32_16x16x32_bf16 v[116:119], a[244:247], a[4:7], v[116:119]
    ds_read_b64_tr_b16 a[234:235], v23 offset:14336
    buffer_load_dwordx4 v20, s[40:43], s91 offen offset:3072  lds
    v_mfma_f32_16x16x32_bf16 v[120:123], a[244:247], a[8:11], v[120:123]
    ds_read_b128 a[32:35], v33 offset:15360
    ds_read_b64_tr_b16 a[236:237], v24 offset:12288
    v_mfma_f32_16x16x32_bf16 v[124:127], a[244:247], a[12:15], v[124:127]
    ds_read_b64_tr_b16 a[238:239], v24 offset:14336
    v_mfma_f32_16x16x32_bf16 v[128:131], a[248:251], a[0:3], v[128:131]
    s_add_u32 m0, s98, 12288
    v_mfma_f32_16x16x32_bf16 v[132:135], a[248:251], a[4:7], v[132:135]
    v_mfma_f32_16x16x32_bf16 v[136:139], a[248:251], a[8:11], v[136:139]
    v_mfma_f32_16x16x32_bf16 v[140:143], a[248:251], a[12:15], v[140:143]
    s_waitcnt lgkmcnt(0)
    buffer_load_dwordx4 v17, s[40:43], s71 offen  lds
    v_mfma_f32_16x16x32_bf16 v[144:147], a[252:255], a[0:3], v[144:147]
    v_mfma_f32_16x16x32_bf16 v[148:151], a[252:255], a[4:7], v[148:151]
    v_mfma_f32_16x16x32_bf16 v[152:155], a[252:255], a[8:11], v[152:155]
    buffer_load_dwordx4 v18, s[40:43], s71 offen offset:1024  lds
    v_mfma_f32_16x16x32_bf16 v[156:159], a[252:255], a[12:15], v[156:159]
    s_waitcnt vmcnt(14)
    ds_read_b64_tr_b16 a[240:241], v21 offset:16384
    v_mfma_f32_16x16x32_bf16 v[96:99], a[224:227], a[20:23], v[96:99]
    ds_read_b128 a[0:3], v33 offset:16384
    ds_read_b64_tr_b16 a[242:243], v21 offset:18432
    v_mfma_f32_16x16x32_bf16 v[100:103], a[224:227], a[24:27], v[100:103]
    ds_read_b64_tr_b16 a[244:245], v22 offset:16384
    buffer_load_dwordx4 v19, s[40:43], s71 offen offset:2048  lds
    v_mfma_f32_16x16x32_bf16 v[104:107], a[224:227], a[28:31], v[104:107]
    ds_read_b128 a[4:7], v33 offset:17408
    ds_read_b64_tr_b16 a[246:247], v22 offset:18432
    v_mfma_f32_16x16x32_bf16 v[108:111], a[224:227], a[32:35], v[108:111]
    ds_read_b64_tr_b16 a[248:249], v23 offset:16384
    v_mfma_f32_16x16x32_bf16 v[112:115], a[228:231], a[20:23], v[112:115]
    ds_read_b128 a[8:11], v33 offset:18432
    ds_read_b64_tr_b16 a[250:251], v23 offset:18432
    v_mfma_f32_16x16x32_bf16 v[116:119], a[228:231], a[24:27], v[116:119]
    ds_read_b64_tr_b16 a[252:253], v24 offset:16384
    buffer_load_dwordx4 v20, s[40:43], s71 offen offset:3072  lds
    v_mfma_f32_16x16x32_bf16 v[120:123], a[228:231], a[28:31], v[120:123]
    ds_read_b128 a[12:15], v33 offset:19456
    ds_read_b64_tr_b16 a[254:255], v24 offset:18432
    v_mfma_f32_16x16x32_bf16 v[124:127], a[228:231], a[32:35], v[124:127]
    s_add_u32 m0, s98, 16384
    s_add_u32 s91, s71, 28672
    v_mfma_f32_16x16x32_bf16 v[128:131], a[232:235], a[20:23], v[128:131]
    ds_read_b128 v[236:239], v38 offset:2048
    v_mfma_f32_16x16x32_bf16 v[132:135], a[232:235], a[24:27], v[132:135]
    s_waitcnt lgkmcnt(1)
    buffer_load_dwordx4 v17, s[40:43], s91 offen  lds
    v_mfma_f32_16x16x32_bf16 v[136:139], a[232:235], a[28:31], v[136:139]
    ds_read_b128 v[240:243], v38 offset:2304
    v_mfma_f32_16x16x32_bf16 v[140:143], a[232:235], a[32:35], v[140:143]
    buffer_load_dwordx4 v18, s[40:43], s91 offen offset:1024  lds
    v_mfma_f32_16x16x32_bf16 v[144:147], a[236:239], a[20:23], v[144:147]
    ds_read_b128 v[244:247], v38 offset:2560
    v_mfma_f32_16x16x32_bf16 v[148:151], a[236:239], a[24:27], v[148:151]
    buffer_load_dwordx4 v19, s[40:43], s91 offen offset:2048  lds
    v_mfma_f32_16x16x32_bf16 v[152:155], a[236:239], a[28:31], v[152:155]
    ds_read_b128 v[248:251], v38 offset:2816
    v_mfma_f32_16x16x32_bf16 v[156:159], a[236:239], a[32:35], v[156:159]
    s_waitcnt vmcnt(15)
    ds_read_b64_tr_b16 a[224:225], v21 offset:0
    buffer_load_dwordx4 v20, s[40:43], s91 offen offset:3072  lds
    v_mfma_f32_16x16x32_bf16 v[96:99], a[240:243], a[0:3], v[96:99]
    ds_read_b128 a[20:23], v33 offset:20480
    s_lshl_b32 s22, s16, 5
    buffer_load_dword v30, off, s[84:87], s22 sc1
    v_mfma_f32_16x16x32_bf16 v[100:103], a[240:243], a[4:7], v[100:103]
    ds_read_b64_tr_b16 a[226:227], v21 offset:2048
    ds_read_b64_tr_b16 a[228:229], v22 offset:0
    v_mfma_f32_16x16x32_bf16 v[104:107], a[240:243], a[8:11], v[104:107]
    ds_read_b128 a[24:27], v33 offset:21504
    ds_read_b64_tr_b16 a[230:231], v22 offset:2048
    v_mfma_f32_16x16x32_bf16 v[108:111], a[240:243], a[12:15], v[108:111]
    ds_read_b64_tr_b16 a[232:233], v23 offset:0
    v_mfma_f32_16x16x32_bf16 v[112:115], a[244:247], a[0:3], v[112:115]
    ds_read_b128 a[28:31], v33 offset:22528
    ds_read_b64_tr_b16 a[234:235], v23 offset:2048
    v_mfma_f32_16x16x32_bf16 v[116:119], a[244:247], a[4:7], v[116:119]
    ds_read_b64_tr_b16 a[236:237], v24 offset:0
    v_mfma_f32_16x16x32_bf16 v[120:123], a[244:247], a[8:11], v[120:123]
    ds_read_b128 a[32:35], v33 offset:23552
    ds_read_b64_tr_b16 a[238:239], v24 offset:2048
    v_mfma_f32_16x16x32_bf16 v[124:127], a[244:247], a[12:15], v[124:127]
    s_waitcnt lgkmcnt(11)
    v_add_f32 v236, v236, v237
    v_add_f32 v238, v238, v239
    v_mfma_f32_16x16x32_bf16 v[128:131], a[248:251], a[0:3], v[128:131]
    v_add_f32 v236, v236, v238
    v_mfma_f32_16x16x32_bf16 v[132:135], a[248:251], a[4:7], v[132:135]
    v_rcp_f32 v46, v236
    v_mfma_f32_16x16x32_bf16 v[136:139], a[248:251], a[8:11], v[136:139]
    v_add_f32 v240, v240, v241
    v_add_f32 v242, v242, v243
    v_mfma_f32_16x16x32_bf16 v[140:143], a[248:251], a[12:15], v[140:143]
    v_add_f32 v240, v240, v242
    v_mfma_f32_16x16x32_bf16 v[144:147], a[252:255], a[0:3], v[144:147]
    v_rcp_f32 v47, v240
    v_mfma_f32_16x16x32_bf16 v[148:151], a[252:255], a[4:7], v[148:151]
    v_add_f32 v244, v244, v245
    v_add_f32 v246, v246, v247
    v_mfma_f32_16x16x32_bf16 v[152:155], a[252:255], a[8:11], v[152:155]
    v_add_f32 v244, v244, v246
    v_mfma_f32_16x16x32_bf16 v[156:159], a[252:255], a[12:15], v[156:159]
    v_rcp_f32 v48, v244
    s_waitcnt lgkmcnt(0)
    v_mfma_f32_16x16x32_bf16 v[96:99], a[224:227], a[20:23], v[96:99]
    v_add_f32 v248, v248, v249
    v_add_f32 v250, v250, v251
    v_mfma_f32_16x16x32_bf16 v[112:115], a[228:231], a[20:23], v[112:115]
    v_add_f32 v248, v248, v250
    v_rcp_f32 v49, v248
    v_mfma_f32_16x16x32_bf16 v[100:103], a[224:227], a[24:27], v[100:103]
    v_mfma_f32_16x16x32_bf16 v[116:119], a[228:231], a[24:27], v[116:119]
    v_mfma_f32_16x16x32_bf16 v[104:107], a[224:227], a[28:31], v[104:107]
    v_cvt_pk_bf16_f32 v4, v96, v97
    v_cvt_pk_bf16_f32 v5, v98, v99
    v_mfma_f32_16x16x32_bf16 v[120:123], a[228:231], a[28:31], v[120:123]
    v_cvt_pk_bf16_f32 v6, v112, v113
    v_cvt_pk_bf16_f32 v7, v114, v115
    v_mfma_f32_16x16x32_bf16 v[108:111], a[224:227], a[32:35], v[108:111]
    ds_write_b128 v36, v[4:7] offset:0
    v_cvt_pk_bf16_f32 v8, v100, v101
    v_cvt_pk_bf16_f32 v9, v102, v103
    v_mfma_f32_16x16x32_bf16 v[124:127], a[228:231], a[32:35], v[124:127]
    v_cvt_pk_bf16_f32 v10, v116, v117
    v_cvt_pk_bf16_f32 v11, v118, v119
    v_mfma_f32_16x16x32_bf16 v[128:131], a[232:235], a[20:23], v[128:131]
    ds_write_b128 v36, v[8:11] offset:1024
    v_cvt_pk_bf16_f32 v4, v104, v105
    v_cvt_pk_bf16_f32 v5, v106, v107
    v_mfma_f32_16x16x32_bf16 v[144:147], a[236:239], a[20:23], v[144:147]
    v_cvt_pk_bf16_f32 v6, v120, v121
    v_cvt_pk_bf16_f32 v7, v122, v123
    v_mfma_f32_16x16x32_bf16 v[132:135], a[232:235], a[24:27], v[132:135]
    ds_write_b128 v36, v[4:7] offset:2048
    v_cvt_pk_bf16_f32 v8, v108, v109
    v_cvt_pk_bf16_f32 v9, v110, v111
    v_mfma_f32_16x16x32_bf16 v[148:151], a[236:239], a[24:27], v[148:151]
    v_cvt_pk_bf16_f32 v10, v124, v125
    v_cvt_pk_bf16_f32 v11, v126, v127
    v_mfma_f32_16x16x32_bf16 v[136:139], a[232:235], a[28:31], v[136:139]
    ds_write_b128 v36, v[8:11] offset:3072
    v_cvt_pk_bf16_f32 v4, v128, v129
    v_cvt_pk_bf16_f32 v5, v130, v131
    v_mfma_f32_16x16x32_bf16 v[152:155], a[236:239], a[28:31], v[152:155]
    v_cvt_pk_bf16_f32 v6, v144, v145
    v_cvt_pk_bf16_f32 v7, v146, v147
    v_mfma_f32_16x16x32_bf16 v[140:143], a[232:235], a[32:35], v[140:143]
    ds_write_b128 v36, v[4:7] offset:4096
    v_cvt_pk_bf16_f32 v8, v132, v133
    v_cvt_pk_bf16_f32 v9, v134, v135
    v_mfma_f32_16x16x32_bf16 v[156:159], a[236:239], a[32:35], v[156:159]
    v_cvt_pk_bf16_f32 v10, v148, v149
    v_cvt_pk_bf16_f32 v11, v150, v151
    ds_write_b128 v36, v[8:11] offset:5120
    v_cvt_pk_bf16_f32 v160, v136, v137
    v_cvt_pk_bf16_f32 v161, v138, v139
    v_cvt_pk_bf16_f32 v162, v152, v153
    v_cvt_pk_bf16_f32 v163, v154, v155
    v_cvt_pk_bf16_f32 v164, v140, v141
    v_cvt_pk_bf16_f32 v165, v142, v143
    v_cvt_pk_bf16_f32 v166, v156, v157
    v_cvt_pk_bf16_f32 v167, v158, v159
    ds_write_b128 v36, v[160:163] offset:6144
    ds_write_b128 v36, v[164:167] offset:7168
    s_waitcnt vmcnt(9)
    s_waitcnt lgkmcnt(0)
    s_barrier
    ds_read_b64_tr_b16 a[240:241], v25 offset:4096
    ds_read_b64_tr_b16 a[242:243], v25 offset:6144
    ds_read_b128 a[0:3], v32 offset:0
    ds_read_b128 a[4:7], v32 offset:1024
    ds_read_b128 a[8:11], v32 offset:2048
    ds_read_b128 a[12:15], v32 offset:3072
    ds_read_b64_tr_b16 a[244:245], v25 offset:8192
    ds_read_b64_tr_b16 a[246:247], v25 offset:10240
    ds_read_b128 a[16:19], v32 offset:4096
    ds_read_b128 a[20:23], v32 offset:5120
    s_waitcnt lgkmcnt(7)
    v_mfma_f32_16x16x32_bf16 v[96:99], a[240:243], a[0:3], 0
    ds_read_b128 a[24:27], v32 offset:6144
    ds_read_b128 a[28:31], v32 offset:7168
    s_waitcnt lgkmcnt(8)
    v_mfma_f32_16x16x32_bf16 v[100:103], a[240:243], a[4:7], 0
    ds_read_b64_tr_b16 a[248:249], v25 offset:24576
    ds_read_b64_tr_b16 a[250:251], v25 offset:26624
    s_waitcnt lgkmcnt(9)
    v_mfma_f32_16x16x32_bf16 v[104:107], a[240:243], a[8:11], 0
    ds_read_b128 a[32:35], v32 offset:8192
    s_lshl_b32 s20, s3, 13
    s_add_u32 m0, s20, 32768
    s_waitcnt lgkmcnt(9)
    v_mfma_f32_16x16x32_bf16 v[108:111], a[240:243], a[12:15], 0
    ds_read_b128 a[36:39], v32 offset:9216
    ds_read_b128 a[40:43], v32 offset:10240
    s_waitcnt lgkmcnt(8)
    v_mfma_f32_16x16x32_bf16 v[96:99], a[244:247], a[16:19], v[96:99]
    ds_read_b128 a[44:47], v32 offset:11264
    buffer_load_dwordx4 v17, s[40:43], s72 offen  lds
    s_waitcnt lgkmcnt(8)
    v_mfma_f32_16x16x32_bf16 v[100:103], a[244:247], a[20:23], v[100:103]
    ds_read_b64_tr_b16 a[252:253], v25 offset:28672
    ds_read_b64_tr_b16 a[254:255], v25 offset:30720
    s_waitcnt lgkmcnt(9)
    v_mfma_f32_16x16x32_bf16 v[104:107], a[244:247], a[24:27], v[104:107]
    ds_read_b128 a[48:51], v32 offset:12288
    ds_read_b128 a[52:55], v32 offset:13312
    s_waitcnt lgkmcnt(10)
    v_mfma_f32_16x16x32_bf16 v[108:111], a[244:247], a[28:31], v[108:111]
    ds_read_b128 a[56:59], v32 offset:14336
    buffer_load_dwordx4 v18, s[40:43], s72 offen offset:1024  lds
    s_waitcnt lgkmcnt(8)
    v_mfma_f32_16x16x32_bf16 v[96:99], a[248:251], a[32:35], v[96:99]
    ds_read_b128 a[60:63], v32 offset:15360
    ds_read_b64_tr_b16 a[224:225], v26 offset:4096
    s_waitcnt lgkmcnt(9)
    v_mfma_f32_16x16x32_bf16 v[100:103], a[248:251], a[36:39], v[100:103]
    ds_read_b64_tr_b16 a[226:227], v26 offset:6144
    buffer_load_dwordx4 v19, s[40:43], s72 offen offset:2048  lds
    s_waitcnt lgkmcnt(9)
    v_mfma_f32_16x16x32_bf16 v[104:107], a[248:251], a[40:43], v[104:107]
    ds_read_b128 a[64:67], v32 offset:16384
    ds_read_b128 a[68:71], v32 offset:17408
    s_waitcnt lgkmcnt(10)
    v_mfma_f32_16x16x32_bf16 v[108:111], a[248:251], a[44:47], v[108:111]
    ds_read_b128 a[72:75], v32 offset:18432
    buffer_load_dwordx4 v20, s[40:43], s72 offen offset:3072  lds
    s_waitcnt lgkmcnt(8)
    v_mfma_f32_16x16x32_bf16 v[96:99], a[252:255], a[48:51], v[96:99]
    ds_read_b128 a[76:79], v32 offset:19456
    ds_read_b64_tr_b16 a[228:229], v26 offset:8192
    s_waitcnt lgkmcnt(9)
    v_mfma_f32_16x16x32_bf16 v[100:103], a[252:255], a[52:55], v[100:103]
    ds_read_b64_tr_b16 a[230:231], v26 offset:10240
    ds_read_b128 a[80:83], v32 offset:20480
    s_waitcnt lgkmcnt(10)
    v_mfma_f32_16x16x32_bf16 v[104:107], a[252:255], a[56:59], v[104:107]
    ds_read_b128 a[84:87], v32 offset:21504
    s_lshl_b32 s20, s3, 13
    s_add_u32 m0, s20, 36864
    s_add_u32 s91, s72, 28672
    s_waitcnt lgkmcnt(10)
    v_mfma_f32_16x16x32_bf16 v[108:111], a[252:255], a[60:63], v[108:111]
    ds_read_b128 a[88:91], v32 offset:22528
    ds_read_b128 a[92:95], v32 offset:23552
    s_waitcnt lgkmcnt(9)
    v_mfma_f32_16x16x32_bf16 v[96:99], a[224:227], a[64:67], v[96:99]
    ds_read_b64_tr_b16 a[232:233], v26 offset:24576
    buffer_load_dwordx4 v17, s[40:43], s91 offen  lds
    s_waitcnt lgkmcnt(9)
    v_mfma_f32_16x16x32_bf16 v[100:103], a[224:227], a[68:71], v[100:103]
    ds_read_b64_tr_b16 a[234:235], v26 offset:26624
    ds_read_b128 a[96:99], v32 offset:24576
    s_waitcnt lgkmcnt(10)
    v_mfma_f32_16x16x32_bf16 v[104:107], a[224:227], a[72:75], v[104:107]
    ds_read_b128 a[100:103], v32 offset:25600
    ds_read_b128 a[104:107], v32 offset:26624
    s_waitcnt lgkmcnt(11)
    v_mfma_f32_16x16x32_bf16 v[108:111], a[224:227], a[76:79], v[108:111]
    ds_read_b128 a[108:111], v32 offset:27648
    buffer_load_dwordx4 v18, s[40:43], s91 offen offset:1024  lds
    s_waitcnt lgkmcnt(9)
    v_mfma_f32_16x16x32_bf16 v[96:99], a[228:231], a[80:83], v[96:99]
    ds_read_b64_tr_b16 a[236:237], v26 offset:28672
    ds_read_b64_tr_b16 a[238:239], v26 offset:30720
    s_waitcnt lgkmcnt(10)
    v_mfma_f32_16x16x32_bf16 v[100:103], a[228:231], a[84:87], v[100:103]
    ds_read_b128 a[112:115], v32 offset:28672
    buffer_load_dwordx4 v19, s[40:43], s91 offen offset:2048  lds
    s_waitcnt lgkmcnt(10)
    v_mfma_f32_16x16x32_bf16 v[104:107], a[228:231], a[88:91], v[104:107]
    ds_read_b128 a[116:119], v32 offset:29696
    ds_read_b128 a[120:123], v32 offset:30720
    s_waitcnt lgkmcnt(11)
    v_mfma_f32_16x16x32_bf16 v[108:111], a[228:231], a[92:95], v[108:111]
    ds_read_b128 a[124:127], v32 offset:31744
    buffer_load_dwordx4 v20, s[40:43], s91 offen offset:3072  lds
    s_waitcnt lgkmcnt(9)
    v_mfma_f32_16x16x32_bf16 v[96:99], a[232:235], a[96:99], v[96:99]
    s_waitcnt lgkmcnt(8)
    v_mfma_f32_16x16x32_bf16 v[100:103], a[232:235], a[100:103], v[100:103]
    s_waitcnt lgkmcnt(7)
    v_mfma_f32_16x16x32_bf16 v[104:107], a[232:235], a[104:107], v[104:107]
    s_waitcnt vmcnt(9)
    s_waitcnt lgkmcnt(4)
    s_barrier
    v_mfma_f32_16x16x32_bf16 v[108:111], a[232:235], a[108:111], v[108:111]
    ds_read_b64_tr_b16 a[240:241], v25 offset:12288
    s_add_u32 m0, s98, 4096
    s_waitcnt lgkmcnt(4)
    v_mfma_f32_16x16x32_bf16 v[96:99], a[236:239], a[112:115], v[96:99]
    ds_read_b64_tr_b16 a[242:243], v25 offset:14336
    buffer_load_dwordx4 v17, s[40:43], s73 offen  lds
    s_waitcnt lgkmcnt(4)
    v_mfma_f32_16x16x32_bf16 v[100:103], a[236:239], a[116:119], v[100:103]
    ds_read_b64_tr_b16 a[244:245], v25 offset:16384
    s_waitcnt lgkmcnt(4)
    v_mfma_f32_16x16x32_bf16 v[104:107], a[236:239], a[120:123], v[104:107]
    ds_read_b64_tr_b16 a[246:247], v25 offset:18432
    buffer_load_dwordx4 v18, s[40:43], s73 offen offset:1024  lds
    s_waitcnt lgkmcnt(4)
    v_mfma_f32_16x16x32_bf16 v[108:111], a[236:239], a[124:127], v[108:111]
    ds_read_b64_tr_b16 a[248:249], v25 offset:32768
    buffer_load_dwordx4 v19, s[40:43], s73 offen offset:2048  lds
    s_waitcnt lgkmcnt(3)
    v_mfma_f32_16x16x32_bf16 v[116:119], a[240:243], a[0:3], 0
    ds_read_b64_tr_b16 a[250:251], v25 offset:34816
    v_mfma_f32_16x16x32_bf16 v[120:123], a[240:243], a[4:7], 0
    ds_read_b64_tr_b16 a[252:253], v25 offset:36864
    buffer_load_dwordx4 v20, s[40:43], s73 offen offset:3072  lds
    v_mfma_f32_16x16x32_bf16 v[124:127], a[240:243], a[8:11], 0
    ds_read_b64_tr_b16 a[254:255], v25 offset:38912
    s_add_u32 m0, s98, 8192
    s_add_u32 s91, s73, 28672
    v_mfma_f32_16x16x32_bf16 v[128:131], a[240:243], a[12:15], 0
    ds_read_b64_tr_b16 a[224:225], v26 offset:12288
    s_waitcnt lgkmcnt(5)
    v_mfma_f32_16x16x32_bf16 v[116:119], a[244:247], a[16:19], v[116:119]
    ds_read_b64_tr_b16 a[226:227], v26 offset:14336
    buffer_load_dwordx4 v17, s[40:43], s91 offen  lds
    v_mul_f32 v96, v46, v96
    v_mfma_f32_16x16x32_bf16 v[120:123], a[244:247], a[20:23], v[120:123]
    ds_read_b64_tr_b16 a[228:229], v26 offset:16384
    buffer_load_dwordx4 v18, s[40:43], s91 offen offset:1024  lds
    v_mul_f32 v97, v46, v97
    v_mfma_f32_16x16x32_bf16 v[124:127], a[244:247], a[24:27], v[124:127]
    ds_read_b64_tr_b16 a[230:231], v26 offset:18432
    v_mul_f32 v98, v46, v98
    v_mul_f32 v99, v46, v99
    v_mfma_f32_16x16x32_bf16 v[128:131], a[244:247], a[28:31], v[128:131]
    ds_read_b64_tr_b16 a[232:233], v26 offset:32768
    buffer_load_dwordx4 v19, s[40:43], s91 offen offset:2048  lds
    v_cvt_pk_bf16_f32 v56, v96, v97
    s_waitcnt lgkmcnt(7)
    v_mfma_f32_16x16x32_bf16 v[116:119], a[248:251], a[32:35], v[116:119]
    ds_read_b64_tr_b16 a[234:235], v26 offset:34816
    buffer_load_dwordx4 v20, s[40:43], s91 offen offset:3072  lds
    v_mfma_f32_16x16x32_bf16 v[120:123], a[248:251], a[36:39], v[120:123]
    ds_read_b64_tr_b16 a[236:237], v26 offset:36864
    v_cvt_pk_bf16_f32 v57, v98, v99
    v_mul_f32 v100, v47, v100
    v_mfma_f32_16x16x32_bf16 v[124:127], a[248:251], a[40:43], v[124:127]
    ds_read_b64_tr_b16 a[238:239], v26 offset:38912
    v_mul_f32 v101, v47, v101
    v_mul_f32 v102, v47, v102
    v_mfma_f32_16x16x32_bf16 v[128:131], a[248:251], a[44:47], v[128:131]
    v_mul_f32 v103, v47, v103
    v_cvt_pk_bf16_f32 v58, v100, v101
    v_cvt_pk_bf16_f32 v59, v102, v103
    s_waitcnt lgkmcnt(6)
    v_mfma_f32_16x16x32_bf16 v[116:119], a[252:255], a[48:51], v[116:119]
    s_mov_b32 s21, 0
    buffer_store_dwordx4 v[56:59], v39, s[44:47], s21 offen sc1
    v_mfma_f32_16x16x32_bf16 v[120:123], a[252:255], a[52:55], v[120:123]
    v_mfma_f32_16x16x32_bf16 v[124:127], a[252:255], a[56:59], v[124:127]
    v_mul_f32 v104, v48, v104
    v_mul_f32 v105, v48, v105
    v_mul_f32 v106, v48, v106
    v_mfma_f32_16x16x32_bf16 v[128:131], a[252:255], a[60:63], v[128:131]
    v_mul_f32 v107, v48, v107
    v_cvt_pk_bf16_f32 v60, v104, v105
    v_cvt_pk_bf16_f32 v61, v106, v107
    v_mfma_f32_16x16x32_bf16 v[116:119], a[224:227], a[64:67], v[116:119]
    v_mul_f32 v108, v49, v108
    v_mul_f32 v109, v49, v109
    v_mul_f32 v110, v49, v110
    v_mfma_f32_16x16x32_bf16 v[120:123], a[224:227], a[68:71], v[120:123]
    s_waitcnt vmcnt(9)
    s_waitcnt lgkmcnt(0)
    s_barrier
    v_mfma_f32_16x16x32_bf16 v[124:127], a[224:227], a[72:75], v[124:127]
    ds_read_b64_tr_b16 a[240:241], v27 offset:0
    ds_read_b64_tr_b16 a[242:243], v27 offset:2048
    v_mul_f32 v111, v49, v111
    v_mfma_f32_16x16x32_bf16 v[128:131], a[224:227], a[76:79], v[128:131]
    ds_read_b64_tr_b16 a[244:245], v27 offset:4096
    s_add_u32 m0, s98, 12288
    v_cvt_pk_bf16_f32 v62, v108, v109
    v_mfma_f32_16x16x32_bf16 v[116:119], a[228:231], a[80:83], v[116:119]
    ds_read_b64_tr_b16 a[246:247], v27 offset:6144
    buffer_load_dwordx4 v17, s[40:43], s74 offen  lds
    v_cvt_pk_bf16_f32 v63, v110, v111
    v_mfma_f32_16x16x32_bf16 v[120:123], a[228:231], a[84:87], v[120:123]
    ds_read_b64_tr_b16 a[248:249], v27 offset:8192
    ds_read_b64_tr_b16 a[250:251], v27 offset:10240
    v_mfma_f32_16x16x32_bf16 v[124:127], a[228:231], a[88:91], v[124:127]
    ds_read_b64_tr_b16 a[252:253], v27 offset:12288
    buffer_load_dwordx4 v18, s[40:43], s74 offen offset:1024  lds
    v_mfma_f32_16x16x32_bf16 v[128:131], a[228:231], a[92:95], v[128:131]
    ds_read_b64_tr_b16 a[254:255], v27 offset:14336
    buffer_load_dwordx4 v19, s[40:43], s74 offen offset:2048  lds
    v_mfma_f32_16x16x32_bf16 v[116:119], a[232:235], a[96:99], v[116:119]
    ds_read_b64_tr_b16 a[208:209], v27 offset:16384
    ds_read_b64_tr_b16 a[210:211], v27 offset:18432
    buffer_store_dwordx4 v[60:63], v40, s[44:47], s21 offen sc1
    v_mfma_f32_16x16x32_bf16 v[120:123], a[232:235], a[100:103], v[120:123]
    ds_read_b64_tr_b16 a[212:213], v27 offset:20480
    buffer_load_dwordx4 v20, s[40:43], s74 offen offset:3072  lds
    v_mfma_f32_16x16x32_bf16 v[124:127], a[232:235], a[104:107], v[124:127]
    ds_read_b64_tr_b16 a[214:215], v27 offset:22528
    s_add_u32 m0, s98, 16384
    s_add_u32 s91, s74, 28672
    v_mfma_f32_16x16x32_bf16 v[128:131], a[232:235], a[108:111], v[128:131]
    ds_read_b64_tr_b16 a[216:217], v27 offset:24576
    ds_read_b64_tr_b16 a[218:219], v27 offset:26624
    v_mfma_f32_16x16x32_bf16 v[116:119], a[236:239], a[112:115], v[116:119]
    ds_read_b64_tr_b16 a[220:221], v27 offset:28672
    buffer_load_dwordx4 v17, s[40:43], s91 offen  lds
    v_mfma_f32_16x16x32_bf16 v[120:123], a[236:239], a[116:119], v[120:123]
    ds_read_b64_tr_b16 a[222:223], v27 offset:30720
    buffer_load_dwordx4 v18, s[40:43], s91 offen offset:1024  lds
    v_mfma_f32_16x16x32_bf16 v[124:127], a[236:239], a[120:123], v[124:127]
    buffer_load_dwordx4 v19, s[40:43], s91 offen offset:2048  lds
    v_mfma_f32_16x16x32_bf16 v[128:131], a[236:239], a[124:127], v[128:131]
    buffer_load_dwordx4 v20, s[40:43], s91 offen offset:3072  lds
    s_waitcnt lgkmcnt(8)
    v_mfma_f32_16x16x32_bf16 v[136:139], a[240:243], a[0:3], 0
    v_mfma_f32_16x16x32_bf16 v[140:143], a[240:243], a[4:7], 0
    v_mfma_f32_16x16x32_bf16 v[144:147], a[240:243], a[8:11], 0
    v_mfma_f32_16x16x32_bf16 v[148:151], a[240:243], a[12:15], 0
    v_mfma_f32_16x16x32_bf16 v[136:139], a[244:247], a[16:19], v[136:139]
    v_mul_f32 v116, v46, v116
    v_mul_f32 v117, v46, v117
    v_mul_f32 v118, v46, v118
    v_mfma_f32_16x16x32_bf16 v[140:143], a[244:247], a[20:23], v[140:143]
    v_mul_f32 v119, v46, v119
    v_cvt_pk_bf16_f32 v68, v116, v117
    v_mfma_f32_16x16x32_bf16 v[144:147], a[244:247], a[24:27], v[144:147]
    v_cvt_pk_bf16_f32 v69, v118, v119
    v_mul_f32 v120, v47, v120
    v_mul_f32 v121, v47, v121
    v_mfma_f32_16x16x32_bf16 v[148:151], a[244:247], a[28:31], v[148:151]
    v_mul_f32 v122, v47, v122
    v_mul_f32 v123, v47, v123
    v_cvt_pk_bf16_f32 v70, v120, v121
    v_mfma_f32_16x16x32_bf16 v[136:139], a[248:251], a[32:35], v[136:139]
    v_cvt_pk_bf16_f32 v71, v122, v123
    v_mfma_f32_16x16x32_bf16 v[140:143], a[248:251], a[36:39], v[140:143]
    s_mov_b32 s21, 8192
    buffer_store_dwordx4 v[68:71], v39, s[44:47], s21 offen sc1
    v_mfma_f32_16x16x32_bf16 v[144:147], a[248:251], a[40:43], v[144:147]
    v_mul_f32 v124, v48, v124
    v_mfma_f32_16x16x32_bf16 v[148:151], a[248:251], a[44:47], v[148:151]
    v_mul_f32 v125, v48, v125
    v_mul_f32 v126, v48, v126
    v_mul_f32 v127, v48, v127
    v_mfma_f32_16x16x32_bf16 v[136:139], a[252:255], a[48:51], v[136:139]
    v_cvt_pk_bf16_f32 v72, v124, v125
    v_cvt_pk_bf16_f32 v73, v126, v127
    v_mfma_f32_16x16x32_bf16 v[140:143], a[252:255], a[52:55], v[140:143]
    v_mul_f32 v128, v49, v128
    v_mul_f32 v129, v49, v129
    v_mul_f32 v130, v49, v130
    v_mfma_f32_16x16x32_bf16 v[144:147], a[252:255], a[56:59], v[144:147]
    v_mul_f32 v131, v49, v131
    v_cvt_pk_bf16_f32 v74, v128, v129
    v_cvt_pk_bf16_f32 v75, v130, v131
    v_mfma_f32_16x16x32_bf16 v[148:151], a[252:255], a[60:63], v[148:151]
    s_waitcnt lgkmcnt(0)
    v_mfma_f32_16x16x32_bf16 v[136:139], a[208:211], a[64:67], v[136:139]
    buffer_store_dwordx4 v[72:75], v40, s[44:47], s21 offen sc1
    v_mfma_f32_16x16x32_bf16 v[140:143], a[208:211], a[68:71], v[140:143]
    s_waitcnt vmcnt(12)
    s_barrier
    v_mfma_f32_16x16x32_bf16 v[144:147], a[208:211], a[72:75], v[144:147]
    ds_read_b64_tr_b16 a[240:241], v25 offset:4096
    ds_read_b64_tr_b16 a[242:243], v25 offset:6144
    v_mfma_f32_16x16x32_bf16 v[148:151], a[208:211], a[76:79], v[148:151]
    ds_read_b64_tr_b16 a[244:245], v25 offset:8192
    s_lshl_b32 s20, s3, 13
    s_add_u32 m0, s20, 32768
    v_mfma_f32_16x16x32_bf16 v[136:139], a[212:215], a[80:83], v[136:139]
    ds_read_b64_tr_b16 a[246:247], v25 offset:10240
    buffer_load_dwordx4 v17, s[40:43], s75 offen  lds
    v_mfma_f32_16x16x32_bf16 v[140:143], a[212:215], a[84:87], v[140:143]
    ds_read_b64_tr_b16 a[248:249], v25 offset:24576
    ds_read_b64_tr_b16 a[250:251], v25 offset:26624
    v_mfma_f32_16x16x32_bf16 v[144:147], a[212:215], a[88:91], v[144:147]
    ds_read_b64_tr_b16 a[252:253], v25 offset:28672
    buffer_load_dwordx4 v18, s[40:43], s75 offen offset:1024  lds
    v_mfma_f32_16x16x32_bf16 v[148:151], a[212:215], a[92:95], v[148:151]
    ds_read_b64_tr_b16 a[254:255], v25 offset:30720
    buffer_load_dwordx4 v19, s[40:43], s75 offen offset:2048  lds
    v_mfma_f32_16x16x32_bf16 v[136:139], a[216:219], a[96:99], v[136:139]
    ds_read_b64_tr_b16 a[224:225], v26 offset:4096
    ds_read_b64_tr_b16 a[226:227], v26 offset:6144
    v_mfma_f32_16x16x32_bf16 v[140:143], a[216:219], a[100:103], v[140:143]
    ds_read_b64_tr_b16 a[228:229], v26 offset:8192
    buffer_load_dwordx4 v20, s[40:43], s75 offen offset:3072  lds
    v_mfma_f32_16x16x32_bf16 v[144:147], a[216:219], a[104:107], v[144:147]
    ds_read_b64_tr_b16 a[230:231], v26 offset:10240
    s_lshl_b32 s20, s3, 13
    s_add_u32 m0, s20, 36864
    s_add_u32 s91, s75, 28672
    v_mfma_f32_16x16x32_bf16 v[148:151], a[216:219], a[108:111], v[148:151]
    ds_read_b64_tr_b16 a[232:233], v26 offset:24576
    ds_read_b64_tr_b16 a[234:235], v26 offset:26624
    v_mfma_f32_16x16x32_bf16 v[136:139], a[220:223], a[112:115], v[136:139]
    ds_read_b64_tr_b16 a[236:237], v26 offset:28672
    buffer_load_dwordx4 v17, s[40:43], s91 offen  lds
    v_mfma_f32_16x16x32_bf16 v[140:143], a[220:223], a[116:119], v[140:143]
    ds_read_b64_tr_b16 a[238:239], v26 offset:30720
    buffer_load_dwordx4 v18, s[40:43], s91 offen offset:1024  lds
    v_mfma_f32_16x16x32_bf16 v[144:147], a[220:223], a[120:123], v[144:147]
    buffer_load_dwordx4 v19, s[40:43], s91 offen offset:2048  lds
    v_mfma_f32_16x16x32_bf16 v[148:151], a[220:223], a[124:127], v[148:151]
    buffer_load_dwordx4 v20, s[40:43], s91 offen offset:3072  lds
    s_waitcnt lgkmcnt(8)
    v_mfma_f32_16x16x32_bf16 v[156:159], a[240:243], a[0:3], 0
    v_mfma_f32_16x16x32_bf16 v[160:163], a[240:243], a[4:7], 0
    v_mfma_f32_16x16x32_bf16 v[164:167], a[240:243], a[8:11], 0
    v_mfma_f32_16x16x32_bf16 v[168:171], a[240:243], a[12:15], 0
    v_mfma_f32_16x16x32_bf16 v[156:159], a[244:247], a[16:19], v[156:159]
    v_mul_f32 v136, v46, v136
    v_mul_f32 v137, v46, v137
    v_mul_f32 v138, v46, v138
    v_mfma_f32_16x16x32_bf16 v[160:163], a[244:247], a[20:23], v[160:163]
    v_mul_f32 v139, v46, v139
    v_cvt_pk_bf16_f32 v80, v136, v137
    v_mfma_f32_16x16x32_bf16 v[164:167], a[244:247], a[24:27], v[164:167]
    v_cvt_pk_bf16_f32 v81, v138, v139
    v_mul_f32 v140, v47, v140
    v_mul_f32 v141, v47, v141
    v_mfma_f32_16x16x32_bf16 v[168:171], a[244:247], a[28:31], v[168:171]
    v_mul_f32 v142, v47, v142
    v_mul_f32 v143, v47, v143
    v_cvt_pk_bf16_f32 v82, v140, v141
    v_mfma_f32_16x16x32_bf16 v[156:159], a[248:251], a[32:35], v[156:159]
    v_cvt_pk_bf16_f32 v83, v142, v143
    v_mfma_f32_16x16x32_bf16 v[160:163], a[248:251], a[36:39], v[160:163]
    s_mov_b32 s21, 16384
    buffer_store_dwordx4 v[80:83], v39, s[44:47], s21 offen sc1
    v_mfma_f32_16x16x32_bf16 v[164:167], a[248:251], a[40:43], v[164:167]
    v_mul_f32 v144, v48, v144
    v_mfma_f32_16x16x32_bf16 v[168:171], a[248:251], a[44:47], v[168:171]
    v_mul_f32 v145, v48, v145
    v_mul_f32 v146, v48, v146
    v_mul_f32 v147, v48, v147
    v_mfma_f32_16x16x32_bf16 v[156:159], a[252:255], a[48:51], v[156:159]
    v_cvt_pk_bf16_f32 v84, v144, v145
    v_cvt_pk_bf16_f32 v85, v146, v147
    v_mfma_f32_16x16x32_bf16 v[160:163], a[252:255], a[52:55], v[160:163]
    v_mul_f32 v148, v49, v148
    v_mul_f32 v149, v49, v149
    v_mul_f32 v150, v49, v150
    v_mfma_f32_16x16x32_bf16 v[164:167], a[252:255], a[56:59], v[164:167]
    v_mul_f32 v151, v49, v151
    v_cvt_pk_bf16_f32 v86, v148, v149
    v_cvt_pk_bf16_f32 v87, v150, v151
    v_mfma_f32_16x16x32_bf16 v[168:171], a[252:255], a[60:63], v[168:171]
    s_waitcnt lgkmcnt(0)
    v_mfma_f32_16x16x32_bf16 v[156:159], a[224:227], a[64:67], v[156:159]
    buffer_store_dwordx4 v[84:87], v40, s[44:47], s21 offen sc1
    v_mfma_f32_16x16x32_bf16 v[160:163], a[224:227], a[68:71], v[160:163]
    s_waitcnt vmcnt(12)
    s_barrier
    v_mfma_f32_16x16x32_bf16 v[164:167], a[224:227], a[72:75], v[164:167]
    ds_read_b64_tr_b16 a[240:241], v25 offset:12288
    ds_read_b64_tr_b16 a[242:243], v25 offset:14336
    v_mfma_f32_16x16x32_bf16 v[168:171], a[224:227], a[76:79], v[168:171]
    ds_read_b64_tr_b16 a[244:245], v25 offset:16384
    s_add_u32 m0, s98, 4096
    v_mfma_f32_16x16x32_bf16 v[156:159], a[228:231], a[80:83], v[156:159]
    ds_read_b64_tr_b16 a[246:247], v25 offset:18432
    buffer_load_dwordx4 v17, s[40:43], s76 offen  lds
    v_mfma_f32_16x16x32_bf16 v[160:163], a[228:231], a[84:87], v[160:163]
    ds_read_b64_tr_b16 a[248:249], v25 offset:32768
    ds_read_b64_tr_b16 a[250:251], v25 offset:34816
    v_mfma_f32_16x16x32_bf16 v[164:167], a[228:231], a[88:91], v[164:167]
    ds_read_b64_tr_b16 a[252:253], v25 offset:36864
    buffer_load_dwordx4 v18, s[40:43], s76 offen offset:1024  lds
    v_mfma_f32_16x16x32_bf16 v[168:171], a[228:231], a[92:95], v[168:171]
    ds_read_b64_tr_b16 a[254:255], v25 offset:38912
    buffer_load_dwordx4 v19, s[40:43], s76 offen offset:2048  lds
    v_mfma_f32_16x16x32_bf16 v[156:159], a[232:235], a[96:99], v[156:159]
    ds_read_b64_tr_b16 a[208:209], v26 offset:12288
    ds_read_b64_tr_b16 a[210:211], v26 offset:14336
    v_mfma_f32_16x16x32_bf16 v[160:163], a[232:235], a[100:103], v[160:163]
    ds_read_b64_tr_b16 a[212:213], v26 offset:16384
    buffer_load_dwordx4 v20, s[40:43], s76 offen offset:3072  lds
    v_mfma_f32_16x16x32_bf16 v[164:167], a[232:235], a[104:107], v[164:167]
    ds_read_b64_tr_b16 a[214:215], v26 offset:18432
    s_add_u32 m0, s98, 8192
    s_add_u32 s91, s76, 28672
    v_mfma_f32_16x16x32_bf16 v[168:171], a[232:235], a[108:111], v[168:171]
    ds_read_b64_tr_b16 a[216:217], v26 offset:32768
    ds_read_b64_tr_b16 a[218:219], v26 offset:34816
    v_mfma_f32_16x16x32_bf16 v[156:159], a[236:239], a[112:115], v[156:159]
    ds_read_b64_tr_b16 a[220:221], v26 offset:36864
    buffer_load_dwordx4 v17, s[40:43], s91 offen  lds
    v_mfma_f32_16x16x32_bf16 v[160:163], a[236:239], a[116:119], v[160:163]
    ds_read_b64_tr_b16 a[222:223], v26 offset:38912
    buffer_load_dwordx4 v18, s[40:43], s91 offen offset:1024  lds
    v_mfma_f32_16x16x32_bf16 v[164:167], a[236:239], a[120:123], v[164:167]
    buffer_load_dwordx4 v19, s[40:43], s91 offen offset:2048  lds
    v_mfma_f32_16x16x32_bf16 v[168:171], a[236:239], a[124:127], v[168:171]
    buffer_load_dwordx4 v20, s[40:43], s91 offen offset:3072  lds
    s_waitcnt lgkmcnt(8)
    v_mfma_f32_16x16x32_bf16 v[176:179], a[240:243], a[0:3], 0
    v_mfma_f32_16x16x32_bf16 v[180:183], a[240:243], a[4:7], 0
    v_mfma_f32_16x16x32_bf16 v[184:187], a[240:243], a[8:11], 0
    s_xor_b32 s51, s19, 1
    v_mfma_f32_16x16x32_bf16 v[188:191], a[240:243], a[12:15], 0
    s_mul_i32 s51, s51, 7
    v_mfma_f32_16x16x32_bf16 v[176:179], a[244:247], a[16:19], v[176:179]
    s_lshr_b32 s50, s51, 4
    v_readfirstlane_b32 s22, v30
    s_nop 1
    s_cmp_ge_u32 s22, 32
    s_cbranch_scc0 L_cnt4
L_cntok4:
    v_mfma_f32_16x16x32_bf16 v[180:183], a[244:247], a[20:23], v[180:183]
    s_mov_b64 exec, 0x3
    buffer_atomic_or v34, v2, s[80:83], 0 offen sc1
    s_mov_b64 exec, -1
    v_mfma_f32_16x16x32_bf16 v[184:187], a[244:247], a[24:27], v[184:187]
    s_lshr_b32 s48, s8, 1
    v_mul_f32 v156, v46, v156
    v_mul_f32 v157, v46, v157
    v_mul_f32 v158, v46, v158
    v_mfma_f32_16x16x32_bf16 v[188:191], a[244:247], a[28:31], v[188:191]
    s_and_b32 s49, s8, 1
    v_mul_f32 v159, v46, v159
    v_cvt_pk_bf16_f32 v56, v156, v157
    v_cvt_pk_bf16_f32 v57, v158, v159
    v_mfma_f32_16x16x32_bf16 v[176:179], a[248:251], a[32:35], v[176:179]
    s_mul_i32 s79, s49, 28672
    v_mul_f32 v160, v47, v160
    v_mul_f32 v161, v47, v161
    v_mul_f32 v162, v47, v162
    v_mfma_f32_16x16x32_bf16 v[180:183], a[248:251], a[36:39], v[180:183]
    s_add_u32 s48, s48, 1
    v_mul_f32 v163, v47, v163
    v_cvt_pk_bf16_f32 v58, v160, v161
    v_cvt_pk_bf16_f32 v59, v162, v163
    v_mfma_f32_16x16x32_bf16 v[184:187], a[248:251], a[40:43], v[184:187]
    s_mov_b32 s21, 24576
    buffer_store_dwordx4 v[56:59], v39, s[44:47], s21 offen sc1
    v_mfma_f32_16x16x32_bf16 v[188:191], a[248:251], a[44:47], v[188:191]
    s_lshl_b32 s51, s8, 1
    s_max_u32 s51, s51, 25
    s_sub_u32 s51, s51, 25
    v_mul_f32 v164, v48, v164
    v_mfma_f32_16x16x32_bf16 v[176:179], a[252:255], a[48:51], v[176:179]
    s_cmp_ge_u32 s8, 12
    s_cselect_b32 s48, s51, s48
    s_cselect_b32 s79, 57344, s79
    v_mul_f32 v165, v48, v165
    v_mul_f32 v166, v48, v166
    v_mul_f32 v167, v48, v167
    v_mfma_f32_16x16x32_bf16 v[180:183], a[252:255], a[52:55], v[180:183]
    v_cvt_pk_bf16_f32 v60, v164, v165
    v_cvt_pk_bf16_f32 v61, v166, v167
    v_mul_f32 v168, v49, v168
    v_mfma_f32_16x16x32_bf16 v[184:187], a[252:255], a[56:59], v[184:187]
    v_mul_f32 v169, v49, v169
    v_mul_f32 v170, v49, v170
    v_mul_f32 v171, v49, v171
    v_cvt_pk_bf16_f32 v62, v168, v169
    v_mfma_f32_16x16x32_bf16 v[188:191], a[252:255], a[60:63], v[188:191]
    s_add_u32 s48, s48, s50
    s_cmp_ge_u32 s48, 7
    s_cselect_b32 s52, 7, 0
    v_cvt_pk_bf16_f32 v63, v170, v171
    s_waitcnt lgkmcnt(0)
    v_mfma_f32_16x16x32_bf16 v[176:179], a[208:211], a[64:67], v[176:179]
    buffer_store_dwordx4 v[60:63], v40, s[44:47], s21 offen sc1
    v_mfma_f32_16x16x32_bf16 v[180:183], a[208:211], a[68:71], v[180:183]
    s_waitcnt vmcnt(13)
    s_barrier
    v_mfma_f32_16x16x32_bf16 v[184:187], a[208:211], a[72:75], v[184:187]
    ds_read_b64_tr_b16 a[240:241], v27 offset:0
    ds_read_b64_tr_b16 a[242:243], v27 offset:2048
    s_sub_u32 s48, s48, s52
    v_mfma_f32_16x16x32_bf16 v[188:191], a[208:211], a[76:79], v[188:191]
    ds_read_b64_tr_b16 a[244:245], v27 offset:4096
    s_lshl_b32 s52, s48, 7
    v_mfma_f32_16x16x32_bf16 v[176:179], a[212:215], a[80:83], v[176:179]
    ds_read_b64_tr_b16 a[246:247], v27 offset:6144
    s_add_u32 s79, s79, s52
    s_add_u32 s78, s79, 14336
    v_mfma_f32_16x16x32_bf16 v[180:183], a[212:215], a[84:87], v[180:183]
    ds_read_b64_tr_b16 a[248:249], v27 offset:8192
    ds_read_b64_tr_b16 a[250:251], v27 offset:10240
    v_mfma_f32_16x16x32_bf16 v[184:187], a[212:215], a[88:91], v[184:187]
    ds_read_b64_tr_b16 a[252:253], v27 offset:12288
    s_cmp_eq_u32 s48, 6
    s_cselect_b32 s52, 896, 0
    v_mfma_f32_16x16x32_bf16 v[188:191], a[212:215], a[92:95], v[188:191]
    ds_read_b64_tr_b16 a[254:255], v27 offset:14336
    s_add_u32 s51, s79, 128
    s_sub_u32 s51, s51, s52
    v_mfma_f32_16x16x32_bf16 v[176:179], a[216:219], a[96:99], v[176:179]
    ds_read_b64_tr_b16 a[224:225], v27 offset:16384
    ds_read_b64_tr_b16 a[226:227], v27 offset:18432
    v_mfma_f32_16x16x32_bf16 v[180:183], a[216:219], a[100:103], v[180:183]
    ds_read_b64_tr_b16 a[228:229], v27 offset:20480
    s_cmp_ge_u32 s8, 12
    s_cselect_b32 s78, s51, s78
    v_mfma_f32_16x16x32_bf16 v[184:187], a[216:219], a[104:107], v[184:187]
    ds_read_b64_tr_b16 a[230:231], v27 offset:22528
    s_cmp_eq_u32 s8, 12
    s_cselect_b32 s78, 0x40000000, s78
    v_mfma_f32_16x16x32_bf16 v[188:191], a[216:219], a[108:111], v[188:191]
    ds_read_b64_tr_b16 a[232:233], v27 offset:24576
    ds_read_b64_tr_b16 a[234:235], v27 offset:26624
    s_add_u32 s51, s8, 16
    v_mfma_f32_16x16x32_bf16 v[176:179], a[220:223], a[112:115], v[176:179]
    ds_read_b64_tr_b16 a[236:237], v27 offset:28672
    s_lshl_b32 s51, s51, 12
    v_mfma_f32_16x16x32_bf16 v[180:183], a[220:223], a[116:119], v[180:183]
    ds_read_b64_tr_b16 a[238:239], v27 offset:30720
    s_lshl_b32 s49, s3, 5
    v_mfma_f32_16x16x32_bf16 v[184:187], a[220:223], a[120:123], v[184:187]
    s_mov_b32 s77, 0xffff
    v_mfma_f32_16x16x32_bf16 v[188:191], a[220:223], a[124:127], v[188:191]
    s_waitcnt lgkmcnt(8)
    v_mfma_f32_16x16x32_bf16 v[196:199], a[240:243], a[0:3], 0
    v_add_u32 v3, s51, v39
    v_mfma_f32_16x16x32_bf16 v[200:203], a[240:243], a[4:7], 0
    v_and_b32 v13, 15, v0
    v_mfma_f32_16x16x32_bf16 v[204:207], a[240:243], a[8:11], 0
    v_mul_u32_u24 v13, 896, v13
    v_lshrrev_b32 v14, 4, v0
    v_mfma_f32_16x16x32_bf16 v[208:211], a[240:243], a[12:15], 0
    v_lshl_add_u32 v13, v14, 3, v13
    v_mfma_f32_16x16x32_bf16 v[196:199], a[244:247], a[16:19], v[196:199]
    s_mov_b64 exec, 0xc
    buffer_atomic_or v34, v2, s[80:83], 0 offen sc1
    s_mov_b64 exec, -1
    v_mfma_f32_16x16x32_bf16 v[200:203], a[244:247], a[20:23], v[200:203]
    v_mul_f32 v176, v46, v176
    v_mul_f32 v177, v46, v177
    v_mfma_f32_16x16x32_bf16 v[204:207], a[244:247], a[24:27], v[204:207]
    v_mul_f32 v178, v46, v178
    v_mul_f32 v179, v46, v179
    v_cvt_pk_bf16_f32 v68, v176, v177
    v_mfma_f32_16x16x32_bf16 v[208:211], a[244:247], a[28:31], v[208:211]
    v_cvt_pk_bf16_f32 v69, v178, v179
    v_mul_f32 v180, v47, v180
    v_mul_f32 v181, v47, v181
    v_mfma_f32_16x16x32_bf16 v[196:199], a[248:251], a[32:35], v[196:199]
    v_mul_f32 v182, v47, v182
    v_mul_f32 v183, v47, v183
    v_cvt_pk_bf16_f32 v70, v180, v181
    v_mfma_f32_16x16x32_bf16 v[200:203], a[248:251], a[36:39], v[200:203]
    v_cvt_pk_bf16_f32 v71, v182, v183
    v_mfma_f32_16x16x32_bf16 v[204:207], a[248:251], a[40:43], v[204:207]
    s_mov_b32 s21, 32768
    buffer_store_dwordx4 v[68:71], v39, s[44:47], s21 offen sc1
    v_mfma_f32_16x16x32_bf16 v[208:211], a[248:251], a[44:47], v[208:211]
    v_mul_f32 v184, v48, v184
    v_mul_f32 v185, v48, v185
    v_mfma_f32_16x16x32_bf16 v[196:199], a[252:255], a[48:51], v[196:199]
    v_mul_f32 v186, v48, v186
    v_mul_f32 v187, v48, v187
    v_cvt_pk_bf16_f32 v72, v184, v185
    v_mfma_f32_16x16x32_bf16 v[200:203], a[252:255], a[52:55], v[200:203]
    v_cvt_pk_bf16_f32 v73, v186, v187
    v_mul_f32 v188, v49, v188
    v_mul_f32 v189, v49, v189
    v_mfma_f32_16x16x32_bf16 v[204:207], a[252:255], a[56:59], v[204:207]
    v_mul_f32 v190, v49, v190
    v_mul_f32 v191, v49, v191
    v_cvt_pk_bf16_f32 v74, v188, v189
    v_mfma_f32_16x16x32_bf16 v[208:211], a[252:255], a[60:63], v[208:211]
    v_cvt_pk_bf16_f32 v75, v190, v191
    s_waitcnt lgkmcnt(0)
    v_mfma_f32_16x16x32_bf16 v[196:199], a[224:227], a[64:67], v[196:199]
    buffer_store_dwordx4 v[72:75], v40, s[44:47], s21 offen sc1
    v_mfma_f32_16x16x32_bf16 v[200:203], a[224:227], a[68:71], v[200:203]
    s_waitcnt vmcnt(6)
    s_barrier
    v_mfma_f32_16x16x32_bf16 v[204:207], a[224:227], a[72:75], v[204:207]
    ds_read_b64_tr_b16 a[240:241], v25 offset:4096
    ds_read_b64_tr_b16 a[242:243], v25 offset:6144
    v_mfma_f32_16x16x32_bf16 v[208:211], a[224:227], a[76:79], v[208:211]
    ds_read_b64_tr_b16 a[244:245], v25 offset:8192
    v_mfma_f32_16x16x32_bf16 v[196:199], a[228:231], a[80:83], v[196:199]
    ds_read_b64_tr_b16 a[246:247], v25 offset:10240
    v_add_u32 v28, s49, v13
    v_mfma_f32_16x16x32_bf16 v[200:203], a[228:231], a[84:87], v[200:203]
    ds_read_b64_tr_b16 a[248:249], v25 offset:24576
    ds_read_b64_tr_b16 a[250:251], v25 offset:26624
    v_mfma_f32_16x16x32_bf16 v[204:207], a[228:231], a[88:91], v[204:207]
    ds_read_b64_tr_b16 a[252:253], v25 offset:28672
    v_mfma_f32_16x16x32_bf16 v[208:211], a[228:231], a[92:95], v[208:211]
    ds_read_b64_tr_b16 a[254:255], v25 offset:30720
    v_mfma_f32_16x16x32_bf16 v[196:199], a[232:235], a[96:99], v[196:199]
    ds_read_b64_tr_b16 a[208:209], v26 offset:4096
    ds_read_b64_tr_b16 a[210:211], v26 offset:6144
    v_mfma_f32_16x16x32_bf16 v[200:203], a[232:235], a[100:103], v[200:203]
    ds_read_b64_tr_b16 a[212:213], v26 offset:8192
    v_mfma_f32_16x16x32_bf16 v[204:207], a[232:235], a[104:107], v[204:207]
    ds_read_b64_tr_b16 a[214:215], v26 offset:10240
    v_mfma_f32_16x16x32_bf16 v[208:211], a[232:235], a[108:111], v[208:211]
    ds_read_b64_tr_b16 a[216:217], v26 offset:24576
    ds_read_b64_tr_b16 a[218:219], v26 offset:26624
    v_mfma_f32_16x16x32_bf16 v[196:199], a[236:239], a[112:115], v[196:199]
    ds_read_b64_tr_b16 a[220:221], v26 offset:28672
    v_mfma_f32_16x16x32_bf16 v[200:203], a[236:239], a[116:119], v[200:203]
    ds_read_b64_tr_b16 a[222:223], v26 offset:30720
    v_mfma_f32_16x16x32_bf16 v[204:207], a[236:239], a[120:123], v[204:207]
    v_mfma_f32_16x16x32_bf16 v[208:211], a[236:239], a[124:127], v[208:211]
    v_mov_b32 v31, 0
    s_waitcnt lgkmcnt(9)
    v_mfma_f32_16x16x32_bf16 v[216:219], a[240:243], a[0:3], 0
    buffer_atomic_or v31, v1, s[80:83], 0 offen sc0 sc1
    v_mfma_f32_16x16x32_bf16 v[216:219], a[244:247], a[16:19], v[216:219]
    v_mfma_f32_16x16x32_bf16 v[216:219], a[248:251], a[32:35], v[216:219]
    s_waitcnt lgkmcnt(6)
    v_mfma_f32_16x16x32_bf16 v[216:219], a[252:255], a[48:51], v[216:219]
    v_mfma_f32_16x16x32_bf16 v[216:219], a[208:211], a[64:67], v[216:219]
    s_mov_b64 exec, 0x30
    buffer_atomic_or v34, v2, s[80:83], 0 offen sc1
    s_mov_b64 exec, -1
    s_waitcnt lgkmcnt(4)
    v_mfma_f32_16x16x32_bf16 v[216:219], a[212:215], a[80:83], v[216:219]
    v_mul_f32 v196, v46, v196
    v_mul_f32 v197, v46, v197
    v_mul_f32 v198, v46, v198
    s_waitcnt lgkmcnt(2)
    v_mfma_f32_16x16x32_bf16 v[216:219], a[216:219], a[96:99], v[216:219]
    v_mul_f32 v199, v46, v199
    v_cvt_pk_bf16_f32 v80, v196, v197
    v_cvt_pk_bf16_f32 v81, v198, v199
    s_waitcnt lgkmcnt(0)
    v_mfma_f32_16x16x32_bf16 v[216:219], a[220:223], a[112:115], v[216:219]
    v_mul_f32 v200, v47, v200
    v_mul_f32 v201, v47, v201
    v_mul_f32 v202, v47, v202
    v_mfma_f32_16x16x32_bf16 v[220:223], a[240:243], a[4:7], 0
    v_mul_f32 v203, v47, v203
    v_cvt_pk_bf16_f32 v82, v200, v201
    v_cvt_pk_bf16_f32 v83, v202, v203
    v_mfma_f32_16x16x32_bf16 v[220:223], a[244:247], a[20:23], v[220:223]
    s_mov_b32 s21, 40960
    buffer_store_dwordx4 v[80:83], v39, s[44:47], s21 offen sc1
    v_mfma_f32_16x16x32_bf16 v[220:223], a[248:251], a[36:39], v[220:223]
    v_mul_f32 v204, v48, v204
    v_mfma_f32_16x16x32_bf16 v[220:223], a[252:255], a[52:55], v[220:223]
    v_mul_f32 v205, v48, v205
    v_mul_f32 v206, v48, v206
    v_mul_f32 v207, v48, v207
    v_mfma_f32_16x16x32_bf16 v[220:223], a[208:211], a[68:71], v[220:223]
    v_cvt_pk_bf16_f32 v84, v204, v205
    v_cvt_pk_bf16_f32 v85, v206, v207
    v_mul_f32 v208, v49, v208
    v_mfma_f32_16x16x32_bf16 v[220:223], a[212:215], a[84:87], v[220:223]
    v_mul_f32 v209, v49, v209
    v_mul_f32 v210, v49, v210
    v_mul_f32 v211, v49, v211
    v_cvt_pk_bf16_f32 v86, v208, v209
    v_mfma_f32_16x16x32_bf16 v[220:223], a[216:219], a[100:103], v[220:223]
    v_cvt_pk_bf16_f32 v87, v210, v211
    v_mfma_f32_16x16x32_bf16 v[220:223], a[220:223], a[116:119], v[220:223]
    buffer_store_dwordx4 v[84:87], v40, s[44:47], s21 offen sc1
    v_mfma_f32_16x16x32_bf16 v[224:227], a[240:243], a[8:11], 0
    s_waitcnt vmcnt(7)
    s_mov_b64 exec, 0xc0
    buffer_atomic_or v34, v2, s[80:83], 0 offen sc1
    s_mov_b64 exec, -1
    v_mfma_f32_16x16x32_bf16 v[224:227], a[244:247], a[24:27], v[224:227]
    v_mul_f32 v216, v46, v216
    v_mul_f32 v217, v46, v217
    v_mul_f32 v218, v46, v218
    v_mfma_f32_16x16x32_bf16 v[224:227], a[248:251], a[40:43], v[224:227]
    v_mul_f32 v219, v46, v219
    v_cvt_pk_bf16_f32 v56, v216, v217
    v_cvt_pk_bf16_f32 v57, v218, v219
    v_mfma_f32_16x16x32_bf16 v[224:227], a[252:255], a[56:59], v[224:227]
    v_mfma_f32_16x16x32_bf16 v[224:227], a[208:211], a[72:75], v[224:227]
    v_mul_f32 v220, v47, v220
    v_mul_f32 v221, v47, v221
    v_mul_f32 v222, v47, v222
    v_mul_f32 v223, v47, v223
    v_mfma_f32_16x16x32_bf16 v[224:227], a[212:215], a[88:91], v[224:227]
    v_cvt_pk_bf16_f32 v58, v220, v221
    v_cvt_pk_bf16_f32 v59, v222, v223
    v_mfma_f32_16x16x32_bf16 v[224:227], a[216:219], a[104:107], v[224:227]
    s_mov_b32 s21, 49152
    buffer_store_dwordx4 v[56:59], v39, s[44:47], s21 offen sc1
    v_mfma_f32_16x16x32_bf16 v[224:227], a[220:223], a[120:123], v[224:227]
    v_mfma_f32_16x16x32_bf16 v[228:231], a[240:243], a[12:15], 0
    v_mfma_f32_16x16x32_bf16 v[228:231], a[244:247], a[28:31], v[228:231]
    v_mfma_f32_16x16x32_bf16 v[228:231], a[248:251], a[44:47], v[228:231]
    v_mfma_f32_16x16x32_bf16 v[228:231], a[252:255], a[60:63], v[228:231]
    v_mfma_f32_16x16x32_bf16 v[228:231], a[208:211], a[76:79], v[228:231]
    s_nop 2
    v_mul_f32 v224, v48, v224
    v_mul_f32 v225, v48, v225
    v_mfma_f32_16x16x32_bf16 v[228:231], a[212:215], a[92:95], v[228:231]
    v_mul_f32 v226, v48, v226
    v_mul_f32 v227, v48, v227
    v_mfma_f32_16x16x32_bf16 v[228:231], a[216:219], a[108:111], v[228:231]
    v_cvt_pk_bf16_f32 v60, v224, v225
    v_cvt_pk_bf16_f32 v61, v226, v227
    v_mfma_f32_16x16x32_bf16 v[228:231], a[220:223], a[124:127], v[228:231]
    s_nop 7
    v_mul_f32 v228, v49, v228
    v_mul_f32 v229, v49, v229
    v_mul_f32 v230, v49, v230
    v_mul_f32 v231, v49, v231
    v_cvt_pk_bf16_f32 v62, v228, v229
    v_cvt_pk_bf16_f32 v63, v230, v231
    buffer_store_dwordx4 v[60:63], v40, s[44:47], s21 offen sc1
    s_mul_i32 s20, s16, 2129920
    s_add_u32 s24, s14, s20
    s_addc_u32 s25, s15, 0
    s_mov_b32 s26, 2129920
    s_mov_b32 s27, 0x20000
    s_waitcnt vmcnt(6)
    v_readfirstlane_b32 s22, v31
    s_nop 1
    s_cmp_eq_u32 s22, s77
    s_cbranch_scc0 L_slow4
    s_mov_b32 s21, 0
    buffer_load_dwordx4 v[96:99], v3, s[24:27], s21 offen sc1
    s_mov_b32 s21, 133120
    buffer_load_dwordx4 v[100:103], v3, s[24:27], s21 offen sc1
    s_mov_b32 s21, 266240
    buffer_load_dwordx4 v[104:107], v3, s[24:27], s21 offen sc1
    s_mov_b32 s21, 399360
    buffer_load_dwordx4 v[108:111], v3, s[24:27], s21 offen sc1
    s_waitcnt vmcnt(4)
    s_mov_b64 exec, 0x3f00
    buffer_atomic_or v34, v2, s[80:83], 0 offen sc1
    s_mov_b64 exec, -1
    s_branch L_join4
L_slow4:
    v_mov_b32 v31, 0
    buffer_atomic_or v31, v1, s[80:83], 0 offen sc0 sc1
    s_mov_b32 s20, 0
    s_waitcnt vmcnt(1)
    s_mov_b64 exec, 0x3f00
    buffer_atomic_or v34, v2, s[80:83], 0 offen sc1
    s_mov_b64 exec, -1
    s_waitcnt vmcnt(1)
    s_branch L_got4
L_poll4:
    s_sleep 1
    v_mov_b32 v31, 0
    buffer_atomic_or v31, v1, s[80:83], 0 offen sc0 sc1
    s_waitcnt vmcnt(0)
L_got4:
    v_readfirstlane_b32 s22, v31
    s_add_u32 s20, s20, 1
    s_cmp_ge_u32 s20, 400000
    s_cselect_b32 s22, s77, s22
    s_cmp_eq_u32 s22, s77
    s_cbranch_scc0 L_poll4
    s_mov_b32 s21, 0
    buffer_load_dwordx4 v[96:99], v3, s[24:27], s21 offen sc1
    s_mov_b32 s21, 133120
    buffer_load_dwordx4 v[100:103], v3, s[24:27], s21 offen sc1
    s_mov_b32 s21, 266240
    buffer_load_dwordx4 v[104:107], v3, s[24:27], s21 offen sc1
    s_mov_b32 s21, 399360
    buffer_load_dwordx4 v[108:111], v3, s[24:27], s21 offen sc1
L_join4:
    s_mov_b32 s21, 532480
    buffer_load_dwordx4 v[112:115], v3, s[24:27], s21 offen sc1
    s_mov_b32 s21, 665600
    buffer_load_dwordx4 v[116:119], v3, s[24:27], s21 offen sc1
    s_mov_b32 s21, 798720
    buffer_load_dwordx4 v[120:123], v3, s[24:27], s21 offen sc1
    s_mov_b32 s21, 931840
    buffer_load_dwordx4 v[124:127], v3, s[24:27], s21 offen sc1
    s_mov_b32 s21, 1064960
    buffer_load_dwordx4 v[128:131], v3, s[24:27], s21 offen sc1
    s_mov_b32 s21, 1198080
    buffer_load_dwordx4 v[132:135], v3, s[24:27], s21 offen sc1
    s_mov_b32 s21, 1331200
    buffer_load_dwordx4 v[136:139], v3, s[24:27], s21 offen sc1
    s_mov_b32 s21, 1464320
    buffer_load_dwordx4 v[140:143], v3, s[24:27], s21 offen sc1
    s_mov_b32 s21, 1597440
    buffer_load_dwordx4 v[144:147], v3, s[24:27], s21 offen sc1
    s_mov_b32 s21, 1730560
    buffer_load_dwordx4 v[148:151], v3, s[24:27], s21 offen sc1
    s_mov_b32 s21, 1863680
    buffer_load_dwordx4 v[152:155], v3, s[24:27], s21 offen sc1
    s_mov_b32 s21, 1996800
    buffer_load_dwordx4 v[156:159], v3, s[24:27], s21 offen sc1
    s_mul_i32 s20, s16, 129024
    s_add_u32 s28, s88, s20
    s_addc_u32 s29, s89, 0
    s_mov_b32 s30, 129024
    s_mov_b32 s31, 0x20000
    s_mov_b32 s22, 0xffff0000
    s_waitcnt vmcnt(15)
    v_lshlrev_b32 v240, 16, v96
    v_and_b32 v241, s22, v96
    v_lshlrev_b32 v242, 16, v97
    v_and_b32 v243, s22, v97
    v_lshlrev_b32 v244, 16, v98
    v_and_b32 v245, s22, v98
    v_lshlrev_b32 v246, 16, v99
    v_and_b32 v247, s22, v99
    s_waitcnt vmcnt(14)
    v_lshlrev_b32 v248, 16, v100
    v_and_b32 v249, s22, v100
    v_pk_add_f32 v[240:241], v[240:241], v[248:249]
    v_lshlrev_b32 v250, 16, v101
    v_and_b32 v251, s22, v101
    v_pk_add_f32 v[242:243], v[242:243], v[250:251]
    v_lshlrev_b32 v248, 16, v102
    v_and_b32 v249, s22, v102
    v_pk_add_f32 v[244:245], v[244:245], v[248:249]
    v_lshlrev_b32 v250, 16, v103
    v_and_b32 v251, s22, v103
    v_pk_add_f32 v[246:247], v[246:247], v[250:251]
    s_waitcnt vmcnt(13)
    v_lshlrev_b32 v248, 16, v104
    v_and_b32 v249, s22, v104
    v_pk_add_f32 v[240:241], v[240:241], v[248:249]
    v_lshlrev_b32 v250, 16, v105
    v_and_b32 v251, s22, v105
    v_pk_add_f32 v[242:243], v[242:243], v[250:251]
    v_lshlrev_b32 v248, 16, v106
    v_and_b32 v249, s22, v106
    v_pk_add_f32 v[244:245], v[244:245], v[248:249]
    v_lshlrev_b32 v250, 16, v107
    v_and_b32 v251, s22, v107
    v_pk_add_f32 v[246:247], v[246:247], v[250:251]
    s_waitcnt vmcnt(12)
    v_lshlrev_b32 v248, 16, v108
    v_and_b32 v249, s22, v108
    v_pk_add_f32 v[240:241], v[240:241], v[248:249]
    v_lshlrev_b32 v250, 16, v109
    v_and_b32 v251, s22, v109
    v_pk_add_f32 v[242:243], v[242:243], v[250:251]
    v_lshlrev_b32 v248, 16, v110
    v_and_b32 v249, s22, v110
    v_pk_add_f32 v[244:245], v[244:245], v[248:249]
    v_lshlrev_b32 v250, 16, v111
    v_and_b32 v251, s22, v111
    v_pk_add_f32 v[246:247], v[246:247], v[250:251]
    s_waitcnt vmcnt(11)
    v_lshlrev_b32 v248, 16, v112
    v_and_b32 v249, s22, v112
    v_pk_add_f32 v[240:241], v[240:241], v[248:249]
    v_lshlrev_b32 v250, 16, v113
    v_and_b32 v251, s22, v113
    v_pk_add_f32 v[242:243], v[242:243], v[250:251]
    v_lshlrev_b32 v248, 16, v114
    v_and_b32 v249, s22, v114
    v_pk_add_f32 v[244:245], v[244:245], v[248:249]
    v_lshlrev_b32 v250, 16, v115
    v_and_b32 v251, s22, v115
    v_pk_add_f32 v[246:247], v[246:247], v[250:251]
    s_waitcnt vmcnt(10)
    v_lshlrev_b32 v248, 16, v116
    v_and_b32 v249, s22, v116
    v_pk_add_f32 v[240:241], v[240:241], v[248:249]
    v_lshlrev_b32 v250, 16, v117
    v_and_b32 v251, s22, v117
    v_pk_add_f32 v[242:243], v[242:243], v[250:251]
    v_lshlrev_b32 v248, 16, v118
    v_and_b32 v249, s22, v118
    v_pk_add_f32 v[244:245], v[244:245], v[248:249]
    v_lshlrev_b32 v250, 16, v119
    v_and_b32 v251, s22, v119
    v_pk_add_f32 v[246:247], v[246:247], v[250:251]
    s_waitcnt vmcnt(9)
    v_lshlrev_b32 v248, 16, v120
    v_and_b32 v249, s22, v120
    v_pk_add_f32 v[240:241], v[240:241], v[248:249]
    v_lshlrev_b32 v250, 16, v121
    v_and_b32 v251, s22, v121
    v_pk_add_f32 v[242:243], v[242:243], v[250:251]
    v_lshlrev_b32 v248, 16, v122
    v_and_b32 v249, s22, v122
    v_pk_add_f32 v[244:245], v[244:245], v[248:249]
    v_lshlrev_b32 v250, 16, v123
    v_and_b32 v251, s22, v123
    v_pk_add_f32 v[246:247], v[246:247], v[250:251]
    s_waitcnt vmcnt(8)
    v_lshlrev_b32 v248, 16, v124
    v_and_b32 v249, s22, v124
    v_pk_add_f32 v[240:241], v[240:241], v[248:249]
    v_lshlrev_b32 v250, 16, v125
    v_and_b32 v251, s22, v125
    v_pk_add_f32 v[242:243], v[242:243], v[250:251]
    v_lshlrev_b32 v248, 16, v126
    v_and_b32 v249, s22, v126
    v_pk_add_f32 v[244:245], v[244:245], v[248:249]
    v_lshlrev_b32 v250, 16, v127
    v_and_b32 v251, s22, v127
    v_pk_add_f32 v[246:247], v[246:247], v[250:251]
    s_waitcnt vmcnt(7)
    v_lshlrev_b32 v248, 16, v128
    v_and_b32 v249, s22, v128
    v_pk_add_f32 v[240:241], v[240:241], v[248:249]
    v_lshlrev_b32 v250, 16, v129
    v_and_b32 v251, s22, v129
    v_pk_add_f32 v[242:243], v[242:243], v[250:251]
    v_lshlrev_b32 v248, 16, v130
    v_and_b32 v249, s22, v130
    v_pk_add_f32 v[244:245], v[244:245], v[248:249]
    v_lshlrev_b32 v250, 16, v131
    v_and_b32 v251, s22, v131
    v_pk_add_f32 v[246:247], v[246:247], v[250:251]
    s_waitcnt vmcnt(6)
    v_lshlrev_b32 v248, 16, v132
    v_and_b32 v249, s22, v132
    v_pk_add_f32 v[240:241], v[240:241], v[248:249]
    v_lshlrev_b32 v250, 16, v133
    v_and_b32 v251, s22, v133
    v_pk_add_f32 v[242:243], v[242:243], v[250:251]
    v_lshlrev_b32 v248, 16, v134
    v_and_b32 v249, s22, v134
    v_pk_add_f32 v[244:245], v[244:245], v[248:249]
    v_lshlrev_b32 v250, 16, v135
    v_and_b32 v251, s22, v135
    v_pk_add_f32 v[246:247], v[246:247], v[250:251]
    s_waitcnt vmcnt(5)
    v_lshlrev_b32 v248, 16, v136
    v_and_b32 v249, s22, v136
    v_pk_add_f32 v[240:241], v[240:241], v[248:249]
    v_lshlrev_b32 v250, 16, v137
    v_and_b32 v251, s22, v137
    v_pk_add_f32 v[242:243], v[242:243], v[250:251]
    v_lshlrev_b32 v248, 16, v138
    v_and_b32 v249, s22, v138
    v_pk_add_f32 v[244:245], v[244:245], v[248:249]
    v_lshlrev_b32 v250, 16, v139
    v_and_b32 v251, s22, v139
    v_pk_add_f32 v[246:247], v[246:247], v[250:251]
    s_waitcnt vmcnt(4)
    v_lshlrev_b32 v248, 16, v140
    v_and_b32 v249, s22, v140
    v_pk_add_f32 v[240:241], v[240:241], v[248:249]
    v_lshlrev_b32 v250, 16, v141
    v_and_b32 v251, s22, v141
    v_pk_add_f32 v[242:243], v[242:243], v[250:251]
    v_lshlrev_b32 v248, 16, v142
    v_and_b32 v249, s22, v142
    v_pk_add_f32 v[244:245], v[244:245], v[248:249]
    v_lshlrev_b32 v250, 16, v143
    v_and_b32 v251, s22, v143
    v_pk_add_f32 v[246:247], v[246:247], v[250:251]
    s_waitcnt vmcnt(3)
    v_lshlrev_b32 v248, 16, v144
    v_and_b32 v249, s22, v144
    v_pk_add_f32 v[240:241], v[240:241], v[248:249]
    v_lshlrev_b32 v250, 16, v145
    v_and_b32 v251, s22, v145
    v_pk_add_f32 v[242:243], v[242:243], v[250:251]
    v_lshlrev_b32 v248, 16, v146
    v_and_b32 v249, s22, v146
    v_pk_add_f32 v[244:245], v[244:245], v[248:249]
    v_lshlrev_b32 v250, 16, v147
    v_and_b32 v251, s22, v147
    v_pk_add_f32 v[246:247], v[246:247], v[250:251]
    s_waitcnt vmcnt(2)
    v_lshlrev_b32 v248, 16, v148
    v_and_b32 v249, s22, v148
    v_pk_add_f32 v[240:241], v[240:241], v[248:249]
    v_lshlrev_b32 v250, 16, v149
    v_and_b32 v251, s22, v149
    v_pk_add_f32 v[242:243], v[242:243], v[250:251]
    v_lshlrev_b32 v248, 16, v150
    v_and_b32 v249, s22, v150
    v_pk_add_f32 v[244:245], v[244:245], v[248:249]
    v_lshlrev_b32 v250, 16, v151
    v_and_b32 v251, s22, v151
    v_pk_add_f32 v[246:247], v[246:247], v[250:251]
    s_waitcnt vmcnt(1)
    v_lshlrev_b32 v248, 16, v152
    v_and_b32 v249, s22, v152
    v_pk_add_f32 v[240:241], v[240:241], v[248:249]
    v_lshlrev_b32 v250, 16, v153
    v_and_b32 v251, s22, v153
    v_pk_add_f32 v[242:243], v[242:243], v[250:251]
    v_lshlrev_b32 v248, 16, v154
    v_and_b32 v249, s22, v154
    v_pk_add_f32 v[244:245], v[244:245], v[248:249]
    v_lshlrev_b32 v250, 16, v155
    v_and_b32 v251, s22, v155
    v_pk_add_f32 v[246:247], v[246:247], v[250:251]
    s_waitcnt vmcnt(0)
    v_lshlrev_b32 v248, 16, v156
    v_and_b32 v249, s22, v156
    v_pk_add_f32 v[240:241], v[240:241], v[248:249]
    v_lshlrev_b32 v250, 16, v157
    v_and_b32 v251, s22, v157
    v_pk_add_f32 v[242:243], v[242:243], v[250:251]
    v_lshlrev_b32 v248, 16, v158
    v_and_b32 v249, s22, v158
    v_pk_add_f32 v[244:245], v[244:245], v[248:249]
    v_lshlrev_b32 v250, 16, v159
    v_and_b32 v251, s22, v159
    v_pk_add_f32 v[246:247], v[246:247], v[250:251]
    v_cvt_pk_bf16_f32 v96, v240, v241
    v_cvt_pk_bf16_f32 v97, v242, v243
    v_cvt_pk_bf16_f32 v98, v244, v245
    v_cvt_pk_bf16_f32 v99, v246, v247
    buffer_store_dwordx2 v[96:97], v28, s[28:31], s79 offen
    buffer_store_dwordx2 v[98:99], v28, s[28:31], s78 offen
L_k1_end4:
    s_endpgm
L_cnt4:
    s_mov_b32 s92, 0
    s_lshl_b32 s93, s16, 5
L_cntl4:
    s_sleep 8
    buffer_load_dword v30, off, s[84:87], s93 sc1
    s_add_u32 s92, s92, 1
    s_waitcnt vmcnt(0)
    v_readfirstlane_b32 s22, v30
    s_cmp_ge_u32 s92, 400000
    s_cbranch_scc1 L_cntok4
    s_cmp_ge_u32 s22, 32
    s_cbranch_scc1 L_cntok4
    s_branch L_cntl4
L_ar4_0:
    s_mov_b64 exec, 1
    v_mov_b32 v3, 1
    s_lshl_b32 s6, s16, 5
    buffer_atomic_add v3, off, s[84:87], s6 sc1
    s_mov_b64 exec, -1
    s_branch L_ab4_0
L_ar4_1:
    s_mov_b64 exec, 1
    v_mov_b32 v3, 1
    s_lshl_b32 s6, s16, 5
    buffer_atomic_add v3, off, s[84:87], s6 sc1
    s_mov_b64 exec, -1
    s_branch L_ab4_1
L_ar4_2:
    s_mov_b64 exec, 1
    v_mov_b32 v3, 1
    s_lshl_b32 s6, s16, 5
    buffer_atomic_add v3, off, s[84:87], s6 sc1
    s_mov_b64 exec, -1
    s_branch L_ab4_2
L_ar4_3:
    s_mov_b64 exec, 1
    v_mov_b32 v3, 1
    s_lshl_b32 s6, s16, 5
    buffer_atomic_add v3, off, s[84:87], s6 sc1
    s_mov_b64 exec, -1
    s_branch L_ab4_3
L_ar4_4:
    s_mov_b64 exec, 1
    v_mov_b32 v3, 1
    s_lshl_b32 s6, s16, 5
    buffer_atomic_add v3, off, s[84:87], s6 sc1
    s_mov_b64 exec, -1
    s_branch L_ab4_4
L_ar4_5:
    s_mov_b64 exec, 1
    v_mov_b32 v3, 1
    s_lshl_b32 s6, s16, 5
    buffer_atomic_add v3, off, s[84:87], s6 sc1
    s_mov_b64 exec, -1
    s_branch L_ab4_5
L_ar4_6:
    s_mov_b64 exec, 1
    v_mov_b32 v3, 1
    s_lshl_b32 s6, s16, 5
    buffer_atomic_add v3, off, s[84:87], s6 sc1
    s_mov_b64 exec, -1
    s_branch L_ab4_6
L_ar4_7:
    s_mov_b64 exec, 1
    v_mov_b32 v3, 1
    s_lshl_b32 s6, s16, 5
    buffer_atomic_add v3, off, s[84:87], s6 sc1
    s_mov_b64 exec, -1
    s_branch L_ab4_7
L_rs4_1:
    s_nop 7
    v_mul_f32 v96, v80, v96
    v_mul_f32 v97, v80, v97
    v_mul_f32 v98, v80, v98
    v_mul_f32 v99, v80, v99
    v_mul_f32 v100, v81, v100
    v_mul_f32 v101, v81, v101
    v_mul_f32 v102, v81, v102
    v_mul_f32 v103, v81, v103
    v_mul_f32 v104, v82, v104
    v_mul_f32 v105, v82, v105
    v_mul_f32 v106, v82, v106
    v_mul_f32 v107, v82, v107
    v_mul_f32 v108, v83, v108
    v_mul_f32 v109, v83, v109
    v_mul_f32 v110, v83, v110
    v_mul_f32 v111, v83, v111
    v_mul_f32 v112, v80, v112
    v_mul_f32 v113, v80, v113
    v_mul_f32 v114, v80, v114
    v_mul_f32 v115, v80, v115
    v_mul_f32 v116, v81, v116
    v_mul_f32 v117, v81, v117
    v_mul_f32 v118, v81, v118
    v_mul_f32 v119, v81, v119
    v_mul_f32 v120, v82, v120
    v_mul_f32 v121, v82, v121
    v_mul_f32 v122, v82, v122
    v_mul_f32 v123, v82, v123
    v_mul_f32 v124, v83, v124
    v_mul_f32 v125, v83, v125
    v_mul_f32 v126, v83, v126
    v_mul_f32 v127, v83, v127
    v_mul_f32 v128, v80, v128
    v_mul_f32 v129, v80, v129
    v_mul_f32 v130, v80, v130
    v_mul_f32 v131, v80, v131
    v_mul_f32 v132, v81, v132
    v_mul_f32 v133, v81, v133
    v_mul_f32 v134, v81, v134
    v_mul_f32 v135, v81, v135
    v_mul_f32 v136, v82, v136
    v_mul_f32 v137, v82, v137
    v_mul_f32 v138, v82, v138
    v_mul_f32 v139, v82, v139
    v_mul_f32 v140, v83, v140
    v_mul_f32 v141, v83, v141
    v_mul_f32 v142, v83, v142
    v_mul_f32 v143, v83, v143
    v_mul_f32 v144, v80, v144
    v_mul_f32 v145, v80, v145
    v_mul_f32 v146, v80, v146
    v_mul_f32 v147, v80, v147
    v_mul_f32 v148, v81, v148
    v_mul_f32 v149, v81, v149
    v_mul_f32 v150, v81, v150
    v_mul_f32 v151, v81, v151
    v_mul_f32 v152, v82, v152
    v_mul_f32 v153, v82, v153
    v_mul_f32 v154, v82, v154
    v_mul_f32 v155, v82, v155
    v_mul_f32 v156, v83, v156
    v_mul_f32 v157, v83, v157
    v_mul_f32 v158, v83, v158
    v_mul_f32 v159, v83, v159
    s_nop 1
    s_branch L_rb4_1
L_rs4_2:
    s_nop 7
    v_mul_f32 v96, v84, v96
    v_mul_f32 v97, v84, v97
    v_mul_f32 v98, v84, v98
    v_mul_f32 v99, v84, v99
    v_mul_f32 v100, v85, v100
    v_mul_f32 v101, v85, v101
    v_mul_f32 v102, v85, v102
    v_mul_f32 v103, v85, v103
    v_mul_f32 v104, v86, v104
    v_mul_f32 v105, v86, v105
    v_mul_f32 v106, v86, v106
    v_mul_f32 v107, v86, v107
    v_mul_f32 v108, v87, v108
    v_mul_f32 v109, v87, v109
    v_mul_f32 v110, v87, v110
    v_mul_f32 v111, v87, v111
    v_mul_f32 v112, v84, v112
    v_mul_f32 v113, v84, v113
    v_mul_f32 v114, v84, v114
    v_mul_f32 v115, v84, v115
    v_mul_f32 v116, v85, v116
    v_mul_f32 v117, v85, v117
    v_mul_f32 v118, v85, v118
    v_mul_f32 v119, v85, v119
    v_mul_f32 v120, v86, v120
    v_mul_f32 v121, v86, v121
    v_mul_f32 v122, v86, v122
    v_mul_f32 v123, v86, v123
    v_mul_f32 v124, v87, v124
    v_mul_f32 v125, v87, v125
    v_mul_f32 v126, v87, v126
    v_mul_f32 v127, v87, v127
    v_mul_f32 v128, v84, v128
    v_mul_f32 v129, v84, v129
    v_mul_f32 v130, v84, v130
    v_mul_f32 v131, v84, v131
    v_mul_f32 v132, v85, v132
    v_mul_f32 v133, v85, v133
    v_mul_f32 v134, v85, v134
    v_mul_f32 v135, v85, v135
    v_mul_f32 v136, v86, v136
    v_mul_f32 v137, v86, v137
    v_mul_f32 v138, v86, v138
    v_mul_f32 v139, v86, v139
    v_mul_f32 v140, v87, v140
    v_mul_f32 v141, v87, v141
    v_mul_f32 v142, v87, v142
    v_mul_f32 v143, v87, v143
    v_mul_f32 v144, v84, v144
    v_mul_f32 v145, v84, v145
    v_mul_f32 v146, v84, v146
    v_mul_f32 v147, v84, v147
    v_mul_f32 v148, v85, v148
    v_mul_f32 v149, v85, v149
    v_mul_f32 v150, v85, v150
    v_mul_f32 v151, v85, v151
    v_mul_f32 v152, v86, v152
    v_mul_f32 v153, v86, v153
    v_mul_f32 v154, v86, v154
    v_mul_f32 v155, v86, v155
    v_mul_f32 v156, v87, v156
    v_mul_f32 v157, v87, v157
    v_mul_f32 v158, v87, v158
    v_mul_f32 v159, v87, v159
    s_nop 1
    s_branch L_rb4_2
L_rs4_3:
    s_nop 7
    v_mul_f32 v96, v88, v96
    v_mul_f32 v97, v88, v97
    v_mul_f32 v98, v88, v98
    v_mul_f32 v99, v88, v99
    v_mul_f32 v100, v89, v100
    v_mul_f32 v101, v89, v101
    v_mul_f32 v102, v89, v102
    v_mul_f32 v103, v89, v103
    v_mul_f32 v104, v90, v104
    v_mul_f32 v105, v90, v105
    v_mul_f32 v106, v90, v106
    v_mul_f32 v107, v90, v107
    v_mul_f32 v108, v91, v108
    v_mul_f32 v109, v91, v109
    v_mul_f32 v110, v91, v110
    v_mul_f32 v111, v91, v111
    v_mul_f32 v112, v88, v112
    v_mul_f32 v113, v88, v113
    v_mul_f32 v114, v88, v114
    v_mul_f32 v115, v88, v115
    v_mul_f32 v116, v89, v116
    v_mul_f32 v117, v89, v117
    v_mul_f32 v118, v89, v118
    v_mul_f32 v119, v89, v119
    v_mul_f32 v120, v90, v120
    v_mul_f32 v121, v90, v121
    v_mul_f32 v122, v90, v122
    v_mul_f32 v123, v90, v123
    v_mul_f32 v124, v91, v124
    v_mul_f32 v125, v91, v125
    v_mul_f32 v126, v91, v126
    v_mul_f32 v127, v91, v127
    v_mul_f32 v128, v88, v128
    v_mul_f32 v129, v88, v129
    v_mul_f32 v130, v88, v130
    v_mul_f32 v131, v88, v131
    v_mul_f32 v132, v89, v132
    v_mul_f32 v133, v89, v133
    v_mul_f32 v134, v89, v134
    v_mul_f32 v135, v89, v135
    v_mul_f32 v136, v90, v136
    v_mul_f32 v137, v90, v137
    v_mul_f32 v138, v90, v138
    v_mul_f32 v139, v90, v139
    v_mul_f32 v140, v91, v140
    v_mul_f32 v141, v91, v141
    v_mul_f32 v142, v91, v142
    v_mul_f32 v143, v91, v143
    v_mul_f32 v144, v88, v144
    v_mul_f32 v145, v88, v145
    v_mul_f32 v146, v88, v146
    v_mul_f32 v147, v88, v147
    v_mul_f32 v148, v89, v148
    v_mul_f32 v149, v89, v149
    v_mul_f32 v150, v89, v150
    v_mul_f32 v151, v89, v151
    v_mul_f32 v152, v90, v152
    v_mul_f32 v153, v90, v153
    v_mul_f32 v154, v90, v154
    v_mul_f32 v155, v90, v155
    v_mul_f32 v156, v91, v156
    v_mul_f32 v157, v91, v157
    v_mul_f32 v158, v91, v158
    v_mul_f32 v159, v91, v159
    s_nop 1
    s_branch L_rb4_3
L_mv4_1:
    s_nop 7
    v_mul_f32 v96, 0xbdb8aa3b, v96
    v_mul_f32 v97, 0xbdb8aa3b, v97
    v_mul_f32 v98, 0xbdb8aa3b, v98
    v_mul_f32 v99, 0xbdb8aa3b, v99
    v_min_f32 v96, v96, v51
    v_min_f32 v97, v97, v52
    v_min_f32 v98, v98, v53
    v_min_f32 v99, v99, v54
    v_sub_f32 v80, v96, v51
    v_sub_f32 v81, v97, v52
    v_sub_f32 v82, v98, v53
    v_sub_f32 v83, v99, v54
    v_exp_f32 v80, v80
    v_exp_f32 v81, v81
    v_exp_f32 v82, v82
    v_exp_f32 v83, v83
    v_mov_b32 v51, v96
    v_mov_b32 v52, v97
    v_mov_b32 v53, v98
    v_mov_b32 v54, v99
    v_mul_f32 v56, v80, v56
    v_mul_f32 v60, v81, v60
    v_mul_f32 v64, v82, v64
    v_mul_f32 v68, v83, v68
    s_bitset1_b32 s4, 1
    s_nop 1
    s_branch L_mb4_1
L_mv4_2:
    s_nop 7
    v_mul_f32 v4, 0xbdb8aa3b, v4
    v_mul_f32 v5, 0xbdb8aa3b, v5
    v_mul_f32 v6, 0xbdb8aa3b, v6
    v_mul_f32 v7, 0xbdb8aa3b, v7
    v_min_f32 v4, v4, v51
    v_min_f32 v5, v5, v52
    v_min_f32 v6, v6, v53
    v_min_f32 v7, v7, v54
    v_sub_f32 v84, v4, v51
    v_sub_f32 v85, v5, v52
    v_sub_f32 v86, v6, v53
    v_sub_f32 v87, v7, v54
    v_exp_f32 v84, v84
    v_exp_f32 v85, v85
    v_exp_f32 v86, v86
    v_exp_f32 v87, v87
    v_mov_b32 v51, v4
    v_mov_b32 v52, v5
    v_mov_b32 v53, v6
    v_mov_b32 v54, v7
    v_mul_f32 v56, v84, v56
    v_mul_f32 v60, v85, v60
    v_mul_f32 v64, v86, v64
    v_mul_f32 v68, v87, v68
    s_bitset1_b32 s4, 2
    s_nop 1
    s_branch L_mb4_2
L_mv4_3:
    s_nop 7
    v_mul_f32 v4, 0xbdb8aa3b, v4
    v_mul_f32 v5, 0xbdb8aa3b, v5
    v_mul_f32 v6, 0xbdb8aa3b, v6
    v_mul_f32 v7, 0xbdb8aa3b, v7
    v_min_f32 v4, v4, v51
    v_min_f32 v5, v5, v52
    v_min_f32 v6, v6, v53
    v_min_f32 v7, v7, v54
    v_sub_f32 v88, v4, v51
    v_sub_f32 v89, v5, v52
    v_sub_f32 v90, v6, v53
    v_sub_f32 v91, v7, v54
    v_exp_f32 v88, v88
    v_exp_f32 v89, v89
    v_exp_f32 v90, v90
    v_exp_f32 v91, v91
    v_mov_b32 v51, v4
    v_mov_b32 v52, v5
    v_mov_b32 v53, v6
    v_mov_b32 v54, v7
    v_mul_f32 v56, v88, v56
    v_mul_f32 v60, v89, v60
    v_mul_f32 v64, v90, v64
    v_mul_f32 v68, v91, v68
    s_bitset1_b32 s4, 3
    s_nop 1
    s_branch L_mb4_3
L_pend4:
.section .rodata,"a"
.p2align 6
.amdhsa_kernel standalone__mha_block_cached__near_ridge_kernel
  .amdhsa_next_free_vgpr 512
  .amdhsa_next_free_sgpr 102
  .amdhsa_accum_offset 256
  .amdhsa_group_segment_fixed_size 0
  .amdhsa_kernarg_size 64
  .amdhsa_user_sgpr_count 2
  .amdhsa_user_sgpr_kernarg_segment_ptr 1
  .amdhsa_system_sgpr_workgroup_id_x 1
  .amdhsa_float_denorm_mode_32 3
.end_amdhsa_kernel
```
